```python
import torch

def _softmax(x, axis=-1):
    return torch.softmax(x, dim=axis)
def _gelu(x):
    return torch.nn.functional.gelu(x, approximate="tanh")
def _silu(x):
    return torch.nn.functional.silu(x)
def _sigmoid(x):
    return torch.sigmoid(x)
def _layernorm(x, axis=-1, eps=1e-5):
    m = x.mean(dim=axis, keepdim=True)
    v = x.var(dim=axis, keepdim=True, unbiased=False)
    return (x - m) / torch.sqrt(v + eps)
def _scatter_add(tgt, idx, src, axis=0):
    return tgt.clone().index_add_(axis, idx, src)
def _segment_sum(src, seg, n):
    out = torch.zeros((n,) + src.shape[1:], dtype=src.dtype)
    return out.index_add_(0, seg, src)
def _pad(x, pw):
    flat = tuple(v for pair in reversed(pw) for v in pair)
    return torch.nn.functional.pad(x, flat)

kernel_name = 'interleave_layers__sliding_local_dilated__dense_activation_mish__prompt'

def setup_inputs():

    _w = (lambda a: (lambda t: t.to(torch.bfloat16) if t.is_floating_point() else t)(torch.as_tensor(a)))
    def _A_setup():
        B, S, D = 1, 2048, 512
        return {
            "x": _w((lambda *s: torch.randn(*s, dtype=torch.bfloat16) * 0.05)(B, S, D)),
            "wqkv": _w((lambda *s: torch.randn(*s, dtype=torch.bfloat16) * 0.05)(D, 3 * D)),
            "wo": _w((lambda *s: torch.randn(*s, dtype=torch.bfloat16) * 0.05)(D, D)),
        }
    _A_in = _A_setup()

    def _B_setup():
        B, S, D, F = 1, 2048, 512, 1792
        return {
            "x": _w((lambda *s: torch.randn(*s, dtype=torch.bfloat16) * 0.05)(B, S, D)),
            "w1": _w((lambda *s: torch.randn(*s, dtype=torch.bfloat16) * 0.8)(D, F) * (D ** -0.5)),
            "b1": _w((lambda *s: torch.randn(*s, dtype=torch.bfloat16) * 0.8)(F)),
            "w2": _w((lambda *s: torch.randn(*s, dtype=torch.bfloat16) * 0.8)(F, D) * (F ** -0.5)),
        }
    _B_in = _B_setup()

    return {
        "A_x": _A_in["x"],
        "A_wqkv": _A_in["wqkv"],
        "A_wo": _A_in["wo"],
        "B_x": _B_in["x"],
        "B_w1": _B_in["w1"],
        "B_b1": _B_in["b1"],
        "B_w2": _B_in["w2"],
    }

def reference(A_x, A_wqkv, A_wo, B_x, B_w1, B_b1, B_w2):
    def _A_ref(x, wqkv, wo):
        B, S, D = x.shape
        H = 32; Dh = D // H
        W, dil = 8, 2
        qkv = (lambda x, *d: x.permute(*d))((x @ wqkv).reshape(B, S, 3, H, Dh), 2, 0, 3, 1, 4)
        q, k, v = qkv[0], qkv[1], qkv[2]
        scale = Dh ** -0.5
        pos = torch.arange(S)
        off = torch.arange(W) * dil
        idx = pos[:, None] - off[None, :]
        mask = idx >= 0
        idx_c = torch.where(mask, idx, 0).reshape(-1)
        kg = k[:, :, idx_c, :].reshape(B, H, S, W, Dh)
        vg = v[:, :, idx_c, :].reshape(B, H, S, W, Dh)
        logits = torch.einsum("bhsd,bhswd->bhsw", q, kg) * scale
        logits = torch.where(mask[None, None, :, :], logits, -1e9)
        attn = _softmax(logits, axis=-1)
        o = torch.einsum("bhsw,bhswd->bhsd", attn, vg)
        return (lambda x, *d: x.permute(*d))(o, 0, 2, 1, 3).reshape(B, S, D) @ wo

    def _B_ref(x, w1, b1, w2):
        h = torch.einsum("bsd,df->bsf", x, w1) + b1
        sp = torch.log1p(torch.exp(-torch.abs(h))) + torch.where(h > 0, h, torch.zeros_like(h))
        act = h * torch.tanh(sp)
        return torch.einsum("bsf,fd->bsd", act, w2)

    x = A_x
    x = x + _A_ref(_layernorm(x, axis=-1), A_wqkv, A_wo)
    x = x + _B_ref(_layernorm(x, axis=-1), B_w1, B_b1, B_w2)
    x = x + _A_ref(_layernorm(x, axis=-1), A_wqkv, A_wo)
    x = x + _B_ref(_layernorm(x, axis=-1), B_w1, B_b1, B_w2)
    return x
```

```asm
; @launch grid=(256,1,1) block=(256,1,1) lds=163840
.amdgcn_target "amdgcn-amd-amdhsa--gfx950"
.text
.globl interleave_layers__sliding_local_dilated__dense_activation_mish__prompt_kernel
.p2align 8
.type interleave_layers__sliding_local_dilated__dense_activation_mish__prompt_kernel,@function
interleave_layers__sliding_local_dilated__dense_activation_mish__prompt_kernel:
  s_cmp_ge_u32 s2, 256
  s_cbranch_scc1 L_END
  s_load_dwordx16 s[72:87], s[0:1], 0
  s_load_dwordx4 s[88:91], s[0:1], 64
  s_getpc_b64 s[50:51]
L_PC:
  s_lshr_b32 s52, s2, 3
  s_mul_i32 s52, s52, 12
  v_lshrrev_b32 v252, 6, v0
  v_mul_u32_u24 v252, 3, v252
  v_and_b32 v253, 63, v0
  v_add3_u32 v252, v252, v253, s52
  v_lshlrev_b32 v252, 7, v252
  v_min_u32 v252, L_END-L_PC, v252
  s_mov_b64 exec, 7
  global_load_dword v102, v252, s[50:51]
  s_mov_b64 exec, -1
  s_getreg_b32 s44, hwreg(HW_REG_XCC_ID, 0, 4)
  s_and_b32 s52, s2, 7
  s_lshr_b32 s53, s2, 3
  s_lshr_b32 s54, s53, 4
  s_lshl_b32 s4, s52, 1
  s_add_u32 s4, s4, s54
  s_and_b32 s5, s53, 15
  v_lshrrev_b32 v252, 6, v0
  v_and_b32 v0, 63, v0
  v_readfirstlane_b32 s6, v252
  v_lshlrev_b32 v45, 7, v0
  v_lshlrev_b32 v1, 4, v0
  v_lshrrev_b32 v252, 2, v0
  v_lshrrev_b32 v253, 2, v252
  v_xor_b32 v253, v253, v0
  v_and_b32 v253, 3, v253
  v_lshlrev_b32 v253, 4, v253
  v_lshl_add_u32 v240, v252, 11, v253
  v_lshlrev_b32 v254, 1, v252
  v_add_u32 v255, 16, v254
  v_add_u32 v254, 1, v254
  v_cmp_gt_u32 vcc, 8, v252
  s_lshr_b32 s59, s5, 3
  s_and_b32 s60, s5, 7
  v_cndmask_b32 v254, v254, v255, vcc
  v_lshl_add_u32 v241, v254, 10, v253
  s_cmp_eq_u32 s4, 0
  s_cselect_b32 s53, 0x40000000, 0
  v_or_b32 v241, s53, v241
  v_lshrrev_b32 v253, 4, v0
  v_lshrrev_b32 v254, 1, v0
  v_xor_b32 v253, v253, v254
  v_and_b32 v253, 1, v253
  v_lshlrev_b32 v253, 5, v253
  v_and_b32 v254, 1, v0
  v_lshl_add_u32 v253, v254, 4, v253
  v_mul_u32_u24 v254, 3072, v252
  v_add_u32 v35, v253, v254
  s_mov_b32 s3, 0
  s_mov_b32 s7, 0
  s_mul_i32 s45, s6, 49152
  s_lshl_b32 s52, s5, 6
  s_add_u32 s45, s45, s52
  s_lshl_b32 s46, s6, 10
  s_lshl_b32 s47, s6, 13
  s_and_b32 s52, s60, 7
  s_lshl_b32 s52, s52, 7
  s_add_u32 s47, s47, s52
  s_mul_i32 s48, s6, 114688
  s_mul_i32 s52, s5, 224
  s_add_u32 s48, s48, s52
  s_mul_i32 s49, s6, 7168
  s_lshl_b32 s57, s4, 8
  s_lshl_b32 s52, s5, 2
  s_add_u32 s52, s52, s6
  s_lshl_b32 s52, s52, 2
  s_add_u32 s56, s57, s52
  s_and_b32 s52, s4, 1
  s_lshl_b32 s52, s52, 4
  s_add_u32 s52, s52, s5
  s_lshl_b32 s52, s52, 2
  s_add_u32 s52, s52, s6
  s_lshl_b32 s100, s52, 13
  s_mul_i32 s94, s52, 2176
  s_lshl_b32 s52, s5, 2
  s_add_u32 s52, s52, s6
  s_lshl_b32 s101, s52, 13
  s_mul_i32 s58, s4, 598016
  s_andn2_b32 s52, s4, 1
  s_lshl_b32 s52, s52, 17
  s_sub_u32 s52, s52, 16384
  s_max_i32 s52, s52, 0
  s_add_u32 s94, s94, s52
  s_lshl_b32 s52, s4, 7
  s_sub_u32 s53, s52, 32
  s_lshl_b32 s97, s53, 10
  s_cmp_eq_u32 s4, 0
  s_cselect_b32 s97, 0, s97
  s_lshl_b32 s53, s6, 6
  s_add_u32 s97, s97, s53
  s_lshl_b32 s53, s6, 1
  s_add_u32 s53, s53, 0
  s_and_b32 s53, s53, 3
  s_lshl_b32 s53, s53, 5
  s_add_u32 s53, s53, s52
  s_lshr_b32 s54, s6, 1
  s_add_u32 s53, s53, s54
  s_lshl_b32 s95, s53, 10
  s_lshl_b32 s53, s6, 1
  s_add_u32 s53, s53, 1
  s_and_b32 s53, s53, 3
  s_lshl_b32 s53, s53, 5
  s_add_u32 s53, s53, s52
  s_lshr_b32 s54, s6, 1
  s_add_u32 s53, s53, s54
  s_lshl_b32 s96, s53, 10
  s_lshl_b32 s98, s6, 11
  s_waitcnt lgkmcnt(0)
  s_mov_b32 s8, s72
  s_and_b32 s9, s73, 0xffff
  s_mov_b32 s10, 0x200000
  s_mov_b32 s11, 0x20000
  s_mov_b32 s12, s74
  s_and_b32 s13, s75, 0xffff
  s_mov_b32 s14, 0x180000
  s_mov_b32 s15, 0x20000
  s_mov_b32 exec_lo, 0x1ffff
  s_mov_b32 exec_hi, 0
  buffer_load_dword v102, v45, s[8:11], s94 offen
  s_mov_b64 exec, -1
  s_lshr_b32 s55, s100, 13
  s_mul_i32 s55, s55, 3072
  s_add_u32 s55, s55, 0
  s_mov_b32 exec_lo, 0xffffff
  s_mov_b32 exec_hi, 0x0
  buffer_load_dword v102, v45, s[12:15], s55 offen
  s_mov_b64 exec, -1
  s_lshr_b32 s55, s100, 13
  s_mul_i32 s55, s55, 3072
  s_add_u32 s55, s55, 393216
  s_mov_b32 exec_lo, 0xffffff
  s_mov_b32 exec_hi, 0x0
  buffer_load_dword v102, v45, s[12:15], s55 offen
  s_mov_b64 exec, -1
  s_mov_b32 s16, s76
  s_and_b32 s17, s77, 0xffff
  s_mov_b32 s18, 0x80000
  s_mov_b32 s19, 0x20000
  s_mov_b32 s20, s80
  s_and_b32 s21, s81, 0xffff
  s_mov_b32 s22, 0x1c0000
  s_mov_b32 s23, 0x20000
  s_mov_b32 s40, s82
  s_and_b32 s41, s83, 0xffff
  s_mov_b32 s42, 0xe00
  s_mov_b32 s43, 0x20000
  s_mov_b32 s24, s84
  s_and_b32 s25, s85, 0xffff
  s_mov_b32 s26, 0x1c0000
  s_mov_b32 s27, 0x20000
  s_mov_b32 s32, s86
  s_and_b32 s33, s87, 0xffff
  s_mov_b32 s34, 0x200000
  s_mov_b32 s35, 0x20000
  s_mov_b32 s36, s88
  s_and_b32 s37, s89, 0xffff
  s_mov_b32 s38, 0x100
  s_mov_b32 s39, 0x20000
  s_mov_b32 s28, s90
  s_and_b32 s29, s91, 0xffff
  s_mov_b32 s30, 0x2a00000
  s_mov_b32 s31, 0x20000
  s_mov_b32 s83, s95
  s_mov_b32 s84, s96
  s_mov_b32 s85, s97
  s_mov_b32 s82, s98
  s_and_b32 s52, s4, 1
  s_lshl_b32 s52, s52, 3
  s_add_u32 s52, s52, s5
  s_and_b32 s99, s52, 0
  s_lshl_b32 s98, s99, 1
  s_add_u32 s98, s98, s6
  s_lshl_b32 s95, s5, 6
  s_lshl_b32 s52, s6, 6
  s_sub_u32 s85, s85, s52
  v_mov_b32 v253, 0
  s_mov_b64 exec, 1
  buffer_store_dword v253, v253, s[28:31], s56 offen sc1
  s_mov_b64 exec, -1
  v_and_b32 v250, 15, v0
  v_lshrrev_b32 v251, 4, v0
  v_lshrrev_b32 v252, 2, v250
  v_lshl_add_u32 v249, v251, 2, v252
  v_and_b32 v248, 3, v250
  v_mov_b32 v10, 0x3f803f80
  v_mov_b32 v11, 0x3f803f80
  v_mov_b32 v12, 0x3f803f80
  v_mov_b32 v13, 0x3f803f80
  v_lshlrev_b32 v252, 6, v249
  v_lshl_add_u32 v252, v248, 3, v252
  v_add_u32 v252, 2048, v252
  v_and_b32 v253, 1, v251
  v_lshlrev_b32 v253, 5, v253
  v_add_u32 v14, v252, v253
  v_xor_b32 v254, 32, v253
  v_add_u32 v15, v252, v254
  v_add_u32 v16, 0x10000, v14
  v_add_u32 v17, 0x10000, v15
  s_and_b32 s53, s6, 1
  s_lshl_b32 s53, s53, 5
  v_xor_b32 v254, s53, v253
  v_add_u32 v19, v252, v254
  s_lshr_b32 s53, s6, 1
  s_add_u32 s53, s53, 1
  s_lshl_b32 s53, s53, 15
  v_add_u32 v18, s53, v19
  v_lshrrev_b32 v252, 1, v251
  v_lshrrev_b32 v253, 2, v250
  v_xor_b32 v252, v252, v253
  v_lshlrev_b32 v252, 4, v252
  v_lshl_add_u32 v252, v250, 6, v252
  v_and_b32 v253, 1, v251
  v_lshl_add_u32 v252, v253, 3, v252
  v_add_u32 v244, 100352, v252
  v_xor_b32 v245, 32, v244
  s_lshl_b32 s53, s6, 11
  s_add_u32 s53, s53, 116736
  v_add_u32 v242, s53, v252
  v_xor_b32 v243, 32, v242
  v_cmp_eq_u32 s[68:69], 1, v248
  v_cmp_eq_u32 s[70:71], 2, v248
  v_cmp_eq_u32 s[72:73], 3, v248
  v_lshrrev_b32 v252, 2, v250
  v_cmp_eq_u32 s[74:75], v252, v251
  v_lshlrev_b32 v44, 4, v251
  s_lshl_b32 s87, s4, 17
  s_lshl_b32 s52, s59, 2
  s_add_u32 s86, s52, s6
  v_and_b32 v228, 15, v0
  v_lshrrev_b32 v229, 4, v0
  v_lshrrev_b32 v232, 2, v228
  v_lshl_add_u32 v230, v229, 2, v232
  v_and_b32 v231, 3, v228
  v_lshrrev_b32 v232, 3, v0
  v_lshrrev_b32 v233, 1, v232
  v_lshrrev_b32 v234, 1, v0
  v_xor_b32 v233, v233, v234
  v_and_b32 v233, 3, v233
  v_lshlrev_b32 v233, 5, v233
  v_and_b32 v234, 1, v0
  v_lshl_add_u32 v233, v234, 4, v233
  v_lshl_add_u32 v36, v232, 10, v233
  v_add_u32 v232, 0, v0
  v_mul_u32_u24 v233, 4682, v232
  v_lshrrev_b32 v233, 16, v233
  v_mul_u32_u24 v234, 14, v233
  v_sub_u32 v234, v232, v234
  v_lshlrev_b32 v234, 4, v234
  v_mul_u32_u24 v233, 3584, v233
  v_add_u32 v37, v233, v234
  v_add_u32 v232, 64, v0
  v_mul_u32_u24 v233, 4682, v232
  v_lshrrev_b32 v233, 16, v233
  v_mul_u32_u24 v234, 14, v233
  v_sub_u32 v234, v232, v234
  v_lshlrev_b32 v234, 4, v234
  v_mul_u32_u24 v233, 3584, v233
  v_add_u32 v38, v233, v234
  v_add_u32 v232, 128, v0
  v_mul_u32_u24 v233, 4682, v232
  v_lshrrev_b32 v233, 16, v233
  v_mul_u32_u24 v234, 14, v233
  v_sub_u32 v234, v232, v234
  v_lshlrev_b32 v234, 4, v234
  v_mul_u32_u24 v233, 3584, v233
  v_add_u32 v39, v233, v234
  v_add_u32 v232, 192, v0
  v_mul_u32_u24 v233, 4682, v232
  v_lshrrev_b32 v233, 16, v233
  v_mul_u32_u24 v234, 14, v233
  v_sub_u32 v234, v232, v234
  v_lshlrev_b32 v234, 4, v234
  v_mul_u32_u24 v233, 3584, v233
  v_add_u32 v40, v233, v234
  v_add_u32 v232, 256, v0
  v_mul_u32_u24 v233, 4682, v232
  v_lshrrev_b32 v233, 16, v233
  v_mul_u32_u24 v234, 14, v233
  v_sub_u32 v234, v232, v234
  v_lshlrev_b32 v234, 4, v234
  v_mul_u32_u24 v233, 3584, v233
  v_add_u32 v41, v233, v234
  v_add_u32 v232, 320, v0
  v_mul_u32_u24 v233, 4682, v232
  v_lshrrev_b32 v233, 16, v233
  v_mul_u32_u24 v234, 14, v233
  v_sub_u32 v234, v232, v234
  v_lshlrev_b32 v234, 4, v234
  v_mul_u32_u24 v233, 3584, v233
  v_add_u32 v42, v233, v234
  v_add_u32 v232, 384, v0
  v_mul_u32_u24 v233, 4682, v232
  v_lshrrev_b32 v233, 16, v233
  v_mul_u32_u24 v234, 14, v233
  v_sub_u32 v234, v232, v234
  v_lshlrev_b32 v234, 4, v234
  v_mul_u32_u24 v233, 3584, v233
  v_add_u32 v43, v233, v234
  s_lshl_b32 s80, s4, 7
  s_lshl_b32 s81, s6, 5
  s_add_u32 s80, s80, s81
  s_add_u32 s80, s80, s59
  s_lshl_b32 s80, s80, 10
  s_lshl_b32 s81, s60, 7
  s_add_u32 s61, s80, s81
  v_lshlrev_b32 v233, 11, v228
  v_lshl_add_u32 v236, v229, 3, v233
  v_and_b32 v234, 1, v229
  v_lshlrev_b32 v234, 5, v234
  v_lshrrev_b32 v235, 1, v229
  v_lshl_add_u32 v234, v235, 4, v234
  v_lshl_add_u32 v71, v228, 11, v234
  s_mov_b32 s62, 1.0
  s_mov_b32 s63, 1.0
  s_mov_b32 s64, 0xbfb17218
  s_mov_b32 s65, 0xbfb17218
  v_mov_b32 v64, 0x3f317218
  v_mov_b32 v65, 0x3f317218
  v_mul_u32_u24 v232, 224, v230
  v_lshl_add_u32 v20, v231, 3, v232
  v_add_u32 v21, 0x10000, v20
  v_add_u32 v22, 0x20000, v20
  v_lshlrev_b32 v232, 7, v230
  v_lshl_add_u32 v232, v231, 3, v232
  s_and_b32 s80, s6, 1
  s_lshl_b32 s80, s80, 12
  s_add_u32 s80, s80, 2048
  v_add_u32 v232, s80, v232
  v_lshrrev_b32 v233, 1, v230
  v_and_b32 v233, 3, v233
  v_xor_b32 v234, 0, v233
  v_lshl_add_u32 v23, v234, 5, v232
  v_add_u32 v24, 0x10000, v23
  v_add_u32 v25, 0x20000, v23
  v_xor_b32 v234, 1, v233
  v_lshl_add_u32 v26, v234, 5, v232
  v_add_u32 v27, 0x10000, v26
  v_add_u32 v28, 0x20000, v26
  v_xor_b32 v234, 2, v233
  v_lshl_add_u32 v29, v234, 5, v232
  v_add_u32 v30, 0x10000, v29
  v_add_u32 v31, 0x20000, v29
  v_xor_b32 v234, 3, v233
  v_lshl_add_u32 v32, v234, 5, v232
  v_add_u32 v33, 0x10000, v32
  v_add_u32 v34, 0x20000, v32
  v_mov_b32 v235, 0xf149f2ca
  v_lshl_add_u32 v232, v229, 2, 0
  v_sub_u32 v233, v228, v232
  v_cmp_gt_u32 vcc, 8, v233
  s_nop 1
  v_cndmask_b32_e64 v46, v235, 0, vcc
  v_add_u32 v233, 9, v228
  v_cmp_ge_u32 vcc, v232, v233
  s_nop 1
  v_cndmask_b32_e64 v50, v235, 0, vcc
  v_lshl_add_u32 v232, v229, 2, 1
  v_sub_u32 v233, v228, v232
  v_cmp_gt_u32 vcc, 8, v233
  s_nop 1
  v_cndmask_b32_e64 v47, v235, 0, vcc
  v_add_u32 v233, 9, v228
  v_cmp_ge_u32 vcc, v232, v233
  s_nop 1
  v_cndmask_b32_e64 v51, v235, 0, vcc
  v_lshl_add_u32 v232, v229, 2, 2
  v_sub_u32 v233, v228, v232
  v_cmp_gt_u32 vcc, 8, v233
  s_nop 1
  v_cndmask_b32_e64 v48, v235, 0, vcc
  v_add_u32 v233, 9, v228
  v_cmp_ge_u32 vcc, v232, v233
  s_nop 1
  v_cndmask_b32_e64 v52, v235, 0, vcc
  v_lshl_add_u32 v232, v229, 2, 3
  v_sub_u32 v233, v228, v232
  v_cmp_gt_u32 vcc, 8, v233
  s_nop 1
  v_cndmask_b32_e64 v49, v235, 0, vcc
  v_add_u32 v233, 9, v228
  v_cmp_ge_u32 vcc, v232, v233
  s_nop 1
  v_cndmask_b32_e64 v53, v235, 0, vcc
  s_and_b32 s80, s6, 1
  s_or_b32 s80, s80, s4
  s_cmp_eq_u32 s80, 0
  s_cselect_b64 vcc, -1, 0
  v_cndmask_b32 v54, v50, v235, vcc
  v_cndmask_b32 v55, v51, v235, vcc
  v_cndmask_b32 v56, v52, v235, vcc
  v_cndmask_b32 v57, v53, v235, vcc
  v_lshlrev_b32 v232, 2, v229
  v_add_u32 v233, 6, v228
  v_cmp_ge_u32 s[66:67], v232, v233
  v_lshlrev_b32 v232, 5, v228
  v_lshl_add_u32 v232, v229, 3, v232
  s_lshl_b32 s80, s6, 11
  s_add_u32 s80, s80, 67584
  v_add_u32 v58, s80, v232
  s_lshr_b32 s80, s6, 1
  s_add_u32 s81, s80, 3
  s_bitcmp1_b32 s6, 0
  s_cselect_b32 s80, s81, s80
  s_lshl_b32 s80, s80, 10
  s_add_u32 s80, s80, 76800
  v_lshlrev_b32 v233, 3, v0
  v_add_u32 v59, s80, v233
  s_and_b32 s80, s6, 1
  s_lshl_b32 s80, s80, 9
  s_add_u32 s81, s80, 78848
  v_add_u32 v234, s81, v233
  s_add_u32 s81, s80, 75776
  v_add_u32 v235, s81, v232
  s_cmp_ge_u32 s6, 2
  s_cselect_b64 vcc, -1, 0
  v_cndmask_b32 v60, v234, v235, vcc
  v_lshlrev_b32 v232, 5, v230
  v_lshl_add_u32 v232, v231, 3, v232
  s_lshl_b32 s80, s6, 11
  s_add_u32 s80, s80, 67584
  v_add_u32 v62, s80, v232
  v_subrev_u32 v233, 1024, v62
  v_add_u32 v234, 75776, v232
  v_subrev_u32 v235, 256, v234
  v_cmp_le_u32 vcc, 8, v230
  s_nop 1
  v_cndmask_b32 v235, v234, v235, vcc
  s_cmp_eq_u32 s6, 0
  s_cselect_b64 vcc, -1, 0
  v_cndmask_b32 v234, v234, v235, vcc
  s_bitcmp1_b32 s6, 0
  s_cselect_b64 vcc, -1, 0
  v_cndmask_b32 v61, v234, v233, vcc
  v_lshlrev_b32 v232, 3, v0
  s_lshr_b32 s80, s6, 1
  s_bitcmp1_b32 s6, 0
  s_cselect_b32 s80, s80, 2
  s_lshl_b32 s80, s80, 10
  s_add_u32 s80, s80, 76800
  v_add_u32 v232, s80, v232
  v_subrev_u32 v233, 64, v232
  v_cmp_le_u32 vcc, 8, v228
  s_nop 1
  v_cndmask_b32 v233, v232, v233, vcc
  s_cmp_eq_u32 s6, 0
  s_cselect_b64 vcc, -1, 0
  v_cndmask_b32 v63, v232, v233, vcc
  s_lshl_b32 s80, s6, 12
  v_add_u32 v66, s80, v1
  v_xor_b32 v67, 0x1000, v66
  s_lshr_b32 s80, s60, 1
  s_lshl_b32 s80, s80, 8
  s_and_b32 s81, s60, 1
  s_lshl_b32 s81, s81, 3
  s_add_u32 s80, s80, s81
  v_lshlrev_b32 v232, 4, v228
  v_add_u32 v68, s80, v232
  s_cmp_eq_u32 s59, 0
  s_cselect_b32 s81, 8, 0
  v_subrev_u32 v232, s81, v228
  v_lshl_add_u32 v233, v229, 4, v232
  v_lshlrev_b32 v233, 4, v233
  v_lshlrev_b32 v234, 4, v232
  v_add_u32 v234, s80, v234
  s_cmp_eq_u32 s6, 3
  s_cselect_b32 s80, 0, 0x40000000
  s_cmp_eq_u32 s4, 15
  s_cselect_b32 s80, 0x40000000, s80
  v_mov_b32 v235, 0x40000000
  v_cmp_le_u32 vcc, 8, v228
  s_nop 1
  v_cndmask_b32 v233, v235, v233, vcc
  v_cndmask_b32 v234, v235, v234, vcc
  v_or_b32 v69, s80, v233
  v_or_b32 v70, s80, v234
  s_add_u32 m0, s82, 116736
  s_add_u32 s52, s83, 0
  buffer_load_dwordx4 v240, s[8:11], s52 offen lds
  s_add_u32 m0, s82, 117760
  s_add_u32 s52, s84, 0
  buffer_load_dwordx4 v240, s[8:11], s52 offen lds
  s_add_u32 m0, s46, 2048
  s_add_u32 s52, s45, 0
  buffer_load_dwordx4 v35, s[12:15], s52 offen lds
  s_add_u32 m0, s46, 34816
  s_add_u32 s52, s45, 1024
  buffer_load_dwordx4 v35, s[12:15], s52 offen lds
  s_add_u32 m0, s46, 67584
  s_add_u32 s52, s45, 2048
  buffer_load_dwordx4 v35, s[12:15], s52 offen lds
  s_add_u32 m0, s46, 6144
  s_add_u32 s52, s45, 196608
  buffer_load_dwordx4 v35, s[12:15], s52 offen lds
  s_add_u32 m0, s46, 38912
  s_add_u32 s52, s45, 197632
  buffer_load_dwordx4 v35, s[12:15], s52 offen lds
  s_add_u32 m0, s46, 71680
  s_add_u32 s52, s45, 198656
  buffer_load_dwordx4 v35, s[12:15], s52 offen lds
  s_add_u32 m0, s46, 100352
  s_add_u32 s52, s97, 0
  buffer_load_dwordx4 v241, s[8:11], s52 offen lds
  s_add_u32 m0, s82, 124928
  s_add_u32 s52, s83, 64
  buffer_load_dwordx4 v240, s[8:11], s52 offen lds
  s_add_u32 m0, s82, 125952
  s_add_u32 s52, s84, 64
  buffer_load_dwordx4 v240, s[8:11], s52 offen lds
  s_waitcnt vmcnt(2)
  s_barrier
  ds_read_b64 v[180:181], v242 offset:0
  ds_read_b64 v[182:183], v243 offset:0
  ds_read_b64 v[184:185], v242 offset:1024
  ds_read_b64 v[186:187], v243 offset:1024
  ds_read_b64 v[188:189], v244 offset:0
  ds_read_b64 v[190:191], v245 offset:0
  ds_read_b64_tr_b16 v[72:73], v14 offset:0
  ds_read_b64_tr_b16 v[74:75], v14 offset:1024
  ds_read_b64_tr_b16 v[76:77], v15 offset:0
  ds_read_b64_tr_b16 v[78:79], v15 offset:1024
  ds_read_b64_tr_b16 v[80:81], v14 offset:32768
  ds_read_b64_tr_b16 v[82:83], v14 offset:33792
  s_waitcnt lgkmcnt(4)
  v_mfma_f32_16x16x32_bf16 v[104:107], v[72:75], v[180:183], 0
  ds_read_b64_tr_b16 v[84:85], v15 offset:32768
  s_add_u32 m0, s82, 133120
  s_add_u32 s52, s83, 128
  buffer_load_dwordx4 v240, s[8:11], s52 offen lds
  v_mfma_f32_16x16x32_bf16 v[108:111], v[72:75], v[184:187], 0
  s_waitcnt lgkmcnt(3)
  ds_read_b64_tr_b16 v[86:87], v15 offset:33792
  v_mfma_f32_16x16x32_bf16 v[112:115], v[76:79], v[180:183], 0
  ds_read_b64_tr_b16 v[88:89], v16 offset:0
  s_add_u32 m0, s82, 134144
  s_add_u32 s52, s84, 128
  buffer_load_dwordx4 v240, s[8:11], s52 offen lds
  v_mfma_f32_16x16x32_bf16 v[116:119], v[76:79], v[184:187], 0
  ds_read_b64_tr_b16 v[90:91], v16 offset:1024
  v_mfma_f32_16x16x32_bf16 v[204:207], v[10:13], v[180:183], 0
  v_mfma_f32_16x16x32_bf16 v[216:219], v[180:183], v[180:183], 0
  s_waitcnt lgkmcnt(4)
  s_add_u32 m0, s46, 10240
  s_add_u32 s52, s45, 393216
  buffer_load_dwordx4 v35, s[12:15], s52 offen lds
  v_mfma_f32_16x16x32_bf16 v[120:123], v[80:83], v[180:183], 0
  ds_read_b64_tr_b16 v[92:93], v17 offset:0
  v_mfma_f32_16x16x32_bf16 v[124:127], v[80:83], v[184:187], 0
  s_waitcnt lgkmcnt(3)
  ds_read_b64_tr_b16 v[94:95], v17 offset:1024
  v_mfma_f32_16x16x32_bf16 v[128:131], v[84:87], v[180:183], 0
  ds_read_b64_tr_b16 v[72:73], v18 offset:0
  s_add_u32 m0, s46, 43008
  s_add_u32 s52, s45, 394240
  buffer_load_dwordx4 v35, s[12:15], s52 offen lds
  v_mfma_f32_16x16x32_bf16 v[132:135], v[84:87], v[184:187], 0
  ds_read_b64_tr_b16 v[74:75], v18 offset:1024
  v_mfma_f32_16x16x32_bf16 v[208:211], v[10:13], v[184:187], 0
  v_mfma_f32_16x16x32_bf16 v[220:223], v[184:187], v[184:187], 0
  s_waitcnt lgkmcnt(4)
  s_add_u32 m0, s46, 75776
  s_add_u32 s52, s45, 395264
  buffer_load_dwordx4 v35, s[12:15], s52 offen lds
  v_mfma_f32_16x16x32_bf16 v[136:139], v[88:91], v[180:183], 0
  ds_read_b64_tr_b16 v[76:77], v19 offset:0
  v_mfma_f32_16x16x32_bf16 v[140:143], v[88:91], v[184:187], 0
  s_waitcnt lgkmcnt(3)
  ds_read_b64_tr_b16 v[78:79], v19 offset:1024
  v_mfma_f32_16x16x32_bf16 v[144:147], v[92:95], v[180:183], 0
  s_waitcnt vmcnt(5)
  ds_read_b64 v[192:193], v242 offset:8192
  ds_read_b64 v[194:195], v243 offset:8192
  s_add_u32 m0, s82, 141312
  s_add_u32 s52, s83, 192
  buffer_load_dwordx4 v240, s[8:11], s52 offen lds
  v_mfma_f32_16x16x32_bf16 v[148:151], v[92:95], v[184:187], 0
  ds_read_b64 v[196:197], v242 offset:9216
  ds_read_b64 v[198:199], v243 offset:9216
  v_mfma_f32_16x16x32_bf16 v[212:215], v[10:13], v[188:191], 0
  ds_read_b64 v[200:201], v244 offset:1024
  ds_read_b64 v[202:203], v245 offset:1024
  s_add_u32 m0, s82, 142336
  s_add_u32 s52, s84, 192
  buffer_load_dwordx4 v240, s[8:11], s52 offen lds
  v_mfma_f32_16x16x32_bf16 v[224:227], v[188:191], v[188:191], 0
  s_waitcnt lgkmcnt(8)
  ds_read_b64_tr_b16 v[80:81], v14 offset:2048
  ds_read_b64_tr_b16 v[82:83], v14 offset:3072
  v_mfma_f32_16x16x32_bf16 v[152:155], v[72:75], v[188:191], 0
  ds_read_b64_tr_b16 v[84:85], v15 offset:2048
  v_mfma_f32_16x16x32_bf16 v[156:159], v[72:75], v[10:13], 0
  s_waitcnt lgkmcnt(9)
  ds_read_b64_tr_b16 v[86:87], v15 offset:3072
  s_lshr_b32 s55, s100, 13
  s_mul_i32 s55, s55, 3072
  s_add_u32 s55, s55, 786432
  s_mov_b32 exec_lo, 0xffffff
  s_mov_b32 exec_hi, 0x0
  buffer_load_dword v102, v45, s[12:15], s55 offen
  s_mov_b64 exec, -1
  v_mfma_f32_16x16x32_bf16 v[160:163], v[76:79], v[10:13], 0
  s_waitcnt lgkmcnt(2)
  ds_read_b64_tr_b16 v[88:89], v14 offset:34816
  ds_read_b64_tr_b16 v[90:91], v14 offset:35840
  v_mfma_f32_16x16x32_bf16 v[104:107], v[80:83], v[192:195], v[104:107]
  ds_read_b64_tr_b16 v[92:93], v15 offset:34816
  v_mfma_f32_16x16x32_bf16 v[108:111], v[80:83], v[196:199], v[108:111]
  s_waitcnt lgkmcnt(3)
  ds_read_b64_tr_b16 v[94:95], v15 offset:35840
  s_add_u32 m0, s46, 14336
  s_add_u32 s52, s45, 589824
  buffer_load_dwordx4 v35, s[12:15], s52 offen lds
  v_mfma_f32_16x16x32_bf16 v[112:115], v[84:87], v[192:195], v[112:115]
  ds_read_b64_tr_b16 v[72:73], v16 offset:2048
  v_mfma_f32_16x16x32_bf16 v[116:119], v[84:87], v[196:199], v[116:119]
  ds_read_b64_tr_b16 v[74:75], v16 offset:3072
  v_mfma_f32_16x16x32_bf16 v[204:207], v[10:13], v[192:195], v[204:207]
  s_add_u32 m0, s46, 47104
  s_add_u32 s52, s45, 590848
  buffer_load_dwordx4 v35, s[12:15], s52 offen lds
  v_mfma_f32_16x16x32_bf16 v[216:219], v[192:195], v[192:195], v[216:219]
  s_waitcnt lgkmcnt(4)
  v_mfma_f32_16x16x32_bf16 v[120:123], v[88:91], v[192:195], v[120:123]
  ds_read_b64_tr_b16 v[76:77], v17 offset:2048
  v_mfma_f32_16x16x32_bf16 v[124:127], v[88:91], v[196:199], v[124:127]
  s_waitcnt lgkmcnt(3)
  ds_read_b64_tr_b16 v[78:79], v17 offset:3072
  s_add_u32 m0, s46, 79872
  s_add_u32 s52, s45, 591872
  buffer_load_dwordx4 v35, s[12:15], s52 offen lds
  v_mfma_f32_16x16x32_bf16 v[128:131], v[92:95], v[192:195], v[128:131]
  ds_read_b64_tr_b16 v[80:81], v18 offset:2048
  v_mfma_f32_16x16x32_bf16 v[132:135], v[92:95], v[196:199], v[132:135]
  ds_read_b64_tr_b16 v[82:83], v18 offset:3072
  v_mfma_f32_16x16x32_bf16 v[208:211], v[10:13], v[196:199], v[208:211]
  s_add_u32 m0, s46, 104448
  s_add_u32 s52, s97, 256
  buffer_load_dwordx4 v241, s[8:11], s52 offen lds
  v_mfma_f32_16x16x32_bf16 v[220:223], v[196:199], v[196:199], v[220:223]
  s_waitcnt lgkmcnt(4)
  v_mfma_f32_16x16x32_bf16 v[136:139], v[72:75], v[192:195], v[136:139]
  ds_read_b64_tr_b16 v[84:85], v19 offset:2048
  v_mfma_f32_16x16x32_bf16 v[140:143], v[72:75], v[196:199], v[140:143]
  s_waitcnt lgkmcnt(3)
  ds_read_b64_tr_b16 v[86:87], v19 offset:3072
  s_add_u32 m0, s82, 149504
  s_add_u32 s52, s83, 256
  buffer_load_dwordx4 v240, s[8:11], s52 offen lds
  v_mfma_f32_16x16x32_bf16 v[144:147], v[76:79], v[192:195], v[144:147]
  s_waitcnt vmcnt(11)
  ds_read_b64 v[180:181], v242 offset:16384
  ds_read_b64 v[182:183], v243 offset:16384
  v_mfma_f32_16x16x32_bf16 v[148:151], v[76:79], v[196:199], v[148:151]
  ds_read_b64 v[184:185], v242 offset:17408
  ds_read_b64 v[186:187], v243 offset:17408
  s_add_u32 m0, s82, 150528
  s_add_u32 s52, s84, 256
  buffer_load_dwordx4 v240, s[8:11], s52 offen lds
  v_mfma_f32_16x16x32_bf16 v[212:215], v[10:13], v[200:203], v[212:215]
  ds_read_b64 v[188:189], v244 offset:2048
  ds_read_b64 v[190:191], v245 offset:2048
  v_mfma_f32_16x16x32_bf16 v[224:227], v[200:203], v[200:203], v[224:227]
  s_waitcnt lgkmcnt(8)
  ds_read_b64_tr_b16 v[88:89], v14 offset:4096
  ds_read_b64_tr_b16 v[90:91], v14 offset:5120
  v_mfma_f32_16x16x32_bf16 v[152:155], v[80:83], v[200:203], v[152:155]
  ds_read_b64_tr_b16 v[92:93], v15 offset:4096
  s_lshr_b32 s55, s100, 13
  s_mul_i32 s55, s55, 3072
  s_add_u32 s55, s55, 1179648
  s_mov_b32 exec_lo, 0xffffff
  s_mov_b32 exec_hi, 0x0
  buffer_load_dword v102, v45, s[12:15], s55 offen
  s_mov_b64 exec, -1
  v_mfma_f32_16x16x32_bf16 v[156:159], v[80:83], v[10:13], v[156:159]
  s_waitcnt lgkmcnt(9)
  ds_read_b64_tr_b16 v[94:95], v15 offset:5120
  v_mfma_f32_16x16x32_bf16 v[160:163], v[84:87], v[10:13], v[160:163]
  s_waitcnt lgkmcnt(2)
  ds_read_b64_tr_b16 v[72:73], v14 offset:36864
  ds_read_b64_tr_b16 v[74:75], v14 offset:37888
  v_mfma_f32_16x16x32_bf16 v[104:107], v[88:91], v[180:183], v[104:107]
  ds_read_b64_tr_b16 v[76:77], v15 offset:36864
  s_add_u32 m0, s82, 116736
  s_add_u32 s52, s83, 320
  buffer_load_dwordx4 v240, s[8:11], s52 offen lds
  v_mfma_f32_16x16x32_bf16 v[108:111], v[88:91], v[184:187], v[108:111]
  s_waitcnt lgkmcnt(3)
  ds_read_b64_tr_b16 v[78:79], v15 offset:37888
  v_mfma_f32_16x16x32_bf16 v[112:115], v[92:95], v[180:183], v[112:115]
  ds_read_b64_tr_b16 v[80:81], v16 offset:4096
  s_add_u32 m0, s82, 117760
  s_add_u32 s52, s84, 320
  buffer_load_dwordx4 v240, s[8:11], s52 offen lds
  v_mfma_f32_16x16x32_bf16 v[116:119], v[92:95], v[184:187], v[116:119]
  ds_read_b64_tr_b16 v[82:83], v16 offset:5120
  s_add_u32 m0, s82, 133120
  s_add_u32 s52, s83, 448
  buffer_load_dwordx4 v240, s[8:11], s52 offen lds
  v_mfma_f32_16x16x32_bf16 v[204:207], v[10:13], v[180:183], v[204:207]
  s_add_u32 m0, s82, 124928
  s_add_u32 s52, s83, 384
  buffer_load_dwordx4 v240, s[8:11], s52 offen lds
  v_mfma_f32_16x16x32_bf16 v[216:219], v[180:183], v[180:183], v[216:219]
  s_waitcnt lgkmcnt(4)
  s_add_u32 m0, s82, 134144
  s_add_u32 s52, s84, 448
  buffer_load_dwordx4 v240, s[8:11], s52 offen lds
  v_mfma_f32_16x16x32_bf16 v[120:123], v[72:75], v[180:183], v[120:123]
  ds_read_b64_tr_b16 v[84:85], v17 offset:4096
  s_add_u32 m0, s82, 125952
  s_add_u32 s52, s84, 384
  buffer_load_dwordx4 v240, s[8:11], s52 offen lds
  v_mfma_f32_16x16x32_bf16 v[124:127], v[72:75], v[184:187], v[124:127]
  s_waitcnt lgkmcnt(3)
  ds_read_b64_tr_b16 v[86:87], v17 offset:5120
  v_mfma_f32_16x16x32_bf16 v[128:131], v[76:79], v[180:183], v[128:131]
  ds_read_b64_tr_b16 v[88:89], v18 offset:4096
  v_mfma_f32_16x16x32_bf16 v[132:135], v[76:79], v[184:187], v[132:135]
  ds_read_b64_tr_b16 v[90:91], v18 offset:5120
  v_mfma_f32_16x16x32_bf16 v[208:211], v[10:13], v[184:187], v[208:211]
  v_mfma_f32_16x16x32_bf16 v[220:223], v[184:187], v[184:187], v[220:223]
  s_waitcnt lgkmcnt(4)
  v_mfma_f32_16x16x32_bf16 v[136:139], v[80:83], v[180:183], v[136:139]
  ds_read_b64_tr_b16 v[92:93], v19 offset:4096
  v_mfma_f32_16x16x32_bf16 v[140:143], v[80:83], v[184:187], v[140:143]
  s_waitcnt lgkmcnt(3)
  ds_read_b64_tr_b16 v[94:95], v19 offset:5120
  v_mfma_f32_16x16x32_bf16 v[144:147], v[84:87], v[180:183], v[144:147]
  s_waitcnt vmcnt(14)
  ds_read_b64 v[192:193], v242 offset:24576
  ds_read_b64 v[194:195], v243 offset:24576
  v_mfma_f32_16x16x32_bf16 v[148:151], v[84:87], v[184:187], v[148:151]
  ds_read_b64 v[196:197], v242 offset:25600
  ds_read_b64 v[198:199], v243 offset:25600
  v_mfma_f32_16x16x32_bf16 v[212:215], v[10:13], v[188:191], v[212:215]
  ds_read_b64 v[200:201], v244 offset:3072
  ds_read_b64 v[202:203], v245 offset:3072
  v_mfma_f32_16x16x32_bf16 v[224:227], v[188:191], v[188:191], v[224:227]
  s_waitcnt lgkmcnt(8)
  ds_read_b64_tr_b16 v[72:73], v14 offset:6144
  ds_read_b64_tr_b16 v[74:75], v14 offset:7168
  v_mfma_f32_16x16x32_bf16 v[152:155], v[88:91], v[188:191], v[152:155]
  ds_read_b64_tr_b16 v[76:77], v15 offset:6144
  v_mfma_f32_16x16x32_bf16 v[156:159], v[88:91], v[10:13], v[156:159]
  s_waitcnt lgkmcnt(9)
  ds_read_b64_tr_b16 v[78:79], v15 offset:7168
  v_mfma_f32_16x16x32_bf16 v[160:163], v[92:95], v[10:13], v[160:163]
  s_waitcnt lgkmcnt(2)
  ds_read_b64_tr_b16 v[80:81], v14 offset:38912
  ds_read_b64_tr_b16 v[82:83], v14 offset:39936
  v_mfma_f32_16x16x32_bf16 v[104:107], v[72:75], v[192:195], v[104:107]
  ds_read_b64_tr_b16 v[84:85], v15 offset:38912
  v_mfma_f32_16x16x32_bf16 v[108:111], v[72:75], v[196:199], v[108:111]
  s_waitcnt lgkmcnt(3)
  ds_read_b64_tr_b16 v[86:87], v15 offset:39936
  v_mfma_f32_16x16x32_bf16 v[112:115], v[76:79], v[192:195], v[112:115]
  ds_read_b64_tr_b16 v[88:89], v16 offset:6144
  s_add_u32 m0, s82, 141312
  s_add_u32 s52, s83, 512
  buffer_load_dwordx4 v240, s[8:11], s52 offen lds
  v_mfma_f32_16x16x32_bf16 v[116:119], v[76:79], v[196:199], v[116:119]
  ds_read_b64_tr_b16 v[90:91], v16 offset:7168
  v_mfma_f32_16x16x32_bf16 v[204:207], v[10:13], v[192:195], v[204:207]
  s_add_u32 m0, s82, 142336
  s_add_u32 s52, s84, 512
  buffer_load_dwordx4 v240, s[8:11], s52 offen lds
  v_mfma_f32_16x16x32_bf16 v[216:219], v[192:195], v[192:195], v[216:219]
  s_waitcnt lgkmcnt(4)
  v_mfma_f32_16x16x32_bf16 v[120:123], v[80:83], v[192:195], v[120:123]
  ds_read_b64_tr_b16 v[92:93], v17 offset:6144
  v_mfma_f32_16x16x32_bf16 v[124:127], v[80:83], v[196:199], v[124:127]
  s_waitcnt lgkmcnt(3)
  ds_read_b64_tr_b16 v[94:95], v17 offset:7168
  v_mfma_f32_16x16x32_bf16 v[128:131], v[84:87], v[192:195], v[128:131]
  ds_read_b64_tr_b16 v[72:73], v18 offset:6144
  s_add_u32 m0, s46, 18432
  s_add_u32 s52, s45, 786432
  buffer_load_dwordx4 v35, s[12:15], s52 offen lds
  v_mfma_f32_16x16x32_bf16 v[132:135], v[84:87], v[196:199], v[132:135]
  ds_read_b64_tr_b16 v[74:75], v18 offset:7168
  v_mfma_f32_16x16x32_bf16 v[208:211], v[10:13], v[196:199], v[208:211]
  v_mfma_f32_16x16x32_bf16 v[220:223], v[196:199], v[196:199], v[220:223]
  s_waitcnt lgkmcnt(4)
  v_mfma_f32_16x16x32_bf16 v[136:139], v[88:91], v[192:195], v[136:139]
  ds_read_b64_tr_b16 v[76:77], v19 offset:6144
  v_mfma_f32_16x16x32_bf16 v[140:143], v[88:91], v[196:199], v[140:143]
  s_waitcnt lgkmcnt(3)
  ds_read_b64_tr_b16 v[78:79], v19 offset:7168
  s_add_u32 m0, s46, 51200
  s_add_u32 s52, s45, 787456
  buffer_load_dwordx4 v35, s[12:15], s52 offen lds
  v_mfma_f32_16x16x32_bf16 v[144:147], v[92:95], v[192:195], v[144:147]
  s_waitcnt vmcnt(13)
  s_barrier
  s_waitcnt vmcnt(11)
  ds_read_b64 v[180:181], v242 offset:32768
  ds_read_b64 v[182:183], v243 offset:32768
  v_mfma_f32_16x16x32_bf16 v[148:151], v[92:95], v[196:199], v[148:151]
  ds_read_b64 v[184:185], v242 offset:33792
  ds_read_b64 v[186:187], v243 offset:33792
  v_mfma_f32_16x16x32_bf16 v[212:215], v[10:13], v[200:203], v[212:215]
  ds_read_b64 v[188:189], v244 offset:4096
  ds_read_b64 v[190:191], v245 offset:4096
  v_mfma_f32_16x16x32_bf16 v[224:227], v[200:203], v[200:203], v[224:227]
  s_waitcnt lgkmcnt(8)
  ds_read_b64_tr_b16 v[80:81], v14 offset:8192
  ds_read_b64_tr_b16 v[82:83], v14 offset:9216
  v_mfma_f32_16x16x32_bf16 v[152:155], v[72:75], v[200:203], v[152:155]
  ds_read_b64_tr_b16 v[84:85], v15 offset:8192
  v_mfma_f32_16x16x32_bf16 v[156:159], v[72:75], v[10:13], v[156:159]
  s_waitcnt lgkmcnt(9)
  ds_read_b64_tr_b16 v[86:87], v15 offset:9216
  v_mfma_f32_16x16x32_bf16 v[160:163], v[76:79], v[10:13], v[160:163]
  s_waitcnt lgkmcnt(2)
  ds_read_b64_tr_b16 v[88:89], v14 offset:40960
  ds_read_b64_tr_b16 v[90:91], v14 offset:41984
  v_mfma_f32_16x16x32_bf16 v[104:107], v[80:83], v[180:183], v[104:107]
  ds_read_b64_tr_b16 v[92:93], v15 offset:40960
  v_mfma_f32_16x16x32_bf16 v[108:111], v[80:83], v[184:187], v[108:111]
  s_waitcnt lgkmcnt(3)
  ds_read_b64_tr_b16 v[94:95], v15 offset:41984
  v_mfma_f32_16x16x32_bf16 v[112:115], v[84:87], v[180:183], v[112:115]
  ds_read_b64_tr_b16 v[72:73], v16 offset:8192
  s_add_u32 m0, s82, 149504
  s_add_u32 s52, s83, 576
  buffer_load_dwordx4 v240, s[8:11], s52 offen lds
  v_mfma_f32_16x16x32_bf16 v[116:119], v[84:87], v[184:187], v[116:119]
  ds_read_b64_tr_b16 v[74:75], v16 offset:9216
  s_mul_i32 s53, s44, s44
  s_lshl_b32 s53, s53, 13
  s_lshl_b32 s54, s44, 5
  s_add_u32 s53, s53, s54
  s_add_u32 s53, s53, 1
  v_mov_b32 v254, s53
  s_lshr_b32 s53, s4, 1
  s_lshl_b32 s53, s53, 5
  s_and_b32 s54, s4, 1
  s_lshl_b32 s54, s54, 2
  s_add_u32 s54, s53, s54
  v_mov_b32 v255, s54
  s_cmp_eq_u32 s6, 0
  s_cselect_b32 s53, 0, 0x40000000
  v_or_b32 v255, s53, v255
  s_mov_b64 exec, 1
  buffer_atomic_add v254, v255, s[36:39], 0 offen
  s_mov_b64 exec, -1
  v_mfma_f32_16x16x32_bf16 v[204:207], v[10:13], v[180:183], v[204:207]
  s_add_u32 m0, s82, 150528
  s_add_u32 s52, s84, 576
  buffer_load_dwordx4 v240, s[8:11], s52 offen lds
  v_mfma_f32_16x16x32_bf16 v[216:219], v[180:183], v[180:183], v[216:219]
  s_waitcnt lgkmcnt(4)
  v_mfma_f32_16x16x32_bf16 v[120:123], v[88:91], v[180:183], v[120:123]
  ds_read_b64_tr_b16 v[76:77], v17 offset:8192
  v_mfma_f32_16x16x32_bf16 v[124:127], v[88:91], v[184:187], v[124:127]
  s_waitcnt lgkmcnt(3)
  ds_read_b64_tr_b16 v[78:79], v17 offset:9216
  v_mfma_f32_16x16x32_bf16 v[128:131], v[92:95], v[180:183], v[128:131]
  ds_read_b64_tr_b16 v[80:81], v18 offset:8192
  s_add_u32 m0, s46, 83968
  s_add_u32 s52, s45, 788480
  buffer_load_dwordx4 v35, s[12:15], s52 offen lds
  v_mfma_f32_16x16x32_bf16 v[132:135], v[92:95], v[184:187], v[132:135]
  ds_read_b64_tr_b16 v[82:83], v18 offset:9216
  v_mfma_f32_16x16x32_bf16 v[208:211], v[10:13], v[184:187], v[208:211]
  v_mfma_f32_16x16x32_bf16 v[220:223], v[184:187], v[184:187], v[220:223]
  s_waitcnt lgkmcnt(4)
  v_mfma_f32_16x16x32_bf16 v[136:139], v[72:75], v[180:183], v[136:139]
  ds_read_b64_tr_b16 v[84:85], v19 offset:8192
  v_mfma_f32_16x16x32_bf16 v[140:143], v[72:75], v[184:187], v[140:143]
  s_waitcnt lgkmcnt(3)
  ds_read_b64_tr_b16 v[86:87], v19 offset:9216
  s_add_u32 m0, s46, 22528
  s_add_u32 s52, s45, 983040
  buffer_load_dwordx4 v35, s[12:15], s52 offen lds
  v_mfma_f32_16x16x32_bf16 v[144:147], v[76:79], v[180:183], v[144:147]
  s_waitcnt vmcnt(13)
  ds_read_b64 v[192:193], v242 offset:0
  ds_read_b64 v[194:195], v243 offset:0
  v_mfma_f32_16x16x32_bf16 v[148:151], v[76:79], v[184:187], v[148:151]
  ds_read_b64 v[196:197], v242 offset:1024
  ds_read_b64 v[198:199], v243 offset:1024
  v_mfma_f32_16x16x32_bf16 v[212:215], v[10:13], v[188:191], v[212:215]
  ds_read_b64 v[200:201], v244 offset:5120
  ds_read_b64 v[202:203], v245 offset:5120
  v_mfma_f32_16x16x32_bf16 v[224:227], v[188:191], v[188:191], v[224:227]
  s_waitcnt lgkmcnt(8)
  ds_read_b64_tr_b16 v[88:89], v14 offset:10240
  ds_read_b64_tr_b16 v[90:91], v14 offset:11264
  v_mfma_f32_16x16x32_bf16 v[152:155], v[80:83], v[188:191], v[152:155]
  ds_read_b64_tr_b16 v[92:93], v15 offset:10240
  v_mfma_f32_16x16x32_bf16 v[156:159], v[80:83], v[10:13], v[156:159]
  s_waitcnt lgkmcnt(9)
  ds_read_b64_tr_b16 v[94:95], v15 offset:11264
  v_mfma_f32_16x16x32_bf16 v[160:163], v[84:87], v[10:13], v[160:163]
  s_waitcnt lgkmcnt(2)
  ds_read_b64_tr_b16 v[72:73], v14 offset:43008
  ds_read_b64_tr_b16 v[74:75], v14 offset:44032
  v_mfma_f32_16x16x32_bf16 v[104:107], v[88:91], v[192:195], v[104:107]
  ds_read_b64_tr_b16 v[76:77], v15 offset:43008
  v_mfma_f32_16x16x32_bf16 v[108:111], v[88:91], v[196:199], v[108:111]
  s_waitcnt lgkmcnt(3)
  ds_read_b64_tr_b16 v[78:79], v15 offset:44032
  v_mfma_f32_16x16x32_bf16 v[112:115], v[92:95], v[192:195], v[112:115]
  ds_read_b64_tr_b16 v[80:81], v16 offset:10240
  s_add_u32 m0, s82, 116736
  s_add_u32 s52, s83, 640
  buffer_load_dwordx4 v240, s[8:11], s52 offen lds
  v_mfma_f32_16x16x32_bf16 v[116:119], v[92:95], v[196:199], v[116:119]
  ds_read_b64_tr_b16 v[82:83], v16 offset:11264
  v_mfma_f32_16x16x32_bf16 v[204:207], v[10:13], v[192:195], v[204:207]
  s_add_u32 m0, s82, 117760
  s_add_u32 s52, s84, 640
  buffer_load_dwordx4 v240, s[8:11], s52 offen lds
  v_mfma_f32_16x16x32_bf16 v[216:219], v[192:195], v[192:195], v[216:219]
  s_waitcnt lgkmcnt(4)
  v_mfma_f32_16x16x32_bf16 v[120:123], v[72:75], v[192:195], v[120:123]
  ds_read_b64_tr_b16 v[84:85], v17 offset:10240
  v_mfma_f32_16x16x32_bf16 v[124:127], v[72:75], v[196:199], v[124:127]
  s_waitcnt lgkmcnt(3)
  ds_read_b64_tr_b16 v[86:87], v17 offset:11264
  v_mfma_f32_16x16x32_bf16 v[128:131], v[76:79], v[192:195], v[128:131]
  ds_read_b64_tr_b16 v[88:89], v18 offset:10240
  s_add_u32 m0, s46, 55296
  s_add_u32 s52, s45, 984064
  buffer_load_dwordx4 v35, s[12:15], s52 offen lds
  v_mfma_f32_16x16x32_bf16 v[132:135], v[76:79], v[196:199], v[132:135]
  ds_read_b64_tr_b16 v[90:91], v18 offset:11264
  v_mfma_f32_16x16x32_bf16 v[208:211], v[10:13], v[196:199], v[208:211]
  v_mfma_f32_16x16x32_bf16 v[220:223], v[196:199], v[196:199], v[220:223]
  s_waitcnt lgkmcnt(4)
  v_mfma_f32_16x16x32_bf16 v[136:139], v[80:83], v[192:195], v[136:139]
  ds_read_b64_tr_b16 v[92:93], v19 offset:10240
  v_mfma_f32_16x16x32_bf16 v[140:143], v[80:83], v[196:199], v[140:143]
  s_waitcnt lgkmcnt(3)
  ds_read_b64_tr_b16 v[94:95], v19 offset:11264
  s_add_u32 m0, s46, 88064
  s_add_u32 s52, s45, 985088
  buffer_load_dwordx4 v35, s[12:15], s52 offen lds
  v_mfma_f32_16x16x32_bf16 v[144:147], v[84:87], v[192:195], v[144:147]
  s_waitcnt vmcnt(13)
  ds_read_b64 v[180:181], v242 offset:8192
  ds_read_b64 v[182:183], v243 offset:8192
  v_mfma_f32_16x16x32_bf16 v[148:151], v[84:87], v[196:199], v[148:151]
  ds_read_b64 v[184:185], v242 offset:9216
  ds_read_b64 v[186:187], v243 offset:9216
  v_mfma_f32_16x16x32_bf16 v[212:215], v[10:13], v[200:203], v[212:215]
  ds_read_b64 v[188:189], v244 offset:6144
  ds_read_b64 v[190:191], v245 offset:6144
  v_mfma_f32_16x16x32_bf16 v[224:227], v[200:203], v[200:203], v[224:227]
  s_waitcnt lgkmcnt(8)
  ds_read_b64_tr_b16 v[72:73], v14 offset:12288
  ds_read_b64_tr_b16 v[74:75], v14 offset:13312
  v_mfma_f32_16x16x32_bf16 v[152:155], v[88:91], v[200:203], v[152:155]
  ds_read_b64_tr_b16 v[76:77], v15 offset:12288
  v_mfma_f32_16x16x32_bf16 v[156:159], v[88:91], v[10:13], v[156:159]
  s_waitcnt lgkmcnt(9)
  ds_read_b64_tr_b16 v[78:79], v15 offset:13312
  v_mfma_f32_16x16x32_bf16 v[160:163], v[92:95], v[10:13], v[160:163]
  s_waitcnt lgkmcnt(2)
  ds_read_b64_tr_b16 v[80:81], v14 offset:45056
  ds_read_b64_tr_b16 v[82:83], v14 offset:46080
  v_mfma_f32_16x16x32_bf16 v[104:107], v[72:75], v[180:183], v[104:107]
  ds_read_b64_tr_b16 v[84:85], v15 offset:45056
  v_mfma_f32_16x16x32_bf16 v[108:111], v[72:75], v[184:187], v[108:111]
  s_waitcnt lgkmcnt(3)
  ds_read_b64_tr_b16 v[86:87], v15 offset:46080
  v_mfma_f32_16x16x32_bf16 v[112:115], v[76:79], v[180:183], v[112:115]
  ds_read_b64_tr_b16 v[88:89], v16 offset:12288
  s_add_u32 m0, s82, 124928
  s_add_u32 s52, s83, 704
  buffer_load_dwordx4 v240, s[8:11], s52 offen lds
  v_mfma_f32_16x16x32_bf16 v[116:119], v[76:79], v[184:187], v[116:119]
  ds_read_b64_tr_b16 v[90:91], v16 offset:13312
  v_mfma_f32_16x16x32_bf16 v[204:207], v[10:13], v[180:183], v[204:207]
  s_add_u32 m0, s82, 125952
  s_add_u32 s52, s84, 704
  buffer_load_dwordx4 v240, s[8:11], s52 offen lds
  v_mfma_f32_16x16x32_bf16 v[216:219], v[180:183], v[180:183], v[216:219]
  s_waitcnt lgkmcnt(4)
  v_mfma_f32_16x16x32_bf16 v[120:123], v[80:83], v[180:183], v[120:123]
  ds_read_b64_tr_b16 v[92:93], v17 offset:12288
  v_mfma_f32_16x16x32_bf16 v[124:127], v[80:83], v[184:187], v[124:127]
  s_waitcnt lgkmcnt(3)
  ds_read_b64_tr_b16 v[94:95], v17 offset:13312
  v_mfma_f32_16x16x32_bf16 v[128:131], v[84:87], v[180:183], v[128:131]
  ds_read_b64_tr_b16 v[72:73], v18 offset:12288
  s_add_u32 m0, s46, 108544
  s_add_u32 s52, s97, 512
  buffer_load_dwordx4 v241, s[8:11], s52 offen lds
  v_mfma_f32_16x16x32_bf16 v[132:135], v[84:87], v[184:187], v[132:135]
  ds_read_b64_tr_b16 v[74:75], v18 offset:13312
  v_mfma_f32_16x16x32_bf16 v[208:211], v[10:13], v[184:187], v[208:211]
  v_mfma_f32_16x16x32_bf16 v[220:223], v[184:187], v[184:187], v[220:223]
  s_waitcnt lgkmcnt(4)
  v_mfma_f32_16x16x32_bf16 v[136:139], v[88:91], v[180:183], v[136:139]
  ds_read_b64_tr_b16 v[76:77], v19 offset:12288
  v_mfma_f32_16x16x32_bf16 v[140:143], v[88:91], v[184:187], v[140:143]
  s_waitcnt lgkmcnt(3)
  ds_read_b64_tr_b16 v[78:79], v19 offset:13312
  v_mfma_f32_16x16x32_bf16 v[144:147], v[92:95], v[180:183], v[144:147]
  ds_read_b64 v[192:193], v242 offset:16384
  ds_read_b64 v[194:195], v243 offset:16384
  v_mfma_f32_16x16x32_bf16 v[148:151], v[92:95], v[184:187], v[148:151]
  ds_read_b64 v[196:197], v242 offset:17408
  ds_read_b64 v[198:199], v243 offset:17408
  v_mfma_f32_16x16x32_bf16 v[212:215], v[10:13], v[188:191], v[212:215]
  ds_read_b64 v[200:201], v244 offset:7168
  ds_read_b64 v[202:203], v245 offset:7168
  v_mfma_f32_16x16x32_bf16 v[224:227], v[188:191], v[188:191], v[224:227]
  s_waitcnt lgkmcnt(8)
  ds_read_b64_tr_b16 v[80:81], v14 offset:14336
  ds_read_b64_tr_b16 v[82:83], v14 offset:15360
  v_mfma_f32_16x16x32_bf16 v[152:155], v[72:75], v[188:191], v[152:155]
  ds_read_b64_tr_b16 v[84:85], v15 offset:14336
  v_mfma_f32_16x16x32_bf16 v[156:159], v[72:75], v[10:13], v[156:159]
  s_waitcnt lgkmcnt(9)
  ds_read_b64_tr_b16 v[86:87], v15 offset:15360
  v_mfma_f32_16x16x32_bf16 v[160:163], v[76:79], v[10:13], v[160:163]
  s_waitcnt lgkmcnt(2)
  ds_read_b64_tr_b16 v[88:89], v14 offset:47104
  ds_read_b64_tr_b16 v[90:91], v14 offset:48128
  v_mfma_f32_16x16x32_bf16 v[104:107], v[80:83], v[192:195], v[104:107]
  ds_read_b64_tr_b16 v[92:93], v15 offset:47104
  v_mfma_f32_16x16x32_bf16 v[108:111], v[80:83], v[196:199], v[108:111]
  s_waitcnt lgkmcnt(3)
  ds_read_b64_tr_b16 v[94:95], v15 offset:48128
  v_mfma_f32_16x16x32_bf16 v[112:115], v[84:87], v[192:195], v[112:115]
  ds_read_b64_tr_b16 v[72:73], v16 offset:14336
  s_add_u32 m0, s82, 133120
  s_add_u32 s52, s83, 768
  buffer_load_dwordx4 v240, s[8:11], s52 offen lds
  v_mfma_f32_16x16x32_bf16 v[116:119], v[84:87], v[196:199], v[116:119]
  ds_read_b64_tr_b16 v[74:75], v16 offset:15360
  v_mfma_f32_16x16x32_bf16 v[204:207], v[10:13], v[192:195], v[204:207]
  s_add_u32 m0, s82, 134144
  s_add_u32 s52, s84, 768
  buffer_load_dwordx4 v240, s[8:11], s52 offen lds
  v_mfma_f32_16x16x32_bf16 v[216:219], v[192:195], v[192:195], v[216:219]
  s_waitcnt lgkmcnt(4)
  v_mfma_f32_16x16x32_bf16 v[120:123], v[88:91], v[192:195], v[120:123]
  ds_read_b64_tr_b16 v[76:77], v17 offset:14336
  v_mfma_f32_16x16x32_bf16 v[124:127], v[88:91], v[196:199], v[124:127]
  s_waitcnt lgkmcnt(3)
  ds_read_b64_tr_b16 v[78:79], v17 offset:15360
  v_mfma_f32_16x16x32_bf16 v[128:131], v[92:95], v[192:195], v[128:131]
  ds_read_b64_tr_b16 v[80:81], v18 offset:14336
  s_add_u32 m0, s46, 26624
  s_add_u32 s52, s45, 1179648
  buffer_load_dwordx4 v35, s[12:15], s52 offen lds
  v_mfma_f32_16x16x32_bf16 v[132:135], v[92:95], v[196:199], v[132:135]
  ds_read_b64_tr_b16 v[82:83], v18 offset:15360
  v_mfma_f32_16x16x32_bf16 v[208:211], v[10:13], v[196:199], v[208:211]
  v_mfma_f32_16x16x32_bf16 v[220:223], v[196:199], v[196:199], v[220:223]
  s_waitcnt lgkmcnt(4)
  v_mfma_f32_16x16x32_bf16 v[136:139], v[72:75], v[192:195], v[136:139]
  ds_read_b64_tr_b16 v[84:85], v19 offset:14336
  v_mfma_f32_16x16x32_bf16 v[140:143], v[72:75], v[196:199], v[140:143]
  s_waitcnt lgkmcnt(3)
  ds_read_b64_tr_b16 v[86:87], v19 offset:15360
  s_add_u32 m0, s46, 59392
  s_add_u32 s52, s45, 1180672
  buffer_load_dwordx4 v35, s[12:15], s52 offen lds
  v_mfma_f32_16x16x32_bf16 v[144:147], v[76:79], v[192:195], v[144:147]
  s_waitcnt vmcnt(4)
  s_barrier
  ds_read_b64 v[180:181], v242 offset:24576
  ds_read_b64 v[182:183], v243 offset:24576
  v_mfma_f32_16x16x32_bf16 v[148:151], v[76:79], v[196:199], v[148:151]
  ds_read_b64 v[184:185], v242 offset:25600
  ds_read_b64 v[186:187], v243 offset:25600
  v_mfma_f32_16x16x32_bf16 v[212:215], v[10:13], v[200:203], v[212:215]
  ds_read_b64 v[188:189], v244 offset:8192
  ds_read_b64 v[190:191], v245 offset:8192
  v_mfma_f32_16x16x32_bf16 v[224:227], v[200:203], v[200:203], v[224:227]
  s_waitcnt lgkmcnt(8)
  ds_read_b64_tr_b16 v[88:89], v14 offset:16384
  ds_read_b64_tr_b16 v[90:91], v14 offset:17408
  v_mfma_f32_16x16x32_bf16 v[152:155], v[80:83], v[200:203], v[152:155]
  ds_read_b64_tr_b16 v[92:93], v15 offset:16384
  v_mfma_f32_16x16x32_bf16 v[156:159], v[80:83], v[10:13], v[156:159]
  s_waitcnt lgkmcnt(9)
  ds_read_b64_tr_b16 v[94:95], v15 offset:17408
  v_mfma_f32_16x16x32_bf16 v[160:163], v[84:87], v[10:13], v[160:163]
  s_waitcnt lgkmcnt(2)
  ds_read_b64_tr_b16 v[72:73], v14 offset:49152
  ds_read_b64_tr_b16 v[74:75], v14 offset:50176
  v_mfma_f32_16x16x32_bf16 v[104:107], v[88:91], v[180:183], v[104:107]
  ds_read_b64_tr_b16 v[76:77], v15 offset:49152
  v_mfma_f32_16x16x32_bf16 v[108:111], v[88:91], v[184:187], v[108:111]
  s_waitcnt lgkmcnt(3)
  ds_read_b64_tr_b16 v[78:79], v15 offset:50176
  v_mfma_f32_16x16x32_bf16 v[112:115], v[92:95], v[180:183], v[112:115]
  ds_read_b64_tr_b16 v[80:81], v16 offset:16384
  s_add_u32 m0, s82, 141312
  s_add_u32 s52, s83, 832
  buffer_load_dwordx4 v240, s[8:11], s52 offen lds
  v_mfma_f32_16x16x32_bf16 v[116:119], v[92:95], v[184:187], v[116:119]
  ds_read_b64_tr_b16 v[82:83], v16 offset:17408
  v_mfma_f32_16x16x32_bf16 v[204:207], v[10:13], v[180:183], v[204:207]
  s_add_u32 m0, s82, 142336
  s_add_u32 s52, s84, 832
  buffer_load_dwordx4 v240, s[8:11], s52 offen lds
  v_mfma_f32_16x16x32_bf16 v[216:219], v[180:183], v[180:183], v[216:219]
  s_waitcnt lgkmcnt(4)
  v_mfma_f32_16x16x32_bf16 v[120:123], v[72:75], v[180:183], v[120:123]
  ds_read_b64_tr_b16 v[84:85], v17 offset:16384
  v_mfma_f32_16x16x32_bf16 v[124:127], v[72:75], v[184:187], v[124:127]
  s_waitcnt lgkmcnt(3)
  ds_read_b64_tr_b16 v[86:87], v17 offset:17408
  v_mfma_f32_16x16x32_bf16 v[128:131], v[76:79], v[180:183], v[128:131]
  ds_read_b64_tr_b16 v[88:89], v18 offset:16384
  s_add_u32 m0, s46, 92160
  s_add_u32 s52, s45, 1181696
  buffer_load_dwordx4 v35, s[12:15], s52 offen lds
  v_mfma_f32_16x16x32_bf16 v[132:135], v[76:79], v[184:187], v[132:135]
  ds_read_b64_tr_b16 v[90:91], v18 offset:17408
  s_lshr_b32 s53, s4, 1
  s_lshl_b32 s53, s53, 5
  s_and_b32 s54, s4, 1
  s_lshl_b32 s54, s54, 2
  s_add_u32 s79, s53, s54
  v_mov_b32 v255, 0
  buffer_load_dword v254, v255, s[36:39], s79 offen sc1
  v_mfma_f32_16x16x32_bf16 v[208:211], v[10:13], v[184:187], v[208:211]
  v_mfma_f32_16x16x32_bf16 v[220:223], v[184:187], v[184:187], v[220:223]
  s_waitcnt lgkmcnt(4)
  v_mfma_f32_16x16x32_bf16 v[136:139], v[80:83], v[180:183], v[136:139]
  ds_read_b64_tr_b16 v[92:93], v19 offset:16384
  v_mfma_f32_16x16x32_bf16 v[140:143], v[80:83], v[184:187], v[140:143]
  s_waitcnt lgkmcnt(3)
  ds_read_b64_tr_b16 v[94:95], v19 offset:17408
  s_add_u32 m0, s46, 30720
  s_add_u32 s52, s45, 1376256
  buffer_load_dwordx4 v35, s[12:15], s52 offen lds
  v_mfma_f32_16x16x32_bf16 v[144:147], v[84:87], v[180:183], v[144:147]
  ds_read_b64 v[192:193], v242 offset:32768
  ds_read_b64 v[194:195], v243 offset:32768
  v_mfma_f32_16x16x32_bf16 v[148:151], v[84:87], v[184:187], v[148:151]
  ds_read_b64 v[196:197], v242 offset:33792
  ds_read_b64 v[198:199], v243 offset:33792
  v_mfma_f32_16x16x32_bf16 v[212:215], v[10:13], v[188:191], v[212:215]
  ds_read_b64 v[200:201], v244 offset:9216
  ds_read_b64 v[202:203], v245 offset:9216
  v_mfma_f32_16x16x32_bf16 v[224:227], v[188:191], v[188:191], v[224:227]
  s_waitcnt lgkmcnt(8)
  ds_read_b64_tr_b16 v[72:73], v14 offset:18432
  ds_read_b64_tr_b16 v[74:75], v14 offset:19456
  v_mfma_f32_16x16x32_bf16 v[152:155], v[88:91], v[188:191], v[152:155]
  ds_read_b64_tr_b16 v[76:77], v15 offset:18432
  v_mfma_f32_16x16x32_bf16 v[156:159], v[88:91], v[10:13], v[156:159]
  s_waitcnt lgkmcnt(9)
  ds_read_b64_tr_b16 v[78:79], v15 offset:19456
  v_mfma_f32_16x16x32_bf16 v[160:163], v[92:95], v[10:13], v[160:163]
  s_waitcnt lgkmcnt(2)
  ds_read_b64_tr_b16 v[80:81], v14 offset:51200
  ds_read_b64_tr_b16 v[82:83], v14 offset:52224
  v_mfma_f32_16x16x32_bf16 v[104:107], v[72:75], v[192:195], v[104:107]
  ds_read_b64_tr_b16 v[84:85], v15 offset:51200
  v_mfma_f32_16x16x32_bf16 v[108:111], v[72:75], v[196:199], v[108:111]
  s_waitcnt lgkmcnt(3)
  ds_read_b64_tr_b16 v[86:87], v15 offset:52224
  v_mfma_f32_16x16x32_bf16 v[112:115], v[76:79], v[192:195], v[112:115]
  ds_read_b64_tr_b16 v[88:89], v16 offset:18432
  s_add_u32 m0, s82, 149504
  s_add_u32 s52, s83, 896
  buffer_load_dwordx4 v240, s[8:11], s52 offen lds
  v_mfma_f32_16x16x32_bf16 v[116:119], v[76:79], v[196:199], v[116:119]
  ds_read_b64_tr_b16 v[90:91], v16 offset:19456
  v_mfma_f32_16x16x32_bf16 v[204:207], v[10:13], v[192:195], v[204:207]
  s_add_u32 m0, s82, 150528
  s_add_u32 s52, s84, 896
  buffer_load_dwordx4 v240, s[8:11], s52 offen lds
  v_mfma_f32_16x16x32_bf16 v[216:219], v[192:195], v[192:195], v[216:219]
  s_waitcnt lgkmcnt(4)
  v_mfma_f32_16x16x32_bf16 v[120:123], v[80:83], v[192:195], v[120:123]
  ds_read_b64_tr_b16 v[92:93], v17 offset:18432
  v_mfma_f32_16x16x32_bf16 v[124:127], v[80:83], v[196:199], v[124:127]
  s_waitcnt lgkmcnt(3)
  ds_read_b64_tr_b16 v[94:95], v17 offset:19456
  v_mfma_f32_16x16x32_bf16 v[128:131], v[84:87], v[192:195], v[128:131]
  ds_read_b64_tr_b16 v[72:73], v18 offset:18432
  s_add_u32 m0, s46, 63488
  s_add_u32 s52, s45, 1377280
  buffer_load_dwordx4 v35, s[12:15], s52 offen lds
  v_mfma_f32_16x16x32_bf16 v[132:135], v[84:87], v[196:199], v[132:135]
  ds_read_b64_tr_b16 v[74:75], v18 offset:19456
  buffer_load_dwordx2 v[2:3], v236, s[8:11], s61 offen offset:0
  v_mfma_f32_16x16x32_bf16 v[208:211], v[10:13], v[196:199], v[208:211]
  v_mfma_f32_16x16x32_bf16 v[220:223], v[196:199], v[196:199], v[220:223]
  s_waitcnt lgkmcnt(4)
  v_mfma_f32_16x16x32_bf16 v[136:139], v[88:91], v[192:195], v[136:139]
  ds_read_b64_tr_b16 v[76:77], v19 offset:18432
  buffer_load_dwordx2 v[4:5], v236, s[8:11], s61 offen offset:32
  v_mfma_f32_16x16x32_bf16 v[140:143], v[88:91], v[196:199], v[140:143]
  s_waitcnt lgkmcnt(3)
  ds_read_b64_tr_b16 v[78:79], v19 offset:19456
  s_add_u32 m0, s46, 96256
  s_add_u32 s52, s45, 1378304
  buffer_load_dwordx4 v35, s[12:15], s52 offen lds
  v_mfma_f32_16x16x32_bf16 v[144:147], v[92:95], v[192:195], v[144:147]
  ds_read_b64 v[180:181], v242 offset:0
  ds_read_b64 v[182:183], v243 offset:0
  v_mfma_f32_16x16x32_bf16 v[148:151], v[92:95], v[196:199], v[148:151]
  ds_read_b64 v[184:185], v242 offset:1024
  ds_read_b64 v[186:187], v243 offset:1024
  s_mov_b32 s55, 0
  s_add_u32 s55, s55, s61
  buffer_load_dwordx2 v[6:7], v236, s[8:11], s55 offen offset:64
  v_mfma_f32_16x16x32_bf16 v[212:215], v[10:13], v[200:203], v[212:215]
  ds_read_b64 v[188:189], v244 offset:10240
  ds_read_b64 v[190:191], v245 offset:10240
  v_mfma_f32_16x16x32_bf16 v[224:227], v[200:203], v[200:203], v[224:227]
  s_waitcnt lgkmcnt(8)
  ds_read_b64_tr_b16 v[80:81], v14 offset:20480
  ds_read_b64_tr_b16 v[82:83], v14 offset:21504
  v_mfma_f32_16x16x32_bf16 v[152:155], v[72:75], v[200:203], v[152:155]
  ds_read_b64_tr_b16 v[84:85], v15 offset:20480
  s_mov_b32 s55, 0
  s_add_u32 s55, s55, s61
  buffer_load_dwordx2 v[8:9], v236, s[8:11], s55 offen offset:96
  v_mfma_f32_16x16x32_bf16 v[156:159], v[72:75], v[10:13], v[156:159]
  s_waitcnt lgkmcnt(9)
  ds_read_b64_tr_b16 v[86:87], v15 offset:21504
  v_mfma_f32_16x16x32_bf16 v[160:163], v[76:79], v[10:13], v[160:163]
  s_waitcnt lgkmcnt(2)
  ds_read_b64_tr_b16 v[88:89], v14 offset:53248
  ds_read_b64_tr_b16 v[90:91], v14 offset:54272
  v_mfma_f32_16x16x32_bf16 v[104:107], v[80:83], v[180:183], v[104:107]
  ds_read_b64_tr_b16 v[92:93], v15 offset:53248
  v_mfma_f32_16x16x32_bf16 v[108:111], v[80:83], v[184:187], v[108:111]
  s_waitcnt lgkmcnt(3)
  ds_read_b64_tr_b16 v[94:95], v15 offset:54272
  v_mfma_f32_16x16x32_bf16 v[112:115], v[84:87], v[180:183], v[112:115]
  ds_read_b64_tr_b16 v[72:73], v16 offset:20480
  s_add_u32 m0, s82, 116736
  s_add_u32 s52, s83, 960
  buffer_load_dwordx4 v240, s[8:11], s52 offen lds
  v_mfma_f32_16x16x32_bf16 v[116:119], v[84:87], v[184:187], v[116:119]
  ds_read_b64_tr_b16 v[74:75], v16 offset:21504
  v_mfma_f32_16x16x32_bf16 v[204:207], v[10:13], v[180:183], v[204:207]
  s_add_u32 m0, s82, 117760
  s_add_u32 s52, s84, 960
  buffer_load_dwordx4 v240, s[8:11], s52 offen lds
  v_mfma_f32_16x16x32_bf16 v[216:219], v[180:183], v[180:183], v[216:219]
  s_waitcnt lgkmcnt(4)
  v_mfma_f32_16x16x32_bf16 v[120:123], v[88:91], v[180:183], v[120:123]
  ds_read_b64_tr_b16 v[76:77], v17 offset:20480
  v_mfma_f32_16x16x32_bf16 v[124:127], v[88:91], v[184:187], v[124:127]
  s_waitcnt lgkmcnt(3)
  ds_read_b64_tr_b16 v[78:79], v17 offset:21504
  v_mfma_f32_16x16x32_bf16 v[128:131], v[92:95], v[180:183], v[128:131]
  ds_read_b64_tr_b16 v[80:81], v18 offset:20480
  s_add_u32 m0, s46, 112640
  s_add_u32 s52, s97, 768
  buffer_load_dwordx4 v241, s[8:11], s52 offen lds
  v_mfma_f32_16x16x32_bf16 v[132:135], v[92:95], v[184:187], v[132:135]
  ds_read_b64_tr_b16 v[82:83], v18 offset:21504
  v_lshlrev_b32 v237, 2, v0
  s_mul_i32 s80, s5, 224
  buffer_load_dword v247, v237, s[40:43], s80 offen
  v_mfma_f32_16x16x32_bf16 v[208:211], v[10:13], v[184:187], v[208:211]
  v_mfma_f32_16x16x32_bf16 v[220:223], v[184:187], v[184:187], v[220:223]
  s_waitcnt lgkmcnt(4)
  v_mfma_f32_16x16x32_bf16 v[136:139], v[72:75], v[180:183], v[136:139]
  ds_read_b64_tr_b16 v[84:85], v19 offset:20480
  v_mfma_f32_16x16x32_bf16 v[140:143], v[72:75], v[184:187], v[140:143]
  s_waitcnt lgkmcnt(3)
  ds_read_b64_tr_b16 v[86:87], v19 offset:21504
  v_mfma_f32_16x16x32_bf16 v[144:147], v[76:79], v[180:183], v[144:147]
  ds_read_b64 v[192:193], v242 offset:8192
  ds_read_b64 v[194:195], v243 offset:8192
  v_mfma_f32_16x16x32_bf16 v[148:151], v[76:79], v[184:187], v[148:151]
  ds_read_b64 v[196:197], v242 offset:9216
  ds_read_b64 v[198:199], v243 offset:9216
  v_mfma_f32_16x16x32_bf16 v[212:215], v[10:13], v[188:191], v[212:215]
  ds_read_b64 v[200:201], v244 offset:11264
  ds_read_b64 v[202:203], v245 offset:11264
  v_mfma_f32_16x16x32_bf16 v[224:227], v[188:191], v[188:191], v[224:227]
  s_waitcnt lgkmcnt(8)
  ds_read_b64_tr_b16 v[88:89], v14 offset:22528
  ds_read_b64_tr_b16 v[90:91], v14 offset:23552
  v_mfma_f32_16x16x32_bf16 v[152:155], v[80:83], v[188:191], v[152:155]
  ds_read_b64_tr_b16 v[92:93], v15 offset:22528
  v_mfma_f32_16x16x32_bf16 v[156:159], v[80:83], v[10:13], v[156:159]
  s_waitcnt lgkmcnt(9)
  ds_read_b64_tr_b16 v[94:95], v15 offset:23552
  v_mfma_f32_16x16x32_bf16 v[160:163], v[84:87], v[10:13], v[160:163]
  s_waitcnt lgkmcnt(2)
  ds_read_b64_tr_b16 v[72:73], v14 offset:55296
  ds_read_b64_tr_b16 v[74:75], v14 offset:56320
  v_mfma_f32_16x16x32_bf16 v[104:107], v[88:91], v[192:195], v[104:107]
  ds_read_b64_tr_b16 v[76:77], v15 offset:55296
  v_mfma_f32_16x16x32_bf16 v[108:111], v[88:91], v[196:199], v[108:111]
  s_waitcnt lgkmcnt(3)
  ds_read_b64_tr_b16 v[78:79], v15 offset:56320
  s_waitcnt vmcnt(13)
  s_mov_b32 s77, 0
  v_readfirstlane_b32 s54, v254
  s_nop 4
  s_and_b32 s52, s54, 31
  s_cmp_eq_u32 s52, 16
  s_cbranch_scc1 rok_2
rsp_1:
  buffer_load_dword v254, v255, s[36:39], s79 offen sc1
  s_add_u32 s77, s77, 1
  s_waitcnt vmcnt(0)
  v_readfirstlane_b32 s54, v254
  s_nop 4
  s_and_b32 s52, s54, 31
  s_cmp_eq_u32 s52, 16
  s_cbranch_scc1 rok_2
  s_cmp_lt_u32 s77, 0x100000
  s_cbranch_scc1 rsp_1
  s_endpgm
rok_2:
  s_lshr_b32 s52, s54, 5
  s_and_b32 s52, s52, 255
  s_mul_i32 s52, s52, s52
  s_lshr_b32 s54, s54, 13
  s_lshl_b32 s54, s54, 4
  s_cmp_lg_u32 s52, s54
  s_cselect_b32 s7, 1, 0
  s_mul_i32 s52, s4, 598016
  s_add_u32 s52, s52, 33554432
  s_mul_i32 s53, s4, 458752
  s_lshl_b32 s54, s4, 13
  s_cmp_eq_u32 s7, 0
  s_add_u32 s55, s52, 0
  s_add_u32 s94, s87, 8388608
  s_cmp_eq_u32 s7, 0
  s_cselect_b32 s94, s55, s94
  s_add_u32 s55, s52, 0
  s_add_u32 s95, s53, 16777216
  s_cmp_eq_u32 s7, 0
  s_cselect_b32 s95, s55, s95
  s_add_u32 s55, s52, 458752
  s_add_u32 s96, s87, 1048576
  s_cmp_eq_u32 s7, 0
  s_cselect_b32 s96, s55, s96
  s_add_u32 s55, s52, 458752
  s_add_u32 s98, s87, 3145728
  s_cmp_eq_u32 s7, 0
  s_cselect_b32 s98, s55, s98
  s_add_u32 s55, s52, 589824
  s_add_u32 s97, s54, 65536
  s_cmp_eq_u32 s7, 0
  s_cselect_b32 s97, s55, s97
  s_add_u32 s55, s52, 589824
  s_add_u32 s99, s54, 196608
  s_cmp_eq_u32 s7, 0
  s_cselect_b32 s99, s55, s99
  s_cselect_b32 s83, 0, 2097152
  s_cselect_b32 s84, 0, 8388608
  s_cselect_b32 s85, 0, 4194304
  s_cselect_b32 s82, 0, 262144
  v_mfma_f32_16x16x32_bf16 v[112:115], v[92:95], v[192:195], v[112:115]
  ds_read_b64_tr_b16 v[80:81], v16 offset:22528
  v_mfma_f32_16x16x32_bf16 v[116:119], v[92:95], v[196:199], v[116:119]
  ds_read_b64_tr_b16 v[82:83], v16 offset:23552
  v_mfma_f32_16x16x32_bf16 v[204:207], v[10:13], v[192:195], v[204:207]
  s_lshl_b32 s54, s2, 2
  s_add_u32 s54, s54, s6
  s_sub_u32 s55, s54, 0
  s_cmp_lt_u32 s55, 224
  s_cselect_b32 s55, s55, 0x3ff80
  s_lshl_b32 s55, s55, 13
  buffer_load_dword v102, v45, s[20:23], s55 offen
  s_sub_u32 s55, s54, 256
  s_cmp_lt_u32 s55, 224
  s_cselect_b32 s55, s55, 0x3ff80
  s_lshl_b32 s55, s55, 13
  buffer_load_dword v102, v45, s[24:27], s55 offen
  s_sub_u32 s55, s54, 512
  s_cmp_lt_u32 s55, 64
  s_cselect_b32 s55, s55, 0x3ff80
  s_lshl_b32 s55, s55, 13
  buffer_load_dword v102, v45, s[16:19], s55 offen
  v_mfma_f32_16x16x32_bf16 v[216:219], v[192:195], v[192:195], v[216:219]
  s_waitcnt lgkmcnt(4)
  s_lshr_b32 s55, s101, 13
  s_mul_i32 s55, s55, 2048
  s_add_u32 s55, s55, s58
  s_add_u32 s55, s55, 33554432
  s_mov_b32 exec_lo, 0xffff
  s_mov_b32 exec_hi, 0x0
  buffer_load_dword v102, v45, s[28:31], s55 offen
  s_mov_b64 exec, -1
  v_mfma_f32_16x16x32_bf16 v[120:123], v[72:75], v[192:195], v[120:123]
  ds_read_b64_tr_b16 v[84:85], v17 offset:22528
  v_mfma_f32_16x16x32_bf16 v[124:127], v[72:75], v[196:199], v[124:127]
  s_waitcnt lgkmcnt(3)
  ds_read_b64_tr_b16 v[86:87], v17 offset:23552
  v_mfma_f32_16x16x32_bf16 v[128:131], v[76:79], v[192:195], v[128:131]
  ds_read_b64_tr_b16 v[88:89], v18 offset:22528
  v_mfma_f32_16x16x32_bf16 v[132:135], v[76:79], v[196:199], v[132:135]
  ds_read_b64_tr_b16 v[90:91], v18 offset:23552
  v_mfma_f32_16x16x32_bf16 v[208:211], v[10:13], v[196:199], v[208:211]
  v_mfma_f32_16x16x32_bf16 v[220:223], v[196:199], v[196:199], v[220:223]
  s_waitcnt lgkmcnt(4)
  v_mfma_f32_16x16x32_bf16 v[136:139], v[80:83], v[192:195], v[136:139]
  ds_read_b64_tr_b16 v[92:93], v19 offset:22528
  v_mfma_f32_16x16x32_bf16 v[140:143], v[80:83], v[196:199], v[140:143]
  s_waitcnt lgkmcnt(3)
  ds_read_b64_tr_b16 v[94:95], v19 offset:23552
  v_mfma_f32_16x16x32_bf16 v[144:147], v[84:87], v[192:195], v[144:147]
  s_waitcnt vmcnt(5)
  s_barrier
  ds_read_b64 v[180:181], v242 offset:16384
  ds_read_b64 v[182:183], v243 offset:16384
  v_mfma_f32_16x16x32_bf16 v[148:151], v[84:87], v[196:199], v[148:151]
  ds_read_b64 v[184:185], v242 offset:17408
  ds_read_b64 v[186:187], v243 offset:17408
  v_mfma_f32_16x16x32_bf16 v[212:215], v[10:13], v[200:203], v[212:215]
  ds_read_b64 v[188:189], v244 offset:12288
  ds_read_b64 v[190:191], v245 offset:12288
  v_mfma_f32_16x16x32_bf16 v[224:227], v[200:203], v[200:203], v[224:227]
  s_waitcnt lgkmcnt(8)
  ds_read_b64_tr_b16 v[72:73], v14 offset:24576
  ds_read_b64_tr_b16 v[74:75], v14 offset:25600
  v_mfma_f32_16x16x32_bf16 v[152:155], v[88:91], v[200:203], v[152:155]
  ds_read_b64_tr_b16 v[76:77], v15 offset:24576
  v_mfma_f32_16x16x32_bf16 v[156:159], v[88:91], v[10:13], v[156:159]
  s_waitcnt lgkmcnt(9)
  ds_read_b64_tr_b16 v[78:79], v15 offset:25600
  v_mfma_f32_16x16x32_bf16 v[160:163], v[92:95], v[10:13], v[160:163]
  s_waitcnt lgkmcnt(2)
  ds_read_b64_tr_b16 v[80:81], v14 offset:57344
  ds_read_b64_tr_b16 v[82:83], v14 offset:58368
  v_mfma_f32_16x16x32_bf16 v[104:107], v[72:75], v[180:183], v[104:107]
  ds_read_b64_tr_b16 v[84:85], v15 offset:57344
  v_mfma_f32_16x16x32_bf16 v[108:111], v[72:75], v[184:187], v[108:111]
  s_waitcnt lgkmcnt(3)
  ds_read_b64_tr_b16 v[86:87], v15 offset:58368
  v_mfma_f32_16x16x32_bf16 v[112:115], v[76:79], v[180:183], v[112:115]
  ds_read_b64_tr_b16 v[88:89], v16 offset:24576
  v_mfma_f32_16x16x32_bf16 v[116:119], v[76:79], v[184:187], v[116:119]
  ds_read_b64_tr_b16 v[90:91], v16 offset:25600
  v_mfma_f32_16x16x32_bf16 v[204:207], v[10:13], v[180:183], v[204:207]
  v_mfma_f32_16x16x32_bf16 v[216:219], v[180:183], v[180:183], v[216:219]
  s_waitcnt lgkmcnt(4)
  s_lshr_b32 s55, s101, 13
  s_mul_i32 s55, s55, 2176
  s_add_u32 s55, s55, s58
  s_add_u32 s55, s55, 34013184
  s_mov_b32 exec_lo, 0x1ffff
  s_mov_b32 exec_hi, 0x0
  buffer_load_dword v102, v45, s[28:31], s55 offen
  s_mov_b64 exec, -1
  v_mfma_f32_16x16x32_bf16 v[120:123], v[80:83], v[180:183], v[120:123]
  ds_read_b64_tr_b16 v[92:93], v17 offset:24576
  v_mfma_f32_16x16x32_bf16 v[124:127], v[80:83], v[184:187], v[124:127]
  s_waitcnt lgkmcnt(3)
  ds_read_b64_tr_b16 v[94:95], v17 offset:25600
  v_mfma_f32_16x16x32_bf16 v[128:131], v[84:87], v[180:183], v[128:131]
  ds_read_b64_tr_b16 v[72:73], v18 offset:24576
  v_mfma_f32_16x16x32_bf16 v[132:135], v[84:87], v[184:187], v[132:135]
  ds_read_b64_tr_b16 v[74:75], v18 offset:25600
  v_mfma_f32_16x16x32_bf16 v[208:211], v[10:13], v[184:187], v[208:211]
  v_mfma_f32_16x16x32_bf16 v[220:223], v[184:187], v[184:187], v[220:223]
  s_waitcnt lgkmcnt(4)
  v_mfma_f32_16x16x32_bf16 v[136:139], v[88:91], v[180:183], v[136:139]
  ds_read_b64_tr_b16 v[76:77], v19 offset:24576
  v_mfma_f32_16x16x32_bf16 v[140:143], v[88:91], v[184:187], v[140:143]
  s_waitcnt lgkmcnt(3)
  ds_read_b64_tr_b16 v[78:79], v19 offset:25600
  v_mfma_f32_16x16x32_bf16 v[144:147], v[92:95], v[180:183], v[144:147]
  ds_read_b64 v[192:193], v242 offset:24576
  ds_read_b64 v[194:195], v243 offset:24576
  v_mfma_f32_16x16x32_bf16 v[148:151], v[92:95], v[184:187], v[148:151]
  ds_read_b64 v[196:197], v242 offset:25600
  ds_read_b64 v[198:199], v243 offset:25600
  v_mfma_f32_16x16x32_bf16 v[212:215], v[10:13], v[188:191], v[212:215]
  ds_read_b64 v[200:201], v244 offset:13312
  ds_read_b64 v[202:203], v245 offset:13312
  v_mfma_f32_16x16x32_bf16 v[224:227], v[188:191], v[188:191], v[224:227]
  s_waitcnt lgkmcnt(8)
  ds_read_b64_tr_b16 v[80:81], v14 offset:26624
  ds_read_b64_tr_b16 v[82:83], v14 offset:27648
  v_mfma_f32_16x16x32_bf16 v[152:155], v[72:75], v[188:191], v[152:155]
  ds_read_b64_tr_b16 v[84:85], v15 offset:26624
  v_mfma_f32_16x16x32_bf16 v[156:159], v[72:75], v[10:13], v[156:159]
  s_waitcnt lgkmcnt(9)
  ds_read_b64_tr_b16 v[86:87], v15 offset:27648
  v_mfma_f32_16x16x32_bf16 v[160:163], v[76:79], v[10:13], v[160:163]
  s_waitcnt lgkmcnt(2)
  ds_read_b64_tr_b16 v[88:89], v14 offset:59392
  ds_read_b64_tr_b16 v[90:91], v14 offset:60416
  v_mfma_f32_16x16x32_bf16 v[104:107], v[80:83], v[192:195], v[104:107]
  ds_read_b64_tr_b16 v[92:93], v15 offset:59392
  v_mfma_f32_16x16x32_bf16 v[108:111], v[80:83], v[196:199], v[108:111]
  s_waitcnt lgkmcnt(3)
  ds_read_b64_tr_b16 v[94:95], v15 offset:60416
  v_mfma_f32_16x16x32_bf16 v[112:115], v[84:87], v[192:195], v[112:115]
  ds_read_b64_tr_b16 v[72:73], v16 offset:26624
  v_mfma_f32_16x16x32_bf16 v[116:119], v[84:87], v[196:199], v[116:119]
  ds_read_b64_tr_b16 v[74:75], v16 offset:27648
  v_mfma_f32_16x16x32_bf16 v[204:207], v[10:13], v[192:195], v[204:207]
  v_mfma_f32_16x16x32_bf16 v[216:219], v[192:195], v[192:195], v[216:219]
  s_waitcnt lgkmcnt(4)
  v_mfma_f32_16x16x32_bf16 v[120:123], v[88:91], v[192:195], v[120:123]
  ds_read_b64_tr_b16 v[76:77], v17 offset:26624
  v_mfma_f32_16x16x32_bf16 v[124:127], v[88:91], v[196:199], v[124:127]
  s_waitcnt lgkmcnt(3)
  ds_read_b64_tr_b16 v[78:79], v17 offset:27648
  v_mfma_f32_16x16x32_bf16 v[128:131], v[92:95], v[192:195], v[128:131]
  ds_read_b64_tr_b16 v[80:81], v18 offset:26624
  v_mfma_f32_16x16x32_bf16 v[132:135], v[92:95], v[196:199], v[132:135]
  ds_read_b64_tr_b16 v[82:83], v18 offset:27648
  v_mfma_f32_16x16x32_bf16 v[208:211], v[10:13], v[196:199], v[208:211]
  v_mfma_f32_16x16x32_bf16 v[220:223], v[196:199], v[196:199], v[220:223]
  s_waitcnt lgkmcnt(4)
  v_mfma_f32_16x16x32_bf16 v[136:139], v[72:75], v[192:195], v[136:139]
  ds_read_b64_tr_b16 v[84:85], v19 offset:26624
  v_mfma_f32_16x16x32_bf16 v[140:143], v[72:75], v[196:199], v[140:143]
  s_waitcnt lgkmcnt(3)
  ds_read_b64_tr_b16 v[86:87], v19 offset:27648
  v_mfma_f32_16x16x32_bf16 v[144:147], v[76:79], v[192:195], v[144:147]
  ds_read_b64 v[180:181], v242 offset:32768
  ds_read_b64 v[182:183], v243 offset:32768
  v_mfma_f32_16x16x32_bf16 v[148:151], v[76:79], v[196:199], v[148:151]
  ds_read_b64 v[184:185], v242 offset:33792
  ds_read_b64 v[186:187], v243 offset:33792
  v_mfma_f32_16x16x32_bf16 v[212:215], v[10:13], v[200:203], v[212:215]
  ds_read_b64 v[188:189], v244 offset:14336
  ds_read_b64 v[190:191], v245 offset:14336
  v_mfma_f32_16x16x32_bf16 v[224:227], v[200:203], v[200:203], v[224:227]
  s_waitcnt lgkmcnt(8)
  ds_read_b64_tr_b16 v[88:89], v14 offset:28672
  ds_read_b64_tr_b16 v[90:91], v14 offset:29696
  v_mfma_f32_16x16x32_bf16 v[152:155], v[80:83], v[200:203], v[152:155]
  ds_read_b64_tr_b16 v[92:93], v15 offset:28672
  v_mfma_f32_16x16x32_bf16 v[156:159], v[80:83], v[10:13], v[156:159]
  s_waitcnt lgkmcnt(9)
  ds_read_b64_tr_b16 v[94:95], v15 offset:29696
  v_mfma_f32_16x16x32_bf16 v[160:163], v[84:87], v[10:13], v[160:163]
  s_waitcnt lgkmcnt(2)
  ds_read_b64_tr_b16 v[72:73], v14 offset:61440
  ds_read_b64_tr_b16 v[74:75], v14 offset:62464
  v_mfma_f32_16x16x32_bf16 v[104:107], v[88:91], v[180:183], v[104:107]
  ds_read_b64_tr_b16 v[76:77], v15 offset:61440
  v_mfma_f32_16x16x32_bf16 v[108:111], v[88:91], v[184:187], v[108:111]
  s_waitcnt lgkmcnt(3)
  ds_read_b64_tr_b16 v[78:79], v15 offset:62464
  v_mfma_f32_16x16x32_bf16 v[112:115], v[92:95], v[180:183], v[112:115]
  ds_read_b64_tr_b16 v[80:81], v16 offset:28672
  v_mfma_f32_16x16x32_bf16 v[116:119], v[92:95], v[184:187], v[116:119]
  ds_read_b64_tr_b16 v[82:83], v16 offset:29696
  v_mfma_f32_16x16x32_bf16 v[204:207], v[10:13], v[180:183], v[204:207]
  v_mfma_f32_16x16x32_bf16 v[216:219], v[180:183], v[180:183], v[216:219]
  s_waitcnt lgkmcnt(4)
  v_mfma_f32_16x16x32_bf16 v[120:123], v[72:75], v[180:183], v[120:123]
  ds_read_b64_tr_b16 v[84:85], v17 offset:28672
  v_mfma_f32_16x16x32_bf16 v[124:127], v[72:75], v[184:187], v[124:127]
  s_waitcnt lgkmcnt(3)
  ds_read_b64_tr_b16 v[86:87], v17 offset:29696
  v_mfma_f32_16x16x32_bf16 v[128:131], v[76:79], v[180:183], v[128:131]
  ds_read_b64_tr_b16 v[88:89], v18 offset:28672
  v_mfma_f32_16x16x32_bf16 v[132:135], v[76:79], v[184:187], v[132:135]
  ds_read_b64_tr_b16 v[90:91], v18 offset:29696
  v_mfma_f32_16x16x32_bf16 v[208:211], v[10:13], v[184:187], v[208:211]
  v_mfma_f32_16x16x32_bf16 v[220:223], v[184:187], v[184:187], v[220:223]
  s_waitcnt lgkmcnt(4)
  v_mfma_f32_16x16x32_bf16 v[136:139], v[80:83], v[180:183], v[136:139]
  ds_read_b64_tr_b16 v[92:93], v19 offset:28672
  v_mfma_f32_16x16x32_bf16 v[140:143], v[80:83], v[184:187], v[140:143]
  s_waitcnt lgkmcnt(3)
  ds_read_b64_tr_b16 v[94:95], v19 offset:29696
  v_mfma_f32_16x16x32_bf16 v[144:147], v[84:87], v[180:183], v[144:147]
  ds_read_b64 v[192:193], v242 offset:0
  ds_read_b64 v[194:195], v243 offset:0
  v_mfma_f32_16x16x32_bf16 v[148:151], v[84:87], v[184:187], v[148:151]
  ds_read_b64 v[196:197], v242 offset:1024
  ds_read_b64 v[198:199], v243 offset:1024
  v_mfma_f32_16x16x32_bf16 v[212:215], v[10:13], v[188:191], v[212:215]
  ds_read_b64 v[200:201], v244 offset:15360
  ds_read_b64 v[202:203], v245 offset:15360
  v_mfma_f32_16x16x32_bf16 v[224:227], v[188:191], v[188:191], v[224:227]
  s_waitcnt lgkmcnt(8)
  ds_read_b64_tr_b16 v[72:73], v14 offset:30720
  ds_read_b64_tr_b16 v[74:75], v14 offset:31744
  v_mfma_f32_16x16x32_bf16 v[152:155], v[88:91], v[188:191], v[152:155]
  ds_read_b64_tr_b16 v[76:77], v15 offset:30720
  v_mfma_f32_16x16x32_bf16 v[156:159], v[88:91], v[10:13], v[156:159]
  s_waitcnt lgkmcnt(9)
  ds_read_b64_tr_b16 v[78:79], v15 offset:31744
  v_mfma_f32_16x16x32_bf16 v[160:163], v[92:95], v[10:13], v[160:163]
  s_waitcnt lgkmcnt(2)
  ds_read_b64_tr_b16 v[80:81], v14 offset:63488
  ds_read_b64_tr_b16 v[82:83], v14 offset:64512
  v_mfma_f32_16x16x32_bf16 v[104:107], v[72:75], v[192:195], v[104:107]
  ds_read_b64_tr_b16 v[84:85], v15 offset:63488
  v_mfma_f32_16x16x32_bf16 v[108:111], v[72:75], v[196:199], v[108:111]
  s_waitcnt lgkmcnt(3)
  ds_read_b64_tr_b16 v[86:87], v15 offset:64512
  v_mfma_f32_16x16x32_bf16 v[112:115], v[76:79], v[192:195], v[112:115]
  ds_read_b64_tr_b16 v[88:89], v16 offset:30720
  v_mfma_f32_16x16x32_bf16 v[116:119], v[76:79], v[196:199], v[116:119]
  ds_read_b64_tr_b16 v[90:91], v16 offset:31744
  v_mfma_f32_16x16x32_bf16 v[204:207], v[10:13], v[192:195], v[204:207]
  v_mfma_f32_16x16x32_bf16 v[216:219], v[192:195], v[192:195], v[216:219]
  s_waitcnt lgkmcnt(4)
  v_mfma_f32_16x16x32_bf16 v[120:123], v[80:83], v[192:195], v[120:123]
  ds_read_b64_tr_b16 v[92:93], v17 offset:30720
  v_mfma_f32_16x16x32_bf16 v[124:127], v[80:83], v[196:199], v[124:127]
  s_waitcnt lgkmcnt(3)
  ds_read_b64_tr_b16 v[94:95], v17 offset:31744
  v_mfma_f32_16x16x32_bf16 v[128:131], v[84:87], v[192:195], v[128:131]
  ds_read_b64_tr_b16 v[72:73], v18 offset:30720
  v_mfma_f32_16x16x32_bf16 v[132:135], v[84:87], v[196:199], v[132:135]
  ds_read_b64_tr_b16 v[74:75], v18 offset:31744
  v_mfma_f32_16x16x32_bf16 v[208:211], v[10:13], v[196:199], v[208:211]
  v_mfma_f32_16x16x32_bf16 v[220:223], v[196:199], v[196:199], v[220:223]
  s_waitcnt lgkmcnt(4)
  v_mfma_f32_16x16x32_bf16 v[136:139], v[88:91], v[192:195], v[136:139]
  ds_read_b64_tr_b16 v[76:77], v19 offset:30720
  v_mfma_f32_16x16x32_bf16 v[140:143], v[88:91], v[196:199], v[140:143]
  s_waitcnt lgkmcnt(3)
  ds_read_b64_tr_b16 v[78:79], v19 offset:31744
  v_mfma_f32_16x16x32_bf16 v[144:147], v[92:95], v[192:195], v[144:147]
  v_mfma_f32_16x16x32_bf16 v[148:151], v[92:95], v[196:199], v[148:151]
  v_mfma_f32_16x16x32_bf16 v[212:215], v[10:13], v[200:203], v[212:215]
  v_mfma_f32_16x16x32_bf16 v[224:227], v[200:203], v[200:203], v[224:227]
  s_waitcnt lgkmcnt(2)
  v_mfma_f32_16x16x32_bf16 v[152:155], v[72:75], v[200:203], v[152:155]
  v_mfma_f32_16x16x32_bf16 v[156:159], v[72:75], v[10:13], v[156:159]
  s_waitcnt lgkmcnt(0)
  v_mfma_f32_16x16x32_bf16 v[160:163], v[76:79], v[10:13], v[160:163]
  s_lshl_b32 s53, s6, 10
  s_add_u32 s53, s53, 2048
  v_add_u32 v250, s53, v1
  v_add_u32 v251, 0x10000, v250
  ds_read_b128 a[160:163], v250 offset:0
  ds_read_b128 a[164:167], v250 offset:4096
  ds_read_b128 a[168:171], v250 offset:8192
  ds_read_b128 a[172:175], v250 offset:12288
  ds_read_b128 a[176:179], v250 offset:16384
  ds_read_b128 a[180:183], v250 offset:20480
  ds_read_b128 a[184:187], v250 offset:24576
  ds_read_b128 a[188:191], v250 offset:28672
  ds_read_b128 a[192:195], v250 offset:32768
  ds_read_b128 a[196:199], v250 offset:36864
  ds_read_b128 a[200:203], v250 offset:40960
  ds_read_b128 a[204:207], v250 offset:45056
  ds_read_b128 a[208:211], v250 offset:49152
  ds_read_b128 a[212:215], v250 offset:53248
  ds_read_b128 a[216:219], v250 offset:57344
  ds_read_b128 a[220:223], v250 offset:61440
  ds_read_b128 a[224:227], v251 offset:0
  ds_read_b128 a[228:231], v251 offset:4096
  ds_read_b128 a[232:235], v251 offset:8192
  ds_read_b128 a[236:239], v251 offset:12288
  ds_read_b128 a[240:243], v251 offset:16384
  ds_read_b128 a[244:247], v251 offset:20480
  ds_read_b128 a[248:251], v251 offset:24576
  ds_read_b128 a[252:255], v251 offset:28672
  s_waitcnt vmcnt(5)
  v_lshlrev_b32 v252, 16, v247
  v_and_b32 v253, 0xffff0000, v247
  v_mul_f32 v252, 0x3fb8aa3b, v252
  v_mul_f32 v253, 0x3fb8aa3b, v253
  v_lshlrev_b32 v254, 3, v0
  s_mov_b32 exec_hi, 0x00ffffff
  ds_write_b64 v254, v[252:253] offset:832
  s_mov_b64 exec, -1
  s_add_u32 s53, s6, 2
  s_lshl_b32 s53, s53, 6
  v_add_u32 v254, s53, v44
  s_and_b32 s53, s6, 1
  s_lshl_b32 s53, s53, 6
  v_add_u32 v255, s53, v44
  s_mov_b32 s52, 0x00010001
  s_mov_b32 s53, 0x00010001
  s_mov_b64 exec, s[52:53]
  ds_write_b128 v254, v[156:159] offset:0
  ds_write_b128 v255, v[160:163] offset:0
  s_mov_b64 exec, -1
  v_cndmask_b32_e64 v216, v216, v217, s[68:69]
  v_cndmask_b32_e64 v216, v216, v218, s[70:71]
  v_cndmask_b32_e64 v216, v216, v219, s[72:73]
  v_cndmask_b32_e64 v216, 0, v216, s[74:75]
  v_mov_b32 v217, v216
  s_nop 1
  v_permlane32_swap_b32 v216, v217
  v_add_f32 v216, v216, v217
  v_mov_b32 v217, v216
  s_nop 1
  v_permlane16_swap_b32 v216, v217
  v_add_f32 v216, v216, v217
  v_mul_f32 v248, 0x3b000000, v204
  v_mul_f32 v249, 0x3b000000, v216
  v_fma_f32 v249, -v248, v248, v249
  v_max_f32 v249, 0, v249
  v_add_f32 v249, 0x3727c5ac, v249
  v_rsq_f32 v168, v249
  s_nop 0
  v_mul_f32 v169, -v248, v168
  v_mul_f32 v172, 0x3eb8aa3b, v168
  v_mul_f32 v173, 0x3eb8aa3b, v169
  v_cndmask_b32_e64 v220, v220, v221, s[68:69]
  v_cndmask_b32_e64 v220, v220, v222, s[70:71]
  v_cndmask_b32_e64 v220, v220, v223, s[72:73]
  v_cndmask_b32_e64 v220, 0, v220, s[74:75]
  v_mov_b32 v221, v220
  s_nop 1
  v_permlane32_swap_b32 v220, v221
  v_add_f32 v220, v220, v221
  v_mov_b32 v221, v220
  s_nop 1
  v_permlane16_swap_b32 v220, v221
  v_add_f32 v220, v220, v221
  v_mul_f32 v248, 0x3b000000, v208
  v_mul_f32 v249, 0x3b000000, v220
  v_fma_f32 v249, -v248, v248, v249
  v_max_f32 v249, 0, v249
  v_add_f32 v249, 0x3727c5ac, v249
  v_rsq_f32 v170, v249
  s_nop 0
  v_mul_f32 v171, -v248, v170
  v_mul_f32 v174, 0x3eb8aa3b, v170
  v_mul_f32 v175, 0x3eb8aa3b, v171
  v_cndmask_b32_e64 v224, v224, v225, s[68:69]
  v_cndmask_b32_e64 v224, v224, v226, s[70:71]
  v_cndmask_b32_e64 v224, v224, v227, s[72:73]
  v_cndmask_b32_e64 v224, 0, v224, s[74:75]
  v_mov_b32 v225, v224
  s_nop 1
  v_permlane32_swap_b32 v224, v225
  v_add_f32 v224, v224, v225
  v_mov_b32 v225, v224
  s_nop 1
  v_permlane16_swap_b32 v224, v225
  v_add_f32 v224, v224, v225
  v_mul_f32 v248, 0x3b000000, v212
  v_mul_f32 v249, 0x3b000000, v224
  v_fma_f32 v249, -v248, v248, v249
  v_max_f32 v249, 0, v249
  v_add_f32 v249, 0x3727c5ac, v249
  v_rsq_f32 v176, v249
  s_nop 0
  v_mul_f32 v177, -v248, v176
  s_mov_b32 s72, s50
  s_mov_b32 s73, s51
  s_waitcnt lgkmcnt(0)
  s_barrier
  s_add_u32 m0, s49, 135168
  s_add_u32 s52, s48, 0
  buffer_load_dwordx4 v37, s[20:23], s52 offen lds
  s_add_u32 m0, s49, 136192
  s_add_u32 s52, s48, 0
  buffer_load_dwordx4 v38, s[20:23], s52 offen lds
  s_add_u32 m0, s49, 137216
  s_add_u32 s52, s48, 0
  buffer_load_dwordx4 v39, s[20:23], s52 offen lds
  s_add_u32 m0, s49, 138240
  s_add_u32 s52, s48, 0
  buffer_load_dwordx4 v40, s[20:23], s52 offen lds
  s_add_u32 m0, s49, 139264
  s_add_u32 s52, s48, 0
  buffer_load_dwordx4 v41, s[20:23], s52 offen lds
  s_add_u32 m0, s49, 140288
  s_add_u32 s52, s48, 0
  buffer_load_dwordx4 v42, s[20:23], s52 offen lds
  s_add_u32 m0, s49, 141312
  s_add_u32 s52, s48, 0
  buffer_load_dwordx4 v43, s[20:23], s52 offen lds
L_P1EPI:
  s_cmp_eq_u32 s3, 1
  s_cselect_b64 s[70:71], -1, 0
  s_lshl_b32 s53, s6, 10
  s_add_u32 s53, s53, 2048
  v_add_u32 v247, s53, v1
  ds_read_b128 v[180:183], v44 offset:0
  ds_read_b128 v[184:187], v44 offset:64
  ds_read_b128 v[188:191], v44 offset:128
  ds_read_b128 v[192:195], v44 offset:192
  ds_read_b128 v[196:199], v44 offset:256
  ds_read_b128 v[200:203], v44 offset:320
  s_add_u32 s53, s6, 2
  s_lshl_b32 s53, s53, 6
  v_add_u32 v234, s53, v44
  ds_read_b128 v[204:207], v234 offset:0
  s_waitcnt lgkmcnt(2)
  v_pk_mul_f32 v[234:235], v[196:197], v[168:169] op_sel:[0,1] op_sel_hi:[1,1]
  v_pk_mul_f32 v[236:237], v[198:199], v[168:169] op_sel:[0,1] op_sel_hi:[1,1]
  v_pk_fma_f32 v[234:235], v[136:137], v[168:169], v[234:235] op_sel_hi:[1,0,1]
  v_pk_fma_f32 v[236:237], v[138:139], v[168:169], v[236:237] op_sel_hi:[1,0,1]
  v_cvt_pk_bf16_f32 v224, v234, v235
  v_cvt_pk_bf16_f32 v225, v236, v237
  ds_write_b64 v58, v[224:225] offset:0
  v_pk_mul_f32 v[234:235], v[196:197], v[170:171] op_sel:[0,1] op_sel_hi:[1,1]
  v_pk_mul_f32 v[236:237], v[198:199], v[170:171] op_sel:[0,1] op_sel_hi:[1,1]
  v_pk_fma_f32 v[234:235], v[140:141], v[170:171], v[234:235] op_sel_hi:[1,0,1]
  v_pk_fma_f32 v[236:237], v[142:143], v[170:171], v[236:237] op_sel_hi:[1,0,1]
  v_cvt_pk_bf16_f32 v228, v234, v235
  v_cvt_pk_bf16_f32 v229, v236, v237
  ds_write_b64 v58, v[228:229] offset:1024
  s_waitcnt lgkmcnt(3)
  v_pk_mul_f32 v[234:235], v[200:201], v[168:169] op_sel:[0,1] op_sel_hi:[1,1]
  v_pk_mul_f32 v[236:237], v[202:203], v[168:169] op_sel:[0,1] op_sel_hi:[1,1]
  v_pk_fma_f32 v[234:235], v[144:145], v[168:169], v[234:235] op_sel_hi:[1,0,1]
  v_pk_fma_f32 v[236:237], v[146:147], v[168:169], v[236:237] op_sel_hi:[1,0,1]
  v_cvt_pk_bf16_f32 v226, v234, v235
  v_cvt_pk_bf16_f32 v227, v236, v237
  ds_write_b64 v58, v[226:227] offset:512
  v_pk_mul_f32 v[234:235], v[200:201], v[170:171] op_sel:[0,1] op_sel_hi:[1,1]
  v_pk_mul_f32 v[236:237], v[202:203], v[170:171] op_sel:[0,1] op_sel_hi:[1,1]
  v_pk_fma_f32 v[234:235], v[148:149], v[170:171], v[234:235] op_sel_hi:[1,0,1]
  v_pk_fma_f32 v[236:237], v[150:151], v[170:171], v[236:237] op_sel_hi:[1,0,1]
  v_cvt_pk_bf16_f32 v230, v234, v235
  v_cvt_pk_bf16_f32 v231, v236, v237
  ds_write_b64 v58, v[230:231] offset:1536
  v_pk_mul_f32 v[234:235], v[188:189], v[168:169] op_sel:[0,1] op_sel_hi:[1,1]
  v_pk_mul_f32 v[236:237], v[190:191], v[168:169] op_sel:[0,1] op_sel_hi:[1,1]
  v_pk_fma_f32 v[234:235], v[120:121], v[168:169], v[234:235] op_sel_hi:[1,0,1]
  v_pk_fma_f32 v[236:237], v[122:123], v[168:169], v[236:237] op_sel_hi:[1,0,1]
  v_cvt_pk_bf16_f32 v216, v234, v235
  v_cvt_pk_bf16_f32 v217, v236, v237
  v_pk_mul_f32 v[234:235], v[188:189], v[170:171] op_sel:[0,1] op_sel_hi:[1,1]
  v_pk_mul_f32 v[236:237], v[190:191], v[170:171] op_sel:[0,1] op_sel_hi:[1,1]
  v_pk_fma_f32 v[234:235], v[124:125], v[170:171], v[234:235] op_sel_hi:[1,0,1]
  v_pk_fma_f32 v[236:237], v[126:127], v[170:171], v[236:237] op_sel_hi:[1,0,1]
  v_cvt_pk_bf16_f32 v220, v234, v235
  v_cvt_pk_bf16_f32 v221, v236, v237
  ds_write_b64 v59, v[220:221] offset:0
  v_pk_mul_f32 v[234:235], v[192:193], v[168:169] op_sel:[0,1] op_sel_hi:[1,1]
  v_pk_mul_f32 v[236:237], v[194:195], v[168:169] op_sel:[0,1] op_sel_hi:[1,1]
  v_pk_fma_f32 v[234:235], v[128:129], v[168:169], v[234:235] op_sel_hi:[1,0,1]
  v_pk_fma_f32 v[236:237], v[130:131], v[168:169], v[236:237] op_sel_hi:[1,0,1]
  v_cvt_pk_bf16_f32 v218, v234, v235
  v_cvt_pk_bf16_f32 v219, v236, v237
  v_pk_mul_f32 v[234:235], v[192:193], v[170:171] op_sel:[0,1] op_sel_hi:[1,1]
  v_pk_mul_f32 v[236:237], v[194:195], v[170:171] op_sel:[0,1] op_sel_hi:[1,1]
  v_pk_fma_f32 v[234:235], v[132:133], v[170:171], v[234:235] op_sel_hi:[1,0,1]
  v_pk_fma_f32 v[236:237], v[134:135], v[170:171], v[236:237] op_sel_hi:[1,0,1]
  v_cvt_pk_bf16_f32 v222, v234, v235
  v_cvt_pk_bf16_f32 v223, v236, v237
  ds_write_b64 v59, v[222:223] offset:512
  s_waitcnt lgkmcnt(6)
  v_pk_mul_f32 v[234:235], v[204:205], v[176:177] op_sel:[0,1] op_sel_hi:[1,1]
  v_pk_mul_f32 v[236:237], v[206:207], v[176:177] op_sel:[0,1] op_sel_hi:[1,1]
  v_pk_fma_f32 v[234:235], v[152:153], v[176:177], v[234:235] op_sel_hi:[1,0,1]
  v_pk_fma_f32 v[236:237], v[154:155], v[176:177], v[236:237] op_sel_hi:[1,0,1]
  v_cvt_pk_bf16_f32 v232, v234, v235
  v_cvt_pk_bf16_f32 v233, v236, v237
  ds_write_b64 v60, v[232:233]
  s_waitcnt lgkmcnt(0)
  s_barrier
  ds_read_b64 v[238:239], v63 offset:0
  ds_read_b64 v[240:241], v63 offset:512
  ds_read_b64_tr_b16 v[188:189], v61 offset:0
  ds_read_b64_tr_b16 v[190:191], v62 offset:0
  ds_read_b64_tr_b16 v[192:193], v62 offset:1024
  ds_read_b64_tr_b16 v[194:195], v61 offset:512
  ds_read_b64_tr_b16 v[196:197], v62 offset:512
  ds_read_b64_tr_b16 v[198:199], v62 offset:1536
  v_pk_mul_f32 v[234:235], v[180:181], v[172:173] op_sel:[0,1] op_sel_hi:[1,1]
  v_pk_mul_f32 v[236:237], v[182:183], v[172:173] op_sel:[0,1] op_sel_hi:[1,1]
  v_pk_fma_f32 v[234:235], v[104:105], v[172:173], v[234:235] op_sel_hi:[1,0,1]
  s_cmp_lg_u32 s3, 0
  s_cbranch_scc1 wr1_3
  s_add_u32 m0, s46, 2048
  s_add_u32 s52, s47, 0
  buffer_load_dwordx4 v36, s[16:19], s52 offen lds
  s_add_u32 m0, s46, 6144
  s_add_u32 s52, s47, 262144
  buffer_load_dwordx4 v36, s[16:19], s52 offen lds
wr1_3:
  v_pk_fma_f32 v[236:237], v[106:107], v[172:173], v[236:237] op_sel_hi:[1,0,1]
  v_cvt_pk_bf16_f32 v208, v234, v235
  v_cvt_pk_bf16_f32 v209, v236, v237
  v_pk_mul_f32 v[234:235], v[180:181], v[174:175] op_sel:[0,1] op_sel_hi:[1,1]
  v_pk_mul_f32 v[236:237], v[182:183], v[174:175] op_sel:[0,1] op_sel_hi:[1,1]
  v_pk_fma_f32 v[234:235], v[108:109], v[174:175], v[234:235] op_sel_hi:[1,0,1]
  v_pk_fma_f32 v[236:237], v[110:111], v[174:175], v[236:237] op_sel_hi:[1,0,1]
  v_cvt_pk_bf16_f32 v212, v234, v235
  v_cvt_pk_bf16_f32 v213, v236, v237
  v_pk_mul_f32 v[234:235], v[184:185], v[172:173] op_sel:[0,1] op_sel_hi:[1,1]
  v_pk_mul_f32 v[236:237], v[186:187], v[172:173] op_sel:[0,1] op_sel_hi:[1,1]
  s_cmp_eq_u32 s3, 0
  s_cbranch_scc1 wr2_11
  s_add_u32 m0, s49, 135168
  s_add_u32 s52, s48, 0
  buffer_load_dwordx4 v37, s[20:23], s52 offen lds
  s_add_u32 m0, s49, 136192
  s_add_u32 s52, s48, 0
  buffer_load_dwordx4 v38, s[20:23], s52 offen lds
wr2_11:
  v_pk_fma_f32 v[234:235], v[112:113], v[172:173], v[234:235] op_sel_hi:[1,0,1]
  v_pk_fma_f32 v[236:237], v[114:115], v[172:173], v[236:237] op_sel_hi:[1,0,1]
  v_cvt_pk_bf16_f32 v210, v234, v235
  v_cvt_pk_bf16_f32 v211, v236, v237
  v_pk_mul_f32 v[234:235], v[184:185], v[174:175] op_sel:[0,1] op_sel_hi:[1,1]
  v_pk_mul_f32 v[236:237], v[186:187], v[174:175] op_sel:[0,1] op_sel_hi:[1,1]
  v_pk_fma_f32 v[234:235], v[116:117], v[174:175], v[234:235] op_sel_hi:[1,0,1]
  v_pk_fma_f32 v[236:237], v[118:119], v[174:175], v[236:237] op_sel_hi:[1,0,1]
  v_cvt_pk_bf16_f32 v214, v234, v235
  v_cvt_pk_bf16_f32 v215, v236, v237
  v_mfma_f32_16x16x16_bf16 v[104:107], v[216:217], v[208:209], v[46:49]
  s_cmp_lg_u32 s3, 0
  s_cbranch_scc1 wr1_4
  s_add_u32 m0, s46, 10240
  s_add_u32 s52, s47, 32768
  buffer_load_dwordx4 v36, s[16:19], s52 offen lds
  s_add_u32 m0, s46, 14336
  s_add_u32 s52, s47, 294912
  buffer_load_dwordx4 v36, s[16:19], s52 offen lds
wr1_4:
  v_mfma_f32_16x16x16_bf16 v[108:111], v[218:219], v[210:211], v[46:49]
  v_mfma_f32_16x16x16_bf16 v[112:115], v[220:221], v[212:213], v[46:49]
  v_mfma_f32_16x16x16_bf16 v[116:119], v[222:223], v[214:215], v[46:49]
  s_waitcnt lgkmcnt(7)
  v_mfma_f32_16x16x16_bf16 v[120:123], v[238:239], v[208:209], v[54:57]
  s_waitcnt lgkmcnt(6)
  v_mfma_f32_16x16x16_bf16 v[124:127], v[240:241], v[210:211], v[54:57]
  v_mfma_f32_16x16x16_bf16 v[128:131], v[216:217], v[212:213], v[50:53]
  v_mfma_f32_16x16x16_bf16 v[132:135], v[218:219], v[214:215], v[50:53]
  s_nop 3
  v_max_f32 v104, v104, v120
  v_max_f32 v105, v105, v121
  s_cmp_lg_u32 s3, 0
  s_cbranch_scc1 wr1_5
  s_add_u32 m0, s46, 18432
  s_add_u32 s52, s47, 65536
  buffer_load_dwordx4 v36, s[16:19], s52 offen lds
  s_add_u32 m0, s46, 22528
  s_add_u32 s52, s47, 327680
  buffer_load_dwordx4 v36, s[16:19], s52 offen lds
wr1_5:
  v_max_f32 v106, v106, v122
  v_max_f32 v107, v107, v123
  v_max_f32 v108, v108, v124
  v_max_f32 v109, v109, v125
  v_max_f32 v110, v110, v126
  v_max_f32 v111, v111, v127
  v_max_f32 v112, v112, v128
  v_max_f32 v113, v113, v129
  v_max_f32 v114, v114, v130
  v_max_f32 v115, v115, v131
  v_max_f32 v116, v116, v132
  s_cmp_eq_u32 s3, 0
  s_cbranch_scc1 wr2_12
  s_add_u32 m0, s49, 137216
  s_add_u32 s52, s48, 0
  buffer_load_dwordx4 v39, s[20:23], s52 offen lds
  s_add_u32 m0, s49, 138240
  s_add_u32 s52, s48, 0
  buffer_load_dwordx4 v40, s[20:23], s52 offen lds
wr2_12:
  v_max_f32 v117, v117, v133
  v_max_f32 v118, v118, v134
  v_max_f32 v119, v119, v135
  v_max3_f32 v242, v104, v105, v106
  v_max3_f32 v243, v108, v109, v110
  v_max3_f32 v244, v112, v113, v114
  v_max3_f32 v245, v116, v117, v118
  v_max_f32 v242, v242, v107
  v_max_f32 v243, v243, v111
  v_max_f32 v244, v244, v115
  v_max_f32 v245, v245, v119
  s_cmp_lg_u32 s3, 0
  s_cbranch_scc1 wr1_6
  s_add_u32 m0, s46, 26624
  s_add_u32 s52, s47, 98304
  buffer_load_dwordx4 v36, s[16:19], s52 offen lds
  s_add_u32 m0, s46, 30720
  s_add_u32 s52, s47, 360448
  buffer_load_dwordx4 v36, s[16:19], s52 offen lds
wr1_6:
  v_permlane32_swap_b32 v242, v243
  v_permlane32_swap_b32 v244, v245
  v_max_f32 v242, v242, v243
  v_max_f32 v244, v244, v245
  s_nop 1
  v_permlane16_swap_b32 v242, v244
  v_max_f32 v242, v242, v244
  v_mov_b32 v244, v242
  s_nop 1
  v_permlane16_swap_b32 v242, v244
  v_mov_b32 v243, v242
  v_mov_b32 v245, v244
  s_nop 0
  v_permlane32_swap_b32 v242, v243
  s_cmp_lg_u32 s3, 0
  s_cbranch_scc1 wr1_7
  s_add_u32 m0, s46, 34816
  s_add_u32 s52, s47, 131072
  buffer_load_dwordx4 v36, s[16:19], s52 offen lds
  s_add_u32 m0, s46, 38912
  s_add_u32 s52, s47, 393216
  buffer_load_dwordx4 v36, s[16:19], s52 offen lds
wr1_7:
  v_permlane32_swap_b32 v244, v245
  v_pk_add_f32 v[104:105], v[104:105], v[242:243] op_sel_hi:[1,0] neg_lo:[0,1] neg_hi:[0,1]
  v_pk_add_f32 v[106:107], v[106:107], v[242:243] op_sel_hi:[1,0] neg_lo:[0,1] neg_hi:[0,1]
  v_pk_add_f32 v[108:109], v[108:109], v[242:243] op_sel:[0,1] op_sel_hi:[1,1] neg_lo:[0,1] neg_hi:[0,1]
  v_pk_add_f32 v[110:111], v[110:111], v[242:243] op_sel:[0,1] op_sel_hi:[1,1] neg_lo:[0,1] neg_hi:[0,1]
  v_pk_add_f32 v[112:113], v[112:113], v[244:245] op_sel_hi:[1,0] neg_lo:[0,1] neg_hi:[0,1]
  v_pk_add_f32 v[114:115], v[114:115], v[244:245] op_sel_hi:[1,0] neg_lo:[0,1] neg_hi:[0,1]
  v_pk_add_f32 v[116:117], v[116:117], v[244:245] op_sel:[0,1] op_sel_hi:[1,1] neg_lo:[0,1] neg_hi:[0,1]
  v_pk_add_f32 v[118:119], v[118:119], v[244:245] op_sel:[0,1] op_sel_hi:[1,1] neg_lo:[0,1] neg_hi:[0,1]
  v_exp_f32 v104, v104
  v_exp_f32 v105, v105
  s_cmp_eq_u32 s3, 0
  s_cbranch_scc1 wr2_13
  s_add_u32 m0, s49, 139264
  s_add_u32 s52, s48, 0
  buffer_load_dwordx4 v41, s[20:23], s52 offen lds
  s_add_u32 m0, s49, 140288
  s_add_u32 s52, s48, 0
  buffer_load_dwordx4 v42, s[20:23], s52 offen lds
wr2_13:
  v_exp_f32 v106, v106
  v_exp_f32 v107, v107
  v_exp_f32 v108, v108
  v_exp_f32 v109, v109
  v_exp_f32 v110, v110
  v_exp_f32 v111, v111
  v_exp_f32 v112, v112
  v_exp_f32 v113, v113
  v_exp_f32 v114, v114
  v_exp_f32 v115, v115
  v_exp_f32 v116, v116
  s_cmp_lg_u32 s3, 0
  s_cbranch_scc1 wr1_8
  s_add_u32 m0, s46, 43008
  s_add_u32 s52, s47, 163840
  buffer_load_dwordx4 v36, s[16:19], s52 offen lds
  s_add_u32 m0, s46, 47104
  s_add_u32 s52, s47, 425984
  buffer_load_dwordx4 v36, s[16:19], s52 offen lds
wr1_8:
  v_exp_f32 v117, v117
  v_exp_f32 v118, v118
  v_exp_f32 v119, v119
  v_cvt_pk_bf16_f32 v120, v104, v105
  v_cvt_pk_bf16_f32 v121, v106, v107
  v_cvt_pk_bf16_f32 v124, v108, v109
  v_cvt_pk_bf16_f32 v125, v110, v111
  v_cvt_pk_bf16_f32 v128, v112, v113
  v_cvt_pk_bf16_f32 v129, v114, v115
  v_cvt_pk_bf16_f32 v132, v116, v117
  v_cvt_pk_bf16_f32 v133, v118, v119
  s_cmp_lg_u32 s3, 0
  s_cbranch_scc1 wr1_9
  s_add_u32 m0, s46, 51200
  s_add_u32 s52, s47, 196608
  buffer_load_dwordx4 v36, s[16:19], s52 offen lds
  s_add_u32 m0, s46, 55296
  s_add_u32 s52, s47, 458752
  buffer_load_dwordx4 v36, s[16:19], s52 offen lds
wr1_9:
  v_cndmask_b32_e64 v136, 0, v120, s[66:67]
  v_cndmask_b32_e64 v138, v120, 0, s[66:67]
  v_cndmask_b32_e64 v137, 0, v121, s[66:67]
  v_cndmask_b32_e64 v139, v121, 0, s[66:67]
  v_cndmask_b32_e64 v140, 0, v124, s[66:67]
  v_cndmask_b32_e64 v142, v124, 0, s[66:67]
  v_cndmask_b32_e64 v141, 0, v125, s[66:67]
  v_cndmask_b32_e64 v143, v125, 0, s[66:67]
  v_cndmask_b32_e64 v144, 0, v128, s[66:67]
  v_cndmask_b32_e64 v146, v128, 0, s[66:67]
  v_cndmask_b32_e64 v145, 0, v129, s[66:67]
  s_cmp_eq_u32 s3, 0
  s_cbranch_scc1 wr2_14
  s_add_u32 m0, s49, 141312
  s_add_u32 s52, s48, 0
  buffer_load_dwordx4 v43, s[20:23], s52 offen lds
wr2_14:
  v_cndmask_b32_e64 v147, v129, 0, s[66:67]
  v_cndmask_b32_e64 v148, 0, v132, s[66:67]
  v_cndmask_b32_e64 v150, v132, 0, s[66:67]
  v_cndmask_b32_e64 v149, 0, v133, s[66:67]
  v_cndmask_b32_e64 v151, v133, 0, s[66:67]
  s_waitcnt lgkmcnt(0)
  v_mfma_f32_16x16x32_bf16 v[200:203], v[10:13], v[136:139], 0
  v_mfma_f32_16x16x32_bf16 v[152:155], v[188:191], v[136:139], 0
  v_mfma_f32_16x16x32_bf16 v[204:207], v[10:13], v[140:143], 0
  v_mfma_f32_16x16x32_bf16 v[156:159], v[194:197], v[140:143], 0
  v_mfma_f32_16x16x32_bf16 v[224:227], v[10:13], v[144:147], 0
  s_cmp_lg_u32 s3, 0
  s_cbranch_scc1 wr1_10
  s_add_u32 m0, s46, 59392
  s_add_u32 s52, s47, 229376
  buffer_load_dwordx4 v36, s[16:19], s52 offen lds
  s_add_u32 m0, s46, 63488
  s_add_u32 s52, s47, 491520
  buffer_load_dwordx4 v36, s[16:19], s52 offen lds
wr1_10:
  v_mfma_f32_16x16x32_bf16 v[160:163], v[190:193], v[144:147], 0
  v_mfma_f32_16x16x32_bf16 v[228:231], v[10:13], v[148:151], 0
  v_mfma_f32_16x16x32_bf16 v[164:167], v[196:199], v[148:151], 0
  v_rcp_f32 v200, v200
  v_rcp_f32 v204, v204
  s_nop 0
  v_rcp_f32 v224, v224
  s_nop 2
  v_rcp_f32 v228, v228
  v_pk_mul_f32 v[152:153], v[152:153], v[200:201] op_sel_hi:[1,0]
  v_pk_mul_f32 v[154:155], v[154:155], v[200:201] op_sel_hi:[1,0]
  v_pk_mul_f32 v[156:157], v[156:157], v[204:205] op_sel_hi:[1,0]
  v_pk_mul_f32 v[158:159], v[158:159], v[204:205] op_sel_hi:[1,0]
  v_pk_mul_f32 v[160:161], v[160:161], v[224:225] op_sel_hi:[1,0]
  v_pk_mul_f32 v[162:163], v[162:163], v[224:225] op_sel_hi:[1,0]
  v_pk_mul_f32 v[164:165], v[164:165], v[228:229] op_sel_hi:[1,0]
  v_pk_mul_f32 v[166:167], v[166:167], v[228:229] op_sel_hi:[1,0]
  v_cvt_pk_bf16_f32 v208, v152, v153
  v_cvt_pk_bf16_f32 v209, v154, v155
  v_cvt_pk_bf16_f32 v210, v156, v157
  v_cvt_pk_bf16_f32 v211, v158, v159
  v_cvt_pk_bf16_f32 v212, v160, v161
  v_cvt_pk_bf16_f32 v213, v162, v163
  v_cvt_pk_bf16_f32 v214, v164, v165
  v_cvt_pk_bf16_f32 v215, v166, v167
  s_lshl_b32 s54, s6, 15
  s_add_u32 s53, s54, s94
  s_lshl_b32 s54, s5, 10
  s_add_u32 s53, s53, s54
  s_add_u32 s54, s53, 16384
  s_cmp_eq_u32 s7, 0
  s_cbranch_scc1 stp_15
  buffer_store_dwordx4 v[208:211], v1, s[28:31], s53 offen sc1
  buffer_store_dwordx4 v[212:215], v1, s[28:31], s54 offen sc1
  s_nop 1
  s_branch std_16
stp_15:
  buffer_store_dwordx4 v[208:211], v1, s[28:31], s53 offen
  buffer_store_dwordx4 v[212:215], v1, s[28:31], s54 offen
std_16:
  s_cmp_eq_u32 s3, 0
  s_nop 0
  s_cbranch_scc1 wor_17
  ds_write_b128 v247, a[96:99] offset:0
  ds_write_b128 v247, a[100:103] offset:4096
  ds_write_b128 v247, a[104:107] offset:8192
  ds_write_b128 v247, a[108:111] offset:12288
  ds_write_b128 v247, a[112:115] offset:16384
  ds_write_b128 v247, a[116:119] offset:20480
  ds_write_b128 v247, a[120:123] offset:24576
  ds_write_b128 v247, a[124:127] offset:28672
  ds_write_b128 v247, a[128:131] offset:32768
  ds_write_b128 v247, a[132:135] offset:36864
  ds_write_b128 v247, a[136:139] offset:40960
  ds_write_b128 v247, a[140:143] offset:45056
  ds_write_b128 v247, a[144:147] offset:49152
  ds_write_b128 v247, a[148:151] offset:53248
  ds_write_b128 v247, a[152:155] offset:57344
  ds_write_b128 v247, a[156:159] offset:61440
wor_17:
  s_lshl_b32 s78, s3, 2
  s_add_u32 s76, s78, 1
  v_mov_b32 v254, s76
  v_mov_b32 v255, 0
  v_lshlrev_b32 v250, 2, v0
  s_cmp_lg_u32 s3, 0
  s_nop 0
  s_cbranch_scc1 pr2_18
  s_add_u32 m0, s49, 106496
  s_add_u32 s52, s48, 458752
  buffer_load_dwordx4 v37, s[20:23], s52 offen lds
  s_add_u32 m0, s49, 107520
  s_add_u32 s52, s48, 458752
  buffer_load_dwordx4 v38, s[20:23], s52 offen lds
  s_add_u32 m0, s49, 108544
  s_add_u32 s52, s48, 458752
  buffer_load_dwordx4 v39, s[20:23], s52 offen lds
  s_add_u32 m0, s49, 109568
  s_add_u32 s52, s48, 458752
  buffer_load_dwordx4 v40, s[20:23], s52 offen lds
  s_add_u32 m0, s49, 110592
  s_add_u32 s52, s48, 458752
  buffer_load_dwordx4 v41, s[20:23], s52 offen lds
  s_add_u32 m0, s49, 111616
  s_add_u32 s52, s48, 458752
  buffer_load_dwordx4 v42, s[20:23], s52 offen lds
  s_add_u32 m0, s49, 112640
  s_add_u32 s52, s48, 458752
  buffer_load_dwordx4 v43, s[20:23], s52 offen lds
  s_waitcnt vmcnt(7)
  s_branch pr3_19
pr2_18:
  s_waitcnt vmcnt(0)
pr3_19:
  s_mov_b64 exec, 1
  s_cmp_eq_u32 s7, 0
  s_cbranch_scc1 fp_20
  buffer_store_dword v254, v255, s[28:31], s56 offen sc1
  s_branch fd_21
fp_20:
  buffer_store_dword v254, v255, s[28:31], s56 offen
fd_21:
  s_mov_b64 exec, -1
  s_cmp_lg_u32 s6, 0
  s_cbranch_scc1 so_22
  s_mov_b32 s77, 0
  buffer_load_dword v248, v250, s[28:31], s57 offen sc1
sp_24:
  buffer_load_dword v249, v250, s[28:31], s57 offen sc1
  s_waitcnt vmcnt(1)
  v_cmp_gt_u32 vcc, s76, v248
  s_add_u32 s77, s77, 1
  s_cbranch_vccz sj_23
  buffer_load_dword v248, v250, s[28:31], s57 offen sc1
  s_waitcnt vmcnt(1)
  v_cmp_gt_u32 vcc, s76, v249
  s_cmp_lt_u32 s77, 0x80000
  s_cbranch_vccz sj_23
  s_nop 2
  s_cbranch_scc1 sp_24
  s_endpgm
so_22:
sj_23:
  s_waitcnt vmcnt(0) lgkmcnt(0)
  s_barrier
L_C2:
  s_mul_i32 s53, s86, 16384
  s_add_u32 s50, s53, s94
  s_and_b32 s53, s6, 1
  s_lshl_b32 s53, s53, 12
  v_subrev_u32 v232, s53, v23
  v_subrev_u32 v233, s53, v26
  v_subrev_u32 v234, s53, v29
  v_subrev_u32 v235, s53, v32
  s_add_u32 s92, s50, 0
  buffer_load_dwordx4 a[0:3], v1, s[28:31], s92 offen offset:0 sc1
  buffer_load_dwordx4 a[4:7], v1, s[28:31], s92 offen offset:1024 sc1
  buffer_load_dwordx4 a[8:11], v1, s[28:31], s92 offen offset:2048 sc1
  buffer_load_dwordx4 a[12:15], v1, s[28:31], s92 offen offset:3072 sc1
  s_add_u32 s92, s50, 4096
  buffer_load_dwordx4 a[16:19], v1, s[28:31], s92 offen offset:0 sc1
  buffer_load_dwordx4 a[20:23], v1, s[28:31], s92 offen offset:1024 sc1
  buffer_load_dwordx4 a[24:27], v1, s[28:31], s92 offen offset:2048 sc1
  buffer_load_dwordx4 a[28:31], v1, s[28:31], s92 offen offset:3072 sc1
  s_add_u32 s92, s50, 8192
  buffer_load_dwordx4 a[32:35], v1, s[28:31], s92 offen offset:0 sc1
  buffer_load_dwordx4 a[36:39], v1, s[28:31], s92 offen offset:1024 sc1
  s_lshl_b32 s53, s6, 10
  s_add_u32 s53, s53, 2048
  v_add_u32 v230, s53, v1
  ds_read_b64_tr_b16 v[72:73], v232 offset:0
  ds_read_b64_tr_b16 v[74:75], v232 offset:2048
  ds_read_b64_tr_b16 v[76:77], v233 offset:0
  ds_read_b64_tr_b16 v[78:79], v233 offset:2048
  ds_read_b64_tr_b16 v[80:81], v234 offset:0
  ds_read_b64_tr_b16 v[82:83], v234 offset:2048
  ds_read_b64_tr_b16 v[84:85], v235 offset:0
  ds_read_b64_tr_b16 v[86:87], v235 offset:2048
  s_waitcnt vmcnt(9) lgkmcnt(6)
  v_mfma_f32_16x16x32_bf16 v[104:107], v[72:75], a[0:3], 0
  s_waitcnt lgkmcnt(4)
  ds_read_b64_tr_b16 v[88:89], v232 offset:8192
  ds_read_b64_tr_b16 v[90:91], v232 offset:10240
  v_mfma_f32_16x16x32_bf16 v[108:111], v[76:79], a[0:3], 0
  s_waitcnt lgkmcnt(4)
  ds_read_b64_tr_b16 v[92:93], v233 offset:8192
  ds_read_b64_tr_b16 v[94:95], v233 offset:10240
  buffer_load_dwordx4 a[40:43], v1, s[28:31], s92 offen offset:2048 sc1
  v_mfma_f32_16x16x32_bf16 v[112:115], v[80:83], a[0:3], 0
  s_waitcnt lgkmcnt(4)
  ds_read_b64_tr_b16 v[72:73], v234 offset:8192
  ds_read_b64_tr_b16 v[74:75], v234 offset:10240
  v_mfma_f32_16x16x32_bf16 v[116:119], v[84:87], a[0:3], 0
  s_waitcnt vmcnt(9) lgkmcnt(4)
  ds_read_b64_tr_b16 v[76:77], v235 offset:8192
  ds_read_b64_tr_b16 v[78:79], v235 offset:10240
  v_mfma_f32_16x16x32_bf16 v[104:107], v[88:91], a[4:7], v[104:107]
  s_waitcnt lgkmcnt(4)
  ds_read_b64_tr_b16 v[80:81], v232 offset:16384
  ds_read_b64_tr_b16 v[82:83], v232 offset:18432
  buffer_load_dwordx4 a[44:47], v1, s[28:31], s92 offen offset:3072 sc1
  v_mfma_f32_16x16x32_bf16 v[108:111], v[92:95], a[4:7], v[108:111]
  s_waitcnt lgkmcnt(4)
  ds_read_b64_tr_b16 v[84:85], v233 offset:16384
  ds_read_b64_tr_b16 v[86:87], v233 offset:18432
  v_mfma_f32_16x16x32_bf16 v[112:115], v[72:75], a[4:7], v[112:115]
  s_waitcnt lgkmcnt(4)
  ds_read_b64_tr_b16 v[88:89], v234 offset:16384
  ds_read_b64_tr_b16 v[90:91], v234 offset:18432
  ds_read_b128 a[96:99], v230 offset:0
  v_mfma_f32_16x16x32_bf16 v[116:119], v[76:79], a[4:7], v[116:119]
  s_waitcnt vmcnt(9) lgkmcnt(5)
  ds_read_b64_tr_b16 v[92:93], v235 offset:16384
  ds_read_b64_tr_b16 v[94:95], v235 offset:18432
  s_add_u32 s92, s50, 12288
  buffer_load_dwordx4 a[48:51], v1, s[28:31], s92 offen offset:0 sc1
  v_mfma_f32_16x16x32_bf16 v[104:107], v[80:83], a[8:11], v[104:107]
  s_waitcnt lgkmcnt(5)
  ds_read_b64_tr_b16 v[72:73], v232 offset:24576
  ds_read_b64_tr_b16 v[74:75], v232 offset:26624
  v_mfma_f32_16x16x32_bf16 v[108:111], v[84:87], a[8:11], v[108:111]
  s_waitcnt lgkmcnt(5)
  ds_read_b64_tr_b16 v[76:77], v233 offset:24576
  ds_read_b64_tr_b16 v[78:79], v233 offset:26624
  ds_read_b128 a[100:103], v230 offset:4096
  v_mfma_f32_16x16x32_bf16 v[112:115], v[88:91], a[8:11], v[112:115]
  s_waitcnt lgkmcnt(5)
  ds_read_b64_tr_b16 v[80:81], v234 offset:24576
  ds_read_b64_tr_b16 v[82:83], v234 offset:26624
  buffer_load_dwordx4 a[52:55], v1, s[28:31], s92 offen offset:1024 sc1
  v_mfma_f32_16x16x32_bf16 v[116:119], v[92:95], a[8:11], v[116:119]
  s_waitcnt vmcnt(10) lgkmcnt(5)
  ds_read_b64_tr_b16 v[84:85], v235 offset:24576
  ds_read_b64_tr_b16 v[86:87], v235 offset:26624
  v_mfma_f32_16x16x32_bf16 v[104:107], v[72:75], a[12:15], v[104:107]
  s_waitcnt lgkmcnt(5)
  ds_read_b64_tr_b16 v[88:89], v232 offset:32768
  ds_read_b64_tr_b16 v[90:91], v232 offset:34816
  ds_read_b128 a[104:107], v230 offset:8192
  v_mfma_f32_16x16x32_bf16 v[108:111], v[76:79], a[12:15], v[108:111]
  s_waitcnt lgkmcnt(5)
  ds_read_b64_tr_b16 v[92:93], v233 offset:32768
  ds_read_b64_tr_b16 v[94:95], v233 offset:34816
  buffer_load_dwordx4 a[56:59], v1, s[28:31], s92 offen offset:2048 sc1
  v_mfma_f32_16x16x32_bf16 v[112:115], v[80:83], a[12:15], v[112:115]
  s_waitcnt lgkmcnt(5)
  ds_read_b64_tr_b16 v[72:73], v234 offset:32768
  ds_read_b64_tr_b16 v[74:75], v234 offset:34816
  v_mfma_f32_16x16x32_bf16 v[116:119], v[84:87], a[12:15], v[116:119]
  s_waitcnt vmcnt(10) lgkmcnt(5)
  ds_read_b64_tr_b16 v[76:77], v235 offset:32768
  ds_read_b64_tr_b16 v[78:79], v235 offset:34816
  ds_read_b128 a[108:111], v230 offset:12288
  v_mfma_f32_16x16x32_bf16 v[104:107], v[88:91], a[16:19], v[104:107]
  s_waitcnt lgkmcnt(5)
  ds_read_b64_tr_b16 v[80:81], v232 offset:40960
  ds_read_b64_tr_b16 v[82:83], v232 offset:43008
  buffer_load_dwordx4 a[60:63], v1, s[28:31], s92 offen offset:3072 sc1
  v_mfma_f32_16x16x32_bf16 v[108:111], v[92:95], a[16:19], v[108:111]
  s_waitcnt lgkmcnt(5)
  ds_read_b64_tr_b16 v[84:85], v233 offset:40960
  ds_read_b64_tr_b16 v[86:87], v233 offset:43008
  v_mfma_f32_16x16x32_bf16 v[112:115], v[72:75], a[16:19], v[112:115]
  s_waitcnt lgkmcnt(5)
  ds_read_b64_tr_b16 v[88:89], v234 offset:40960
  ds_read_b64_tr_b16 v[90:91], v234 offset:43008
  ds_read_b128 a[112:115], v230 offset:16384
  v_mfma_f32_16x16x32_bf16 v[116:119], v[76:79], a[16:19], v[116:119]
  s_waitcnt vmcnt(10) lgkmcnt(5)
  ds_read_b64_tr_b16 v[92:93], v235 offset:40960
  ds_read_b64_tr_b16 v[94:95], v235 offset:43008
  v_mfma_f32_16x16x32_bf16 v[104:107], v[80:83], a[20:23], v[104:107]
  s_waitcnt lgkmcnt(5)
  ds_read_b64_tr_b16 v[72:73], v232 offset:49152
  ds_read_b64_tr_b16 v[74:75], v232 offset:51200
  v_mfma_f32_16x16x32_bf16 v[108:111], v[84:87], a[20:23], v[108:111]
  s_waitcnt lgkmcnt(5)
  ds_read_b64_tr_b16 v[76:77], v233 offset:49152
  ds_read_b64_tr_b16 v[78:79], v233 offset:51200
  ds_read_b128 a[116:119], v230 offset:20480
  v_mfma_f32_16x16x32_bf16 v[112:115], v[88:91], a[20:23], v[112:115]
  s_waitcnt lgkmcnt(5)
  ds_read_b64_tr_b16 v[80:81], v234 offset:49152
  ds_read_b64_tr_b16 v[82:83], v234 offset:51200
  s_add_u32 m0, s49, 77824
  s_add_u32 s52, s48, 917504
  buffer_load_dwordx4 v37, s[20:23], s52 offen lds
  v_mfma_f32_16x16x32_bf16 v[116:119], v[92:95], a[20:23], v[116:119]
  s_waitcnt vmcnt(10) lgkmcnt(5)
  ds_read_b64_tr_b16 v[84:85], v235 offset:49152
  ds_read_b64_tr_b16 v[86:87], v235 offset:51200
  v_mfma_f32_16x16x32_bf16 v[104:107], v[72:75], a[24:27], v[104:107]
  s_waitcnt lgkmcnt(5)
  ds_read_b64_tr_b16 v[88:89], v232 offset:57344
  ds_read_b64_tr_b16 v[90:91], v232 offset:59392
  ds_read_b128 a[120:123], v230 offset:24576
  v_mfma_f32_16x16x32_bf16 v[108:111], v[76:79], a[24:27], v[108:111]
  s_waitcnt lgkmcnt(5)
  ds_read_b64_tr_b16 v[92:93], v233 offset:57344
  ds_read_b64_tr_b16 v[94:95], v233 offset:59392
  v_mfma_f32_16x16x32_bf16 v[112:115], v[80:83], a[24:27], v[112:115]
  s_waitcnt lgkmcnt(5)
  ds_read_b64_tr_b16 v[72:73], v234 offset:57344
  ds_read_b64_tr_b16 v[74:75], v234 offset:59392
  s_add_u32 m0, s49, 78848
  s_add_u32 s52, s48, 917504
  buffer_load_dwordx4 v38, s[20:23], s52 offen lds
  v_mfma_f32_16x16x32_bf16 v[116:119], v[84:87], a[24:27], v[116:119]
  s_waitcnt vmcnt(10) lgkmcnt(5)
  ds_read_b64_tr_b16 v[76:77], v235 offset:57344
  ds_read_b64_tr_b16 v[78:79], v235 offset:59392
  ds_read_b128 a[124:127], v230 offset:28672
  v_mfma_f32_16x16x32_bf16 v[104:107], v[88:91], a[28:31], v[104:107]
  s_waitcnt lgkmcnt(5)
  ds_read_b64_tr_b16 v[80:81], v232 offset:4096
  ds_read_b64_tr_b16 v[82:83], v232 offset:6144
  v_mfma_f32_16x16x32_bf16 v[108:111], v[92:95], a[28:31], v[108:111]
  s_waitcnt lgkmcnt(5)
  ds_read_b64_tr_b16 v[84:85], v233 offset:4096
  ds_read_b64_tr_b16 v[86:87], v233 offset:6144
  v_mfma_f32_16x16x32_bf16 v[112:115], v[72:75], a[28:31], v[112:115]
  s_waitcnt lgkmcnt(5)
  ds_read_b64_tr_b16 v[88:89], v234 offset:4096
  ds_read_b64_tr_b16 v[90:91], v234 offset:6144
  ds_read_b128 a[128:131], v230 offset:32768
  v_mfma_f32_16x16x32_bf16 v[116:119], v[76:79], a[28:31], v[116:119]
  s_waitcnt vmcnt(9) lgkmcnt(5)
  ds_read_b64_tr_b16 v[92:93], v235 offset:4096
  ds_read_b64_tr_b16 v[94:95], v235 offset:6144
  s_add_u32 m0, s49, 79872
  s_add_u32 s52, s48, 917504
  buffer_load_dwordx4 v39, s[20:23], s52 offen lds
  v_mfma_f32_16x16x32_bf16 v[104:107], v[80:83], a[32:35], v[104:107]
  s_waitcnt lgkmcnt(5)
  ds_read_b64_tr_b16 v[72:73], v232 offset:12288
  ds_read_b64_tr_b16 v[74:75], v232 offset:14336
  v_mfma_f32_16x16x32_bf16 v[108:111], v[84:87], a[32:35], v[108:111]
  s_waitcnt lgkmcnt(5)
  ds_read_b64_tr_b16 v[76:77], v233 offset:12288
  ds_read_b64_tr_b16 v[78:79], v233 offset:14336
  ds_read_b128 a[132:135], v230 offset:36864
  v_mfma_f32_16x16x32_bf16 v[112:115], v[88:91], a[32:35], v[112:115]
  s_waitcnt lgkmcnt(5)
  ds_read_b64_tr_b16 v[80:81], v234 offset:12288
  ds_read_b64_tr_b16 v[82:83], v234 offset:14336
  v_mfma_f32_16x16x32_bf16 v[116:119], v[92:95], a[32:35], v[116:119]
  s_waitcnt vmcnt(9) lgkmcnt(5)
  ds_read_b64_tr_b16 v[84:85], v235 offset:12288
  ds_read_b64_tr_b16 v[86:87], v235 offset:14336
  v_mfma_f32_16x16x32_bf16 v[104:107], v[72:75], a[36:39], v[104:107]
  s_waitcnt lgkmcnt(5)
  ds_read_b64_tr_b16 v[88:89], v232 offset:20480
  ds_read_b64_tr_b16 v[90:91], v232 offset:22528
  ds_read_b128 a[136:139], v230 offset:40960
  v_mfma_f32_16x16x32_bf16 v[108:111], v[76:79], a[36:39], v[108:111]
  s_waitcnt lgkmcnt(5)
  ds_read_b64_tr_b16 v[92:93], v233 offset:20480
  ds_read_b64_tr_b16 v[94:95], v233 offset:22528
  s_add_u32 m0, s49, 80896
  s_add_u32 s52, s48, 917504
  buffer_load_dwordx4 v40, s[20:23], s52 offen lds
  v_mfma_f32_16x16x32_bf16 v[112:115], v[80:83], a[36:39], v[112:115]
  s_waitcnt lgkmcnt(5)
  ds_read_b64_tr_b16 v[72:73], v234 offset:20480
  ds_read_b64_tr_b16 v[74:75], v234 offset:22528
  v_mfma_f32_16x16x32_bf16 v[116:119], v[84:87], a[36:39], v[116:119]
  s_waitcnt vmcnt(9) lgkmcnt(5)
  ds_read_b64_tr_b16 v[76:77], v235 offset:20480
  ds_read_b64_tr_b16 v[78:79], v235 offset:22528
  ds_read_b128 a[140:143], v230 offset:45056
  v_mfma_f32_16x16x32_bf16 v[104:107], v[88:91], a[40:43], v[104:107]
  s_waitcnt lgkmcnt(5)
  ds_read_b64_tr_b16 v[80:81], v232 offset:28672
  ds_read_b64_tr_b16 v[82:83], v232 offset:30720
  v_mfma_f32_16x16x32_bf16 v[108:111], v[92:95], a[40:43], v[108:111]
  s_waitcnt lgkmcnt(5)
  ds_read_b64_tr_b16 v[84:85], v233 offset:28672
  ds_read_b64_tr_b16 v[86:87], v233 offset:30720
  s_add_u32 m0, s49, 81920
  s_add_u32 s52, s48, 917504
  buffer_load_dwordx4 v41, s[20:23], s52 offen lds
  v_mfma_f32_16x16x32_bf16 v[112:115], v[72:75], a[40:43], v[112:115]
  s_waitcnt lgkmcnt(5)
  ds_read_b64_tr_b16 v[88:89], v234 offset:28672
  ds_read_b64_tr_b16 v[90:91], v234 offset:30720
  ds_read_b128 a[144:147], v230 offset:49152
  v_mfma_f32_16x16x32_bf16 v[116:119], v[76:79], a[40:43], v[116:119]
  s_waitcnt vmcnt(9) lgkmcnt(5)
  ds_read_b64_tr_b16 v[92:93], v235 offset:28672
  ds_read_b64_tr_b16 v[94:95], v235 offset:30720
  v_mfma_f32_16x16x32_bf16 v[104:107], v[80:83], a[44:47], v[104:107]
  s_waitcnt lgkmcnt(5)
  ds_read_b64_tr_b16 v[72:73], v232 offset:36864
  ds_read_b64_tr_b16 v[74:75], v232 offset:38912
  v_mfma_f32_16x16x32_bf16 v[108:111], v[84:87], a[44:47], v[108:111]
  s_waitcnt lgkmcnt(5)
  ds_read_b64_tr_b16 v[76:77], v233 offset:36864
  ds_read_b64_tr_b16 v[78:79], v233 offset:38912
  ds_read_b128 a[148:151], v230 offset:53248
  v_mfma_f32_16x16x32_bf16 v[112:115], v[88:91], a[44:47], v[112:115]
  s_waitcnt lgkmcnt(5)
  ds_read_b64_tr_b16 v[80:81], v234 offset:36864
  ds_read_b64_tr_b16 v[82:83], v234 offset:38912
  s_add_u32 m0, s49, 82944
  s_add_u32 s52, s48, 917504
  buffer_load_dwordx4 v42, s[20:23], s52 offen lds
  v_mfma_f32_16x16x32_bf16 v[116:119], v[92:95], a[44:47], v[116:119]
  s_waitcnt vmcnt(9) lgkmcnt(5)
  ds_read_b64_tr_b16 v[84:85], v235 offset:36864
  ds_read_b64_tr_b16 v[86:87], v235 offset:38912
  v_mfma_f32_16x16x32_bf16 v[104:107], v[72:75], a[48:51], v[104:107]
  s_waitcnt lgkmcnt(5)
  ds_read_b64_tr_b16 v[88:89], v232 offset:45056
  ds_read_b64_tr_b16 v[90:91], v232 offset:47104
  ds_read_b128 a[152:155], v230 offset:57344
  v_mfma_f32_16x16x32_bf16 v[108:111], v[76:79], a[48:51], v[108:111]
  s_waitcnt lgkmcnt(5)
  ds_read_b64_tr_b16 v[92:93], v233 offset:45056
  ds_read_b64_tr_b16 v[94:95], v233 offset:47104
  v_mfma_f32_16x16x32_bf16 v[112:115], v[80:83], a[48:51], v[112:115]
  s_waitcnt lgkmcnt(5)
  ds_read_b64_tr_b16 v[72:73], v234 offset:45056
  ds_read_b64_tr_b16 v[74:75], v234 offset:47104
  v_mfma_f32_16x16x32_bf16 v[116:119], v[84:87], a[48:51], v[116:119]
  s_waitcnt vmcnt(8) lgkmcnt(5)
  ds_read_b64_tr_b16 v[76:77], v235 offset:45056
  ds_read_b64_tr_b16 v[78:79], v235 offset:47104
  ds_read_b128 a[156:159], v230 offset:61440
  v_mfma_f32_16x16x32_bf16 v[104:107], v[88:91], a[52:55], v[104:107]
  s_waitcnt lgkmcnt(5)
  ds_read_b64_tr_b16 v[80:81], v232 offset:53248
  ds_read_b64_tr_b16 v[82:83], v232 offset:55296
  s_add_u32 m0, s49, 83968
  s_add_u32 s52, s48, 917504
  buffer_load_dwordx4 v43, s[20:23], s52 offen lds
  v_mfma_f32_16x16x32_bf16 v[108:111], v[92:95], a[52:55], v[108:111]
  s_waitcnt lgkmcnt(5)
  ds_read_b64_tr_b16 v[84:85], v233 offset:53248
  ds_read_b64_tr_b16 v[86:87], v233 offset:55296
  v_mfma_f32_16x16x32_bf16 v[112:115], v[72:75], a[52:55], v[112:115]
  s_waitcnt lgkmcnt(5)
  ds_read_b64_tr_b16 v[88:89], v234 offset:53248
  ds_read_b64_tr_b16 v[90:91], v234 offset:55296
  v_mfma_f32_16x16x32_bf16 v[116:119], v[76:79], a[52:55], v[116:119]
  s_waitcnt vmcnt(8) lgkmcnt(4)
  ds_read_b64_tr_b16 v[92:93], v235 offset:53248
  ds_read_b64_tr_b16 v[94:95], v235 offset:55296
  v_mfma_f32_16x16x32_bf16 v[104:107], v[80:83], a[56:59], v[104:107]
  s_waitcnt lgkmcnt(4)
  ds_read_b64_tr_b16 v[72:73], v232 offset:61440
  ds_read_b64_tr_b16 v[74:75], v232 offset:63488
  v_mfma_f32_16x16x32_bf16 v[108:111], v[84:87], a[56:59], v[108:111]
  s_waitcnt lgkmcnt(4)
  ds_read_b64_tr_b16 v[76:77], v233 offset:61440
  ds_read_b64_tr_b16 v[78:79], v233 offset:63488
  v_mfma_f32_16x16x32_bf16 v[112:115], v[88:91], a[56:59], v[112:115]
  s_waitcnt lgkmcnt(4)
  ds_read_b64_tr_b16 v[80:81], v234 offset:61440
  ds_read_b64_tr_b16 v[82:83], v234 offset:63488
  v_mfma_f32_16x16x32_bf16 v[116:119], v[92:95], a[56:59], v[116:119]
  s_waitcnt vmcnt(7) lgkmcnt(4)
  ds_read_b64_tr_b16 v[84:85], v235 offset:61440
  ds_read_b64_tr_b16 v[86:87], v235 offset:63488
  v_mfma_f32_16x16x32_bf16 v[104:107], v[72:75], a[60:63], v[104:107]
  s_waitcnt lgkmcnt(4)
  v_mfma_f32_16x16x32_bf16 v[108:111], v[76:79], a[60:63], v[108:111]
  s_waitcnt lgkmcnt(2)
  v_mfma_f32_16x16x32_bf16 v[112:115], v[80:83], a[60:63], v[112:115]
  s_waitcnt lgkmcnt(0)
  v_mfma_f32_16x16x32_bf16 v[116:119], v[84:87], a[60:63], v[116:119]
  v_lshlrev_b32 v184, 16, v2
  v_and_b32 v185, 0xffff0000, v2
  v_lshlrev_b32 v186, 16, v3
  v_and_b32 v187, 0xffff0000, v3
  v_lshlrev_b32 v188, 16, v4
  v_and_b32 v189, 0xffff0000, v4
  v_lshlrev_b32 v190, 16, v5
  v_and_b32 v191, 0xffff0000, v5
  v_lshlrev_b32 v192, 16, v6
  v_and_b32 v193, 0xffff0000, v6
  v_lshlrev_b32 v194, 16, v7
  v_and_b32 v195, 0xffff0000, v7
  v_lshlrev_b32 v196, 16, v8
  v_and_b32 v197, 0xffff0000, v8
  v_lshlrev_b32 v198, 16, v9
  v_and_b32 v199, 0xffff0000, v9
  v_pk_add_f32 v[104:105], v[104:105], v[184:185]
  v_pk_add_f32 v[106:107], v[106:107], v[186:187]
  v_pk_add_f32 v[108:109], v[108:109], v[188:189]
  v_pk_add_f32 v[110:111], v[110:111], v[190:191]
  v_pk_add_f32 v[112:113], v[112:113], v[192:193]
  v_pk_add_f32 v[114:115], v[114:115], v[194:195]
  v_pk_add_f32 v[116:117], v[116:117], v[196:197]
  v_pk_add_f32 v[118:119], v[118:119], v[198:199]
  v_cvt_pk_bf16_f32 v2, v104, v105
  v_cvt_pk_bf16_f32 v3, v106, v107
  v_cvt_pk_bf16_f32 v4, v108, v109
  v_cvt_pk_bf16_f32 v5, v110, v111
  v_cvt_pk_bf16_f32 v6, v112, v113
  v_cvt_pk_bf16_f32 v7, v114, v115
  v_cvt_pk_bf16_f32 v8, v116, v117
  v_cvt_pk_bf16_f32 v9, v118, v119
  s_mul_i32 s53, s86, 16384
  s_add_u32 s53, s53, s96
  s_lshl_b32 s54, s60, 11
  s_add_u32 s53, s53, s54
  s_lshl_b32 s54, s86, 10
  s_add_u32 s54, s54, s97
  s_mov_b32 s55, 0
  s_add_u32 s55, s55, s53
  s_cmp_eq_u32 s7, 0
  s_cbranch_scc1 stp_25
  buffer_store_dwordx4 v[2:5], v1, s[28:31], s53 offen sc1
  buffer_store_dwordx4 v[6:9], v1, s[28:31], s55 offen offset:1024 sc1
  s_nop 1
  s_branch std_26
stp_25:
  buffer_store_dwordx4 v[2:5], v1, s[28:31], s53 offen
  buffer_store_dwordx4 v[6:9], v1, s[28:31], s55 offen offset:1024
std_26:
  v_mov_b32 v200, 0
  v_mov_b32 v201, 0
  v_mov_b32 v202, 0
  v_mov_b32 v203, 0
  v_dot2c_f32_bf16 v200, v2, v10
  v_dot2c_f32_bf16 v201, v2, v2
  v_dot2c_f32_bf16 v202, v3, v10
  v_dot2c_f32_bf16 v203, v3, v3
  v_dot2c_f32_bf16 v200, v4, v10
  v_dot2c_f32_bf16 v201, v4, v4
  v_dot2c_f32_bf16 v202, v5, v10
  v_dot2c_f32_bf16 v203, v5, v5
  v_dot2c_f32_bf16 v200, v6, v10
  v_dot2c_f32_bf16 v201, v6, v6
  v_dot2c_f32_bf16 v202, v7, v10
  v_dot2c_f32_bf16 v203, v7, v7
  v_dot2c_f32_bf16 v200, v8, v10
  v_dot2c_f32_bf16 v201, v8, v8
  v_dot2c_f32_bf16 v202, v9, v10
  v_dot2c_f32_bf16 v203, v9, v9
  s_nop 1
  v_add_f32 v200, v200, v202
  v_add_f32 v201, v201, v203
  s_nop 1
  v_permlane32_swap_b32 v200, v201
  v_add_f32 v200, v200, v201
  v_mov_b32 v252, v200
  s_nop 1
  v_permlane16_swap_b32 v200, v252
  v_add_f32 v200, v200, v252
  v_mov_b32 v201, v200
  s_nop 1
  v_permlane32_swap_b32 v200, v201
  s_mov_b64 exec, 0xffff
  s_cmp_eq_u32 s7, 0
  s_cbranch_scc1 stp_27
  buffer_store_dwordx2 v[200:201], v68, s[28:31], s54 offen sc1
  s_branch std_28
stp_27:
  buffer_store_dwordx2 v[200:201], v68, s[28:31], s54 offen
std_28:
  s_mov_b64 exec, -1
  s_add_u32 s76, s78, 2
  v_mov_b32 v254, s76
  v_mov_b32 v255, 0
  v_lshlrev_b32 v250, 2, v0
  s_waitcnt vmcnt(0)
  s_mov_b64 exec, 1
  s_cmp_eq_u32 s7, 0
  s_cbranch_scc1 fp_29
  buffer_store_dword v254, v255, s[28:31], s56 offen sc1
  s_branch fd_30
fp_29:
  buffer_store_dword v254, v255, s[28:31], s56 offen
fd_30:
  s_mov_b64 exec, -1
  s_cmp_lg_u32 s6, 0
  s_cbranch_scc1 so_31
  s_mov_b32 s77, 0
  buffer_load_dword v248, v250, s[28:31], s57 offen sc1
sp_33:
  buffer_load_dword v249, v250, s[28:31], s57 offen sc1
  s_waitcnt vmcnt(1)
  v_cmp_gt_u32 vcc, s76, v248
  s_add_u32 s77, s77, 1
  s_cbranch_vccz sj_32
  buffer_load_dword v248, v250, s[28:31], s57 offen sc1
  s_waitcnt vmcnt(1)
  v_cmp_gt_u32 vcc, s76, v249
  s_cmp_lt_u32 s77, 0x80000
  s_cbranch_vccz sj_32
  s_nop 2
  s_cbranch_scc1 sp_33
  s_endpgm
so_31:
sj_32:
  s_waitcnt vmcnt(0) lgkmcnt(0)
  s_barrier
  s_lshl_b32 s53, s6, 1
  s_add_u32 s53, s53, 0
  s_lshl_b32 s53, s53, 14
  s_add_u32 s50, s53, s96
  s_lshl_b32 s53, s6, 1
  s_add_u32 s53, s53, 1
  s_lshl_b32 s53, s53, 14
  s_add_u32 s51, s53, s96
  s_add_u32 s92, s50, 0
  buffer_load_dwordx4 a[0:3], v1, s[28:31], s92 offen offset:0 sc1
  s_add_u32 s93, s51, 0
  buffer_load_dwordx4 a[4:7], v1, s[28:31], s93 offen offset:0 sc1
  buffer_load_dwordx4 a[8:11], v1, s[28:31], s92 offen offset:1024 sc1
  buffer_load_dwordx4 a[12:15], v1, s[28:31], s93 offen offset:1024 sc1
  buffer_load_dwordx4 a[16:19], v1, s[28:31], s92 offen offset:2048 sc1
  buffer_load_dwordx4 a[20:23], v1, s[28:31], s93 offen offset:2048 sc1
  buffer_load_dwordx4 a[24:27], v1, s[28:31], s92 offen offset:3072 sc1
  buffer_load_dwordx4 a[28:31], v1, s[28:31], s93 offen offset:3072 sc1
  s_lshl_b32 s54, s6, 11
  s_add_u32 s53, s54, s97
  s_add_u32 s53, s53, 0
  buffer_load_dwordx4 v[180:183], v1, s[28:31], s53 offen sc1
  s_lshl_b32 s54, s6, 11
  s_add_u32 s53, s54, s97
  s_add_u32 s53, s53, 1024
  buffer_load_dwordx4 v[184:187], v1, s[28:31], s53 offen sc1
  ds_read_b64_tr_b16 v[72:73], v22 offset:4096
  ds_read_b64_tr_b16 v[74:75], v22 offset:7680
  ds_read_b64_tr_b16 v[76:77], v22 offset:4128
  ds_read_b64_tr_b16 v[78:79], v22 offset:7712
  ds_read_b64_tr_b16 v[80:81], v22 offset:4160
  ds_read_b64_tr_b16 v[82:83], v22 offset:7744
  s_waitcnt vmcnt(9) lgkmcnt(4)
  v_mfma_f32_16x16x32_bf16 v[104:107], v[72:75], a[0:3], 0
  s_waitcnt vmcnt(8)
  ds_read_b64_tr_b16 v[84:85], v22 offset:4192
  v_mfma_f32_16x16x32_bf16 v[108:111], v[72:75], a[4:7], 0
  s_waitcnt lgkmcnt(3)
  ds_read_b64_tr_b16 v[86:87], v22 offset:7776
  s_add_u32 s92, s50, 4096
  buffer_load_dwordx4 a[32:35], v1, s[28:31], s92 offen offset:0 sc1
  v_mfma_f32_16x16x32_bf16 v[112:115], v[76:79], a[0:3], 0
  ds_read_b64_tr_b16 v[88:89], v22 offset:4224
  v_mfma_f32_16x16x32_bf16 v[116:119], v[76:79], a[4:7], 0
  s_waitcnt lgkmcnt(3)
  ds_read_b64_tr_b16 v[90:91], v22 offset:7808
  v_mfma_f32_16x16x32_bf16 v[120:123], v[80:83], a[0:3], 0
  ds_read_b64_tr_b16 v[92:93], v22 offset:4256
  s_add_u32 s93, s51, 4096
  buffer_load_dwordx4 a[36:39], v1, s[28:31], s93 offen offset:0 sc1
  v_mfma_f32_16x16x32_bf16 v[124:127], v[80:83], a[4:7], 0
  s_waitcnt lgkmcnt(3)
  ds_read_b64_tr_b16 v[94:95], v22 offset:7840
  v_mfma_f32_16x16x32_bf16 v[128:131], v[84:87], a[0:3], 0
  ds_read_b64_tr_b16 v[72:73], v22 offset:4288
  v_mfma_f32_16x16x32_bf16 v[132:135], v[84:87], a[4:7], 0
  s_waitcnt lgkmcnt(3)
  ds_read_b64_tr_b16 v[74:75], v22 offset:7872
  buffer_load_dwordx4 a[40:43], v1, s[28:31], s92 offen offset:1024 sc1
  v_mfma_f32_16x16x32_bf16 v[136:139], v[88:91], a[0:3], 0
  ds_read_b64_tr_b16 v[76:77], v22 offset:11264
  v_mfma_f32_16x16x32_bf16 v[140:143], v[88:91], a[4:7], 0
  s_waitcnt lgkmcnt(3)
  ds_read_b64_tr_b16 v[78:79], v22 offset:14848
  v_mfma_f32_16x16x32_bf16 v[144:147], v[92:95], a[0:3], 0
  ds_read_b64_tr_b16 v[80:81], v22 offset:11296
  buffer_load_dwordx4 a[44:47], v1, s[28:31], s93 offen offset:1024 sc1
  v_mfma_f32_16x16x32_bf16 v[148:151], v[92:95], a[4:7], 0
  s_waitcnt lgkmcnt(3)
  ds_read_b64_tr_b16 v[82:83], v22 offset:14880
  v_mfma_f32_16x16x32_bf16 v[152:155], v[72:75], a[0:3], 0
  ds_read_b64_tr_b16 v[84:85], v22 offset:11328
  v_mfma_f32_16x16x32_bf16 v[156:159], v[72:75], a[4:7], 0
  s_waitcnt vmcnt(11) lgkmcnt(3)
  ds_read_b64_tr_b16 v[86:87], v22 offset:14912
  v_mfma_f32_16x16x32_bf16 v[104:107], v[76:79], a[8:11], v[104:107]
  s_waitcnt vmcnt(10)
  ds_read_b64_tr_b16 v[88:89], v22 offset:11360
  v_mfma_f32_16x16x32_bf16 v[108:111], v[76:79], a[12:15], v[108:111]
  s_waitcnt lgkmcnt(3)
  ds_read_b64_tr_b16 v[90:91], v22 offset:14944
  buffer_load_dwordx4 a[48:51], v1, s[28:31], s92 offen offset:2048 sc1
  v_mfma_f32_16x16x32_bf16 v[112:115], v[80:83], a[8:11], v[112:115]
  ds_read_b64_tr_b16 v[92:93], v22 offset:11392
  v_mfma_f32_16x16x32_bf16 v[116:119], v[80:83], a[12:15], v[116:119]
  s_waitcnt lgkmcnt(3)
  ds_read_b64_tr_b16 v[94:95], v22 offset:14976
  v_mfma_f32_16x16x32_bf16 v[120:123], v[84:87], a[8:11], v[120:123]
  ds_read_b64_tr_b16 v[72:73], v22 offset:11424
  buffer_load_dwordx4 a[52:55], v1, s[28:31], s93 offen offset:2048 sc1
  v_mfma_f32_16x16x32_bf16 v[124:127], v[84:87], a[12:15], v[124:127]
  s_waitcnt lgkmcnt(3)
  ds_read_b64_tr_b16 v[74:75], v22 offset:15008
  v_mfma_f32_16x16x32_bf16 v[128:131], v[88:91], a[8:11], v[128:131]
  ds_read_b64_tr_b16 v[76:77], v22 offset:11456
  v_mfma_f32_16x16x32_bf16 v[132:135], v[88:91], a[12:15], v[132:135]
  s_waitcnt lgkmcnt(3)
  ds_read_b64_tr_b16 v[78:79], v22 offset:15040
  buffer_load_dwordx4 a[56:59], v1, s[28:31], s92 offen offset:3072 sc1
  v_mfma_f32_16x16x32_bf16 v[136:139], v[92:95], a[8:11], v[136:139]
  ds_read_b64_tr_b16 v[80:81], v22 offset:18432
  v_mfma_f32_16x16x32_bf16 v[140:143], v[92:95], a[12:15], v[140:143]
  s_waitcnt lgkmcnt(3)
  ds_read_b64_tr_b16 v[82:83], v22 offset:22016
  v_mfma_f32_16x16x32_bf16 v[144:147], v[72:75], a[8:11], v[144:147]
  ds_read_b64_tr_b16 v[84:85], v22 offset:18464
  buffer_load_dwordx4 a[60:63], v1, s[28:31], s93 offen offset:3072 sc1
  v_mfma_f32_16x16x32_bf16 v[148:151], v[72:75], a[12:15], v[148:151]
  s_waitcnt lgkmcnt(3)
  ds_read_b64_tr_b16 v[86:87], v22 offset:22048
  v_mfma_f32_16x16x32_bf16 v[152:155], v[76:79], a[8:11], v[152:155]
  ds_read_b64_tr_b16 v[88:89], v22 offset:18496
  v_mfma_f32_16x16x32_bf16 v[156:159], v[76:79], a[12:15], v[156:159]
  s_waitcnt vmcnt(13) lgkmcnt(3)
  ds_read_b64_tr_b16 v[90:91], v22 offset:22080
  v_mfma_f32_16x16x32_bf16 v[104:107], v[80:83], a[16:19], v[104:107]
  s_waitcnt vmcnt(12)
  ds_read_b64_tr_b16 v[92:93], v22 offset:18528
  v_mfma_f32_16x16x32_bf16 v[108:111], v[80:83], a[20:23], v[108:111]
  s_waitcnt lgkmcnt(3)
  ds_read_b64_tr_b16 v[94:95], v22 offset:22112
  s_add_u32 s92, s50, 8192
  buffer_load_dwordx4 a[64:67], v1, s[28:31], s92 offen offset:0 sc1
  v_mfma_f32_16x16x32_bf16 v[112:115], v[84:87], a[16:19], v[112:115]
  ds_read_b64_tr_b16 v[72:73], v22 offset:18560
  s_waitcnt vmcnt(9)
  v_add_f32 v180, v180, v182
  v_mfma_f32_16x16x32_bf16 v[116:119], v[84:87], a[20:23], v[116:119]
  s_waitcnt lgkmcnt(3)
  ds_read_b64_tr_b16 v[74:75], v22 offset:22144
  v_add_f32 v181, v181, v183
  v_mfma_f32_16x16x32_bf16 v[120:123], v[88:91], a[16:19], v[120:123]
  ds_read_b64_tr_b16 v[76:77], v22 offset:18592
  s_add_u32 s93, s51, 8192
  buffer_load_dwordx4 a[68:71], v1, s[28:31], s93 offen offset:0 sc1
  v_mfma_f32_16x16x32_bf16 v[124:127], v[88:91], a[20:23], v[124:127]
  s_waitcnt lgkmcnt(3)
  ds_read_b64_tr_b16 v[78:79], v22 offset:22176
  v_permlane32_swap_b32 v180, v181
  v_mfma_f32_16x16x32_bf16 v[128:131], v[92:95], a[16:19], v[128:131]
  ds_read_b64_tr_b16 v[80:81], v22 offset:18624
  v_add_f32 v180, v180, v181
  v_mfma_f32_16x16x32_bf16 v[132:135], v[92:95], a[20:23], v[132:135]
  s_waitcnt lgkmcnt(3)
  ds_read_b64_tr_b16 v[82:83], v22 offset:22208
  v_mov_b32 v252, v180
  v_mfma_f32_16x16x32_bf16 v[136:139], v[72:75], a[16:19], v[136:139]
  ds_read_b64_tr_b16 v[84:85], v22 offset:25600
  buffer_load_dwordx4 a[72:75], v1, s[28:31], s92 offen offset:1024 sc1
  v_mfma_f32_16x16x32_bf16 v[140:143], v[72:75], a[20:23], v[140:143]
  s_waitcnt lgkmcnt(3)
  ds_read_b64_tr_b16 v[86:87], v22 offset:29184
  v_permlane16_swap_b32 v180, v252
  v_mfma_f32_16x16x32_bf16 v[144:147], v[76:79], a[16:19], v[144:147]
  ds_read_b64_tr_b16 v[88:89], v22 offset:25632
  v_add_f32 v180, v180, v252
  v_mfma_f32_16x16x32_bf16 v[148:151], v[76:79], a[20:23], v[148:151]
  s_waitcnt lgkmcnt(3)
  ds_read_b64_tr_b16 v[90:91], v22 offset:29216
  v_mov_b32 v181, v180
  v_mfma_f32_16x16x32_bf16 v[152:155], v[80:83], a[16:19], v[152:155]
  ds_read_b64_tr_b16 v[92:93], v22 offset:25664
  buffer_load_dwordx4 a[76:79], v1, s[28:31], s93 offen offset:1024 sc1
  v_mfma_f32_16x16x32_bf16 v[156:159], v[80:83], a[20:23], v[156:159]
  s_waitcnt lgkmcnt(3)
  ds_read_b64_tr_b16 v[94:95], v22 offset:29248
  v_permlane32_swap_b32 v180, v181
  v_mfma_f32_16x16x32_bf16 v[104:107], v[84:87], a[24:27], v[104:107]
  ds_read_b64_tr_b16 v[72:73], v22 offset:25696
  v_mul_f32 v248, 0x3b000000, v180
  v_mfma_f32_16x16x32_bf16 v[108:111], v[84:87], a[28:31], v[108:111]
  s_waitcnt lgkmcnt(3)
  ds_read_b64_tr_b16 v[74:75], v22 offset:29280
  v_mul_f32 v249, 0x3b000000, v181
  v_mfma_f32_16x16x32_bf16 v[112:115], v[88:91], a[24:27], v[112:115]
  ds_read_b64_tr_b16 v[76:77], v22 offset:25728
  v_fma_f32 v249, -v248, v248, v249
  v_mfma_f32_16x16x32_bf16 v[116:119], v[88:91], a[28:31], v[116:119]
  s_waitcnt lgkmcnt(3)
  ds_read_b64_tr_b16 v[78:79], v22 offset:29312
  v_max_f32 v249, 0, v249
  v_mfma_f32_16x16x32_bf16 v[120:123], v[92:95], a[24:27], v[120:123]
  ds_read_b64_tr_b16 v[80:81], v22 offset:25760
  buffer_load_dwordx4 a[80:83], v1, s[28:31], s92 offen offset:2048 sc1
  v_mfma_f32_16x16x32_bf16 v[124:127], v[92:95], a[28:31], v[124:127]
  s_waitcnt lgkmcnt(3)
  ds_read_b64_tr_b16 v[82:83], v22 offset:29344
  v_add_f32 v249, 0x3727c5ac, v249
  v_mfma_f32_16x16x32_bf16 v[128:131], v[72:75], a[24:27], v[128:131]
  ds_read_b64_tr_b16 v[84:85], v22 offset:25792
  v_rsq_f32 v168, v249
  v_mfma_f32_16x16x32_bf16 v[132:135], v[72:75], a[28:31], v[132:135]
  s_waitcnt lgkmcnt(3)
  ds_read_b64_tr_b16 v[86:87], v22 offset:29376
  v_mul_f32 v168, 0x3fb8aa3b, v168
  v_mfma_f32_16x16x32_bf16 v[136:139], v[76:79], a[24:27], v[136:139]
  ds_read_b64_tr_b16 v[88:89], v21 offset:40960
  buffer_load_dwordx4 a[84:87], v1, s[28:31], s93 offen offset:2048 sc1
  v_mfma_f32_16x16x32_bf16 v[140:143], v[76:79], a[28:31], v[140:143]
  s_waitcnt lgkmcnt(3)
  ds_read_b64_tr_b16 v[90:91], v21 offset:44544
  v_mul_f32 v169, -v248, v168
  v_mfma_f32_16x16x32_bf16 v[144:147], v[80:83], a[24:27], v[144:147]
  ds_read_b64_tr_b16 v[92:93], v21 offset:40992
  v_add_f32 v184, v184, v186
  v_mfma_f32_16x16x32_bf16 v[148:151], v[80:83], a[28:31], v[148:151]
  s_waitcnt lgkmcnt(3)
  ds_read_b64_tr_b16 v[94:95], v21 offset:44576
  v_add_f32 v185, v185, v187
  v_mfma_f32_16x16x32_bf16 v[152:155], v[84:87], a[24:27], v[152:155]
  ds_read_b64_tr_b16 v[72:73], v21 offset:41024
  buffer_load_dwordx4 a[88:91], v1, s[28:31], s92 offen offset:3072 sc1
  v_mfma_f32_16x16x32_bf16 v[156:159], v[84:87], a[28:31], v[156:159]
  s_waitcnt vmcnt(14) lgkmcnt(3)
  ds_read_b64_tr_b16 v[74:75], v21 offset:44608
  v_permlane32_swap_b32 v184, v185
  v_mfma_f32_16x16x32_bf16 v[104:107], v[88:91], a[32:35], v[104:107]
  s_waitcnt vmcnt(13)
  ds_read_b64_tr_b16 v[76:77], v21 offset:41056
  v_add_f32 v184, v184, v185
  v_mfma_f32_16x16x32_bf16 v[108:111], v[88:91], a[36:39], v[108:111]
  s_waitcnt lgkmcnt(3)
  ds_read_b64_tr_b16 v[78:79], v21 offset:44640
  v_mov_b32 v252, v184
  v_mfma_f32_16x16x32_bf16 v[112:115], v[92:95], a[32:35], v[112:115]
  ds_read_b64_tr_b16 v[80:81], v21 offset:41088
  buffer_load_dwordx4 a[92:95], v1, s[28:31], s93 offen offset:3072 sc1
  v_mfma_f32_16x16x32_bf16 v[116:119], v[92:95], a[36:39], v[116:119]
  s_waitcnt lgkmcnt(3)
  ds_read_b64_tr_b16 v[82:83], v21 offset:44672
  v_permlane16_swap_b32 v184, v252
  v_mfma_f32_16x16x32_bf16 v[120:123], v[72:75], a[32:35], v[120:123]
  ds_read_b64_tr_b16 v[84:85], v21 offset:41120
  s_add_u32 s92, s50, 12288
  buffer_load_dwordx4 a[0:3], v1, s[28:31], s92 offen offset:0 sc1
  v_mfma_f32_16x16x32_bf16 v[124:127], v[72:75], a[36:39], v[124:127]
  s_waitcnt lgkmcnt(3)
  ds_read_b64_tr_b16 v[86:87], v21 offset:44704
  v_add_f32 v184, v184, v252
  v_mfma_f32_16x16x32_bf16 v[128:131], v[76:79], a[32:35], v[128:131]
  ds_read_b64_tr_b16 v[88:89], v21 offset:41152
  s_add_u32 s93, s51, 12288
  buffer_load_dwordx4 a[4:7], v1, s[28:31], s93 offen offset:0 sc1
  v_mfma_f32_16x16x32_bf16 v[132:135], v[76:79], a[36:39], v[132:135]
  s_waitcnt lgkmcnt(3)
  ds_read_b64_tr_b16 v[90:91], v21 offset:44736
  v_mov_b32 v185, v184
  v_mfma_f32_16x16x32_bf16 v[136:139], v[80:83], a[32:35], v[136:139]
  ds_read_b64_tr_b16 v[92:93], v21 offset:48128
  buffer_load_dwordx4 a[8:11], v1, s[28:31], s92 offen offset:1024 sc1
  v_mfma_f32_16x16x32_bf16 v[140:143], v[80:83], a[36:39], v[140:143]
  s_waitcnt lgkmcnt(3)
  ds_read_b64_tr_b16 v[94:95], v21 offset:51712
  v_permlane32_swap_b32 v184, v185
  v_mfma_f32_16x16x32_bf16 v[144:147], v[84:87], a[32:35], v[144:147]
  ds_read_b64_tr_b16 v[72:73], v21 offset:48160
  buffer_load_dwordx4 a[12:15], v1, s[28:31], s93 offen offset:1024 sc1
  v_mfma_f32_16x16x32_bf16 v[148:151], v[84:87], a[36:39], v[148:151]
  s_waitcnt lgkmcnt(3)
  ds_read_b64_tr_b16 v[74:75], v21 offset:51744
  v_mul_f32 v248, 0x3b000000, v184
  v_mfma_f32_16x16x32_bf16 v[152:155], v[88:91], a[32:35], v[152:155]
  ds_read_b64_tr_b16 v[76:77], v21 offset:48192
  buffer_load_dwordx4 a[16:19], v1, s[28:31], s92 offen offset:2048 sc1
  v_mfma_f32_16x16x32_bf16 v[156:159], v[88:91], a[36:39], v[156:159]
  s_waitcnt vmcnt(18) lgkmcnt(3)
  ds_read_b64_tr_b16 v[78:79], v21 offset:51776
  v_mul_f32 v249, 0x3b000000, v185
  v_mfma_f32_16x16x32_bf16 v[104:107], v[92:95], a[40:43], v[104:107]
  s_waitcnt vmcnt(17)
  ds_read_b64_tr_b16 v[80:81], v21 offset:48224
  buffer_load_dwordx4 a[20:23], v1, s[28:31], s93 offen offset:2048 sc1
  v_mfma_f32_16x16x32_bf16 v[108:111], v[92:95], a[44:47], v[108:111]
  s_waitcnt lgkmcnt(3)
  ds_read_b64_tr_b16 v[82:83], v21 offset:51808
  v_fma_f32 v249, -v248, v248, v249
  v_mfma_f32_16x16x32_bf16 v[112:115], v[72:75], a[40:43], v[112:115]
  ds_read_b64_tr_b16 v[84:85], v21 offset:48256
  buffer_load_dwordx4 a[24:27], v1, s[28:31], s92 offen offset:3072 sc1
  v_mfma_f32_16x16x32_bf16 v[116:119], v[72:75], a[44:47], v[116:119]
  s_waitcnt lgkmcnt(3)
  ds_read_b64_tr_b16 v[86:87], v21 offset:51840
  v_max_f32 v249, 0, v249
  v_mfma_f32_16x16x32_bf16 v[120:123], v[76:79], a[40:43], v[120:123]
  ds_read_b64_tr_b16 v[88:89], v21 offset:48288
  buffer_load_dwordx4 a[28:31], v1, s[28:31], s93 offen offset:3072 sc1
  v_mfma_f32_16x16x32_bf16 v[124:127], v[76:79], a[44:47], v[124:127]
  s_waitcnt lgkmcnt(3)
  ds_read_b64_tr_b16 v[90:91], v21 offset:51872
  v_add_f32 v249, 0x3727c5ac, v249
  v_mfma_f32_16x16x32_bf16 v[128:131], v[80:83], a[40:43], v[128:131]
  ds_read_b64_tr_b16 v[92:93], v21 offset:48320
  v_rsq_f32 v170, v249
  v_mfma_f32_16x16x32_bf16 v[132:135], v[80:83], a[44:47], v[132:135]
  s_waitcnt lgkmcnt(3)
  ds_read_b64_tr_b16 v[94:95], v21 offset:51904
  s_add_u32 m0, s49, 49152
  s_add_u32 s52, s48, 1376256
  buffer_load_dwordx4 v37, s[20:23], s52 offen lds
  v_mfma_f32_16x16x32_bf16 v[136:139], v[84:87], a[40:43], v[136:139]
  ds_read_b64_tr_b16 v[72:73], v21 offset:55296
  v_mul_f32 v170, 0x3fb8aa3b, v170
  v_mfma_f32_16x16x32_bf16 v[140:143], v[84:87], a[44:47], v[140:143]
  s_waitcnt lgkmcnt(3)
  ds_read_b64_tr_b16 v[74:75], v21 offset:58880
  v_mul_f32 v171, -v248, v170
  v_mfma_f32_16x16x32_bf16 v[144:147], v[88:91], a[40:43], v[144:147]
  ds_read_b64_tr_b16 v[76:77], v21 offset:55328
  s_add_u32 m0, s49, 50176
  s_add_u32 s52, s48, 1376256
  buffer_load_dwordx4 v38, s[20:23], s52 offen lds
  v_mfma_f32_16x16x32_bf16 v[148:151], v[88:91], a[44:47], v[148:151]
  s_waitcnt lgkmcnt(3)
  ds_read_b64_tr_b16 v[78:79], v21 offset:58912
  s_add_u32 m0, s49, 51200
  s_add_u32 s52, s48, 1376256
  buffer_load_dwordx4 v39, s[20:23], s52 offen lds
  v_mfma_f32_16x16x32_bf16 v[152:155], v[92:95], a[40:43], v[152:155]
  ds_read_b64_tr_b16 v[80:81], v21 offset:55360
  s_add_u32 m0, s49, 52224
  s_add_u32 s52, s48, 1376256
  buffer_load_dwordx4 v40, s[20:23], s52 offen lds
  v_mfma_f32_16x16x32_bf16 v[156:159], v[92:95], a[44:47], v[156:159]
  s_waitcnt vmcnt(23) lgkmcnt(3)
  ds_read_b64_tr_b16 v[82:83], v21 offset:58944
  s_add_u32 m0, s49, 53248
  s_add_u32 s52, s48, 1376256
  buffer_load_dwordx4 v41, s[20:23], s52 offen lds
  v_mfma_f32_16x16x32_bf16 v[104:107], v[72:75], a[48:51], v[104:107]
  s_waitcnt vmcnt(23)
  ds_read_b64_tr_b16 v[84:85], v21 offset:55392
  s_add_u32 m0, s49, 54272
  s_add_u32 s52, s48, 1376256
  buffer_load_dwordx4 v42, s[20:23], s52 offen lds
  v_mfma_f32_16x16x32_bf16 v[108:111], v[72:75], a[52:55], v[108:111]
  s_waitcnt lgkmcnt(3)
  ds_read_b64_tr_b16 v[86:87], v21 offset:58976
  v_mfma_f32_16x16x32_bf16 v[112:115], v[76:79], a[48:51], v[112:115]
  ds_read_b64_tr_b16 v[88:89], v21 offset:55424
  s_add_u32 m0, s49, 55296
  s_add_u32 s52, s48, 1376256
  buffer_load_dwordx4 v43, s[20:23], s52 offen lds
  v_mfma_f32_16x16x32_bf16 v[116:119], v[76:79], a[52:55], v[116:119]
  s_waitcnt lgkmcnt(3)
  ds_read_b64_tr_b16 v[90:91], v21 offset:59008
  v_mfma_f32_16x16x32_bf16 v[120:123], v[80:83], a[48:51], v[120:123]
  ds_read_b64_tr_b16 v[92:93], v21 offset:55456
  v_mfma_f32_16x16x32_bf16 v[124:127], v[80:83], a[52:55], v[124:127]
  s_waitcnt lgkmcnt(3)
  ds_read_b64_tr_b16 v[94:95], v21 offset:59040
  v_mfma_f32_16x16x32_bf16 v[128:131], v[84:87], a[48:51], v[128:131]
  ds_read_b64_tr_b16 v[72:73], v21 offset:55488
  v_mfma_f32_16x16x32_bf16 v[132:135], v[84:87], a[52:55], v[132:135]
  s_waitcnt lgkmcnt(3)
  ds_read_b64_tr_b16 v[74:75], v21 offset:59072
  v_mfma_f32_16x16x32_bf16 v[136:139], v[88:91], a[48:51], v[136:139]
  ds_read_b64_tr_b16 v[76:77], v21 offset:62464
  v_mfma_f32_16x16x32_bf16 v[140:143], v[88:91], a[52:55], v[140:143]
  s_waitcnt lgkmcnt(3)
  ds_read_b64_tr_b16 v[78:79], v22 offset:512
  v_mfma_f32_16x16x32_bf16 v[144:147], v[92:95], a[48:51], v[144:147]
  ds_read_b64_tr_b16 v[80:81], v21 offset:62496
  v_mfma_f32_16x16x32_bf16 v[148:151], v[92:95], a[52:55], v[148:151]
  s_waitcnt lgkmcnt(3)
  ds_read_b64_tr_b16 v[82:83], v22 offset:544
  v_mfma_f32_16x16x32_bf16 v[152:155], v[72:75], a[48:51], v[152:155]
  ds_read_b64_tr_b16 v[84:85], v21 offset:62528
  v_mfma_f32_16x16x32_bf16 v[156:159], v[72:75], a[52:55], v[156:159]
  s_waitcnt vmcnt(24) lgkmcnt(3)
  ds_read_b64_tr_b16 v[86:87], v22 offset:576
  v_mfma_f32_16x16x32_bf16 v[104:107], v[76:79], a[56:59], v[104:107]
  s_waitcnt vmcnt(23)
  ds_read_b64_tr_b16 v[88:89], v21 offset:62560
  v_mfma_f32_16x16x32_bf16 v[108:111], v[76:79], a[60:63], v[108:111]
  s_waitcnt lgkmcnt(3)
  ds_read_b64_tr_b16 v[90:91], v22 offset:608
  v_mfma_f32_16x16x32_bf16 v[112:115], v[80:83], a[56:59], v[112:115]
  ds_read_b64_tr_b16 v[92:93], v21 offset:62592
  v_mfma_f32_16x16x32_bf16 v[116:119], v[80:83], a[60:63], v[116:119]
  s_waitcnt lgkmcnt(3)
  ds_read_b64_tr_b16 v[94:95], v22 offset:640
  v_mfma_f32_16x16x32_bf16 v[120:123], v[84:87], a[56:59], v[120:123]
  ds_read_b64_tr_b16 v[72:73], v21 offset:62624
  v_mfma_f32_16x16x32_bf16 v[124:127], v[84:87], a[60:63], v[124:127]
  s_waitcnt lgkmcnt(3)
  ds_read_b64_tr_b16 v[74:75], v22 offset:672
  v_mfma_f32_16x16x32_bf16 v[128:131], v[88:91], a[56:59], v[128:131]
  ds_read_b64_tr_b16 v[76:77], v21 offset:62656
  v_mfma_f32_16x16x32_bf16 v[132:135], v[88:91], a[60:63], v[132:135]
  s_waitcnt lgkmcnt(3)
  ds_read_b64_tr_b16 v[78:79], v22 offset:704
  v_mfma_f32_16x16x32_bf16 v[136:139], v[92:95], a[56:59], v[136:139]
  ds_read_b64_tr_b16 v[80:81], v21 offset:12288
  v_mfma_f32_16x16x32_bf16 v[140:143], v[92:95], a[60:63], v[140:143]
  s_waitcnt lgkmcnt(3)
  ds_read_b64_tr_b16 v[82:83], v21 offset:15872
  v_mfma_f32_16x16x32_bf16 v[144:147], v[72:75], a[56:59], v[144:147]
  ds_read_b64_tr_b16 v[84:85], v21 offset:12320
  v_mfma_f32_16x16x32_bf16 v[148:151], v[72:75], a[60:63], v[148:151]
  s_waitcnt lgkmcnt(3)
  ds_read_b64_tr_b16 v[86:87], v21 offset:15904
  v_mfma_f32_16x16x32_bf16 v[152:155], v[76:79], a[56:59], v[152:155]
  ds_read_b64_tr_b16 v[88:89], v21 offset:12352
  v_mfma_f32_16x16x32_bf16 v[156:159], v[76:79], a[60:63], v[156:159]
  s_waitcnt vmcnt(22) lgkmcnt(3)
  ds_read_b64_tr_b16 v[90:91], v21 offset:15936
  v_mfma_f32_16x16x32_bf16 v[104:107], v[80:83], a[64:67], v[104:107]
  s_waitcnt vmcnt(21)
  ds_read_b64_tr_b16 v[92:93], v21 offset:12384
  v_mfma_f32_16x16x32_bf16 v[108:111], v[80:83], a[68:71], v[108:111]
  s_waitcnt lgkmcnt(3)
  ds_read_b64_tr_b16 v[94:95], v21 offset:15968
  v_mfma_f32_16x16x32_bf16 v[112:115], v[84:87], a[64:67], v[112:115]
  ds_read_b64_tr_b16 v[72:73], v21 offset:12416
  v_mfma_f32_16x16x32_bf16 v[116:119], v[84:87], a[68:71], v[116:119]
  s_waitcnt lgkmcnt(3)
  ds_read_b64_tr_b16 v[74:75], v21 offset:16000
  v_mfma_f32_16x16x32_bf16 v[120:123], v[88:91], a[64:67], v[120:123]
  ds_read_b64_tr_b16 v[76:77], v21 offset:12448
  v_mfma_f32_16x16x32_bf16 v[124:127], v[88:91], a[68:71], v[124:127]
  s_waitcnt lgkmcnt(3)
  ds_read_b64_tr_b16 v[78:79], v21 offset:16032
  v_mfma_f32_16x16x32_bf16 v[128:131], v[92:95], a[64:67], v[128:131]
  ds_read_b64_tr_b16 v[80:81], v21 offset:12480
  v_mfma_f32_16x16x32_bf16 v[132:135], v[92:95], a[68:71], v[132:135]
  s_waitcnt lgkmcnt(3)
  ds_read_b64_tr_b16 v[82:83], v21 offset:16064
  v_mfma_f32_16x16x32_bf16 v[136:139], v[72:75], a[64:67], v[136:139]
  ds_read_b64_tr_b16 v[84:85], v21 offset:19456
  v_mfma_f32_16x16x32_bf16 v[140:143], v[72:75], a[68:71], v[140:143]
  s_waitcnt lgkmcnt(3)
  ds_read_b64_tr_b16 v[86:87], v21 offset:23040
  v_mfma_f32_16x16x32_bf16 v[144:147], v[76:79], a[64:67], v[144:147]
  ds_read_b64_tr_b16 v[88:89], v21 offset:19488
  v_mfma_f32_16x16x32_bf16 v[148:151], v[76:79], a[68:71], v[148:151]
  s_waitcnt lgkmcnt(3)
  ds_read_b64_tr_b16 v[90:91], v21 offset:23072
  v_mfma_f32_16x16x32_bf16 v[152:155], v[80:83], a[64:67], v[152:155]
  ds_read_b64_tr_b16 v[92:93], v21 offset:19520
  v_mfma_f32_16x16x32_bf16 v[156:159], v[80:83], a[68:71], v[156:159]
  s_waitcnt vmcnt(20) lgkmcnt(3)
  ds_read_b64_tr_b16 v[94:95], v21 offset:23104
  v_mfma_f32_16x16x32_bf16 v[104:107], v[84:87], a[72:75], v[104:107]
  s_waitcnt vmcnt(19)
  ds_read_b64_tr_b16 v[72:73], v21 offset:19552
  s_add_u32 m0, s46, 2048
  s_add_u32 s52, s47, 294912
  buffer_load_dwordx4 v36, s[24:27], s52 offen lds
  v_mfma_f32_16x16x32_bf16 v[108:111], v[84:87], a[76:79], v[108:111]
  s_waitcnt lgkmcnt(3)
  ds_read_b64_tr_b16 v[74:75], v21 offset:23136
  v_mfma_f32_16x16x32_bf16 v[112:115], v[88:91], a[72:75], v[112:115]
  ds_read_b64_tr_b16 v[76:77], v21 offset:19584
  v_mfma_f32_16x16x32_bf16 v[116:119], v[88:91], a[76:79], v[116:119]
  s_waitcnt lgkmcnt(3)
  ds_read_b64_tr_b16 v[78:79], v21 offset:23168
  s_lshr_b32 s55, s101, 13
  s_mul_i32 s55, s55, 5120
  s_add_u32 s55, s55, s58
  s_add_u32 s55, s55, 33685504
  s_mov_b32 exec_lo, 0xffffffff
  s_mov_b32 exec_hi, 0xff
  buffer_load_dword v102, v45, s[28:31], s55 offen
  s_mov_b64 exec, -1
  v_mfma_f32_16x16x32_bf16 v[120:123], v[92:95], a[72:75], v[120:123]
  ds_read_b64_tr_b16 v[80:81], v21 offset:19616
  v_mfma_f32_16x16x32_bf16 v[124:127], v[92:95], a[76:79], v[124:127]
  s_waitcnt lgkmcnt(3)
  ds_read_b64_tr_b16 v[82:83], v21 offset:23200
  v_mfma_f32_16x16x32_bf16 v[128:131], v[72:75], a[72:75], v[128:131]
  ds_read_b64_tr_b16 v[84:85], v21 offset:19648
  v_mfma_f32_16x16x32_bf16 v[132:135], v[72:75], a[76:79], v[132:135]
  s_waitcnt lgkmcnt(3)
  ds_read_b64_tr_b16 v[86:87], v21 offset:23232
  s_add_u32 m0, s46, 6144
  s_add_u32 s52, s47, 1212416
  buffer_load_dwordx4 v36, s[24:27], s52 offen lds
  v_mfma_f32_16x16x32_bf16 v[136:139], v[76:79], a[72:75], v[136:139]
  ds_read_b64_tr_b16 v[88:89], v21 offset:26624
  v_mfma_f32_16x16x32_bf16 v[140:143], v[76:79], a[76:79], v[140:143]
  s_waitcnt lgkmcnt(3)
  ds_read_b64_tr_b16 v[90:91], v21 offset:30208
  v_mfma_f32_16x16x32_bf16 v[144:147], v[80:83], a[72:75], v[144:147]
  ds_read_b64_tr_b16 v[92:93], v21 offset:26656
  v_mfma_f32_16x16x32_bf16 v[148:151], v[80:83], a[76:79], v[148:151]
  s_waitcnt lgkmcnt(3)
  ds_read_b64_tr_b16 v[94:95], v21 offset:30240
  v_mfma_f32_16x16x32_bf16 v[152:155], v[84:87], a[72:75], v[152:155]
  ds_read_b64_tr_b16 v[72:73], v21 offset:26688
  v_mfma_f32_16x16x32_bf16 v[156:159], v[84:87], a[76:79], v[156:159]
  s_waitcnt vmcnt(21) lgkmcnt(3)
  ds_read_b64_tr_b16 v[74:75], v21 offset:30272
  v_mfma_f32_16x16x32_bf16 v[104:107], v[88:91], a[80:83], v[104:107]
  s_waitcnt vmcnt(20)
  ds_read_b64_tr_b16 v[76:77], v21 offset:26720
  s_add_u32 m0, s46, 10240
  s_add_u32 s52, s47, 327680
  buffer_load_dwordx4 v36, s[24:27], s52 offen lds
  v_mfma_f32_16x16x32_bf16 v[108:111], v[88:91], a[84:87], v[108:111]
  s_waitcnt lgkmcnt(3)
  ds_read_b64_tr_b16 v[78:79], v21 offset:30304
  v_mfma_f32_16x16x32_bf16 v[112:115], v[92:95], a[80:83], v[112:115]
  ds_read_b64_tr_b16 v[80:81], v21 offset:26752
  v_mfma_f32_16x16x32_bf16 v[116:119], v[92:95], a[84:87], v[116:119]
  s_waitcnt lgkmcnt(3)
  ds_read_b64_tr_b16 v[82:83], v21 offset:30336
  v_mfma_f32_16x16x32_bf16 v[120:123], v[72:75], a[80:83], v[120:123]
  ds_read_b64_tr_b16 v[84:85], v21 offset:26784
  v_mfma_f32_16x16x32_bf16 v[124:127], v[72:75], a[84:87], v[124:127]
  s_waitcnt lgkmcnt(3)
  ds_read_b64_tr_b16 v[86:87], v21 offset:30368
  v_mfma_f32_16x16x32_bf16 v[128:131], v[76:79], a[80:83], v[128:131]
  ds_read_b64_tr_b16 v[88:89], v21 offset:26816
  v_mfma_f32_16x16x32_bf16 v[132:135], v[76:79], a[84:87], v[132:135]
  s_waitcnt lgkmcnt(3)
  ds_read_b64_tr_b16 v[90:91], v21 offset:30400
  s_add_u32 m0, s46, 14336
  s_add_u32 s52, s47, 1245184
  buffer_load_dwordx4 v36, s[24:27], s52 offen lds
  v_mfma_f32_16x16x32_bf16 v[136:139], v[80:83], a[80:83], v[136:139]
  ds_read_b64_tr_b16 v[92:93], v21 offset:33792
  v_mfma_f32_16x16x32_bf16 v[140:143], v[80:83], a[84:87], v[140:143]
  s_waitcnt lgkmcnt(3)
  ds_read_b64_tr_b16 v[94:95], v21 offset:37376
  v_mfma_f32_16x16x32_bf16 v[144:147], v[84:87], a[80:83], v[144:147]
  ds_read_b64_tr_b16 v[72:73], v21 offset:33824
  v_mfma_f32_16x16x32_bf16 v[148:151], v[84:87], a[84:87], v[148:151]
  s_waitcnt lgkmcnt(3)
  ds_read_b64_tr_b16 v[74:75], v21 offset:37408
  v_mfma_f32_16x16x32_bf16 v[152:155], v[88:91], a[80:83], v[152:155]
  ds_read_b64_tr_b16 v[76:77], v21 offset:33856
  v_mfma_f32_16x16x32_bf16 v[156:159], v[88:91], a[84:87], v[156:159]
  s_waitcnt vmcnt(21) lgkmcnt(3)
  ds_read_b64_tr_b16 v[78:79], v21 offset:37440
  v_mfma_f32_16x16x32_bf16 v[104:107], v[92:95], a[88:91], v[104:107]
  s_waitcnt vmcnt(20)
  ds_read_b64_tr_b16 v[80:81], v21 offset:33888
  s_add_u32 m0, s46, 18432
  s_add_u32 s52, s47, 360448
  buffer_load_dwordx4 v36, s[24:27], s52 offen lds
  v_mfma_f32_16x16x32_bf16 v[108:111], v[92:95], a[92:95], v[108:111]
  s_waitcnt lgkmcnt(3)
  ds_read_b64_tr_b16 v[82:83], v21 offset:37472
  v_mfma_f32_16x16x32_bf16 v[112:115], v[72:75], a[88:91], v[112:115]
  ds_read_b64_tr_b16 v[84:85], v21 offset:33920
  v_mfma_f32_16x16x32_bf16 v[116:119], v[72:75], a[92:95], v[116:119]
  s_waitcnt lgkmcnt(3)
  ds_read_b64_tr_b16 v[86:87], v21 offset:37504
  v_mfma_f32_16x16x32_bf16 v[120:123], v[76:79], a[88:91], v[120:123]
  ds_read_b64_tr_b16 v[88:89], v21 offset:33952
  v_mfma_f32_16x16x32_bf16 v[124:127], v[76:79], a[92:95], v[124:127]
  s_waitcnt lgkmcnt(3)
  ds_read_b64_tr_b16 v[90:91], v21 offset:37536
  v_mfma_f32_16x16x32_bf16 v[128:131], v[80:83], a[88:91], v[128:131]
  ds_read_b64_tr_b16 v[92:93], v21 offset:33984
  v_mfma_f32_16x16x32_bf16 v[132:135], v[80:83], a[92:95], v[132:135]
  s_waitcnt lgkmcnt(3)
  ds_read_b64_tr_b16 v[94:95], v21 offset:37568
  s_add_u32 m0, s46, 22528
  s_add_u32 s52, s47, 1277952
  buffer_load_dwordx4 v36, s[24:27], s52 offen lds
  v_mfma_f32_16x16x32_bf16 v[136:139], v[84:87], a[88:91], v[136:139]
  s_waitcnt vmcnt(7)
  s_barrier
  ds_read_b64_tr_b16 v[72:73], v20 offset:49152
  v_mfma_f32_16x16x32_bf16 v[140:143], v[84:87], a[92:95], v[140:143]
  s_waitcnt lgkmcnt(3)
  ds_read_b64_tr_b16 v[74:75], v20 offset:52736
  v_mfma_f32_16x16x32_bf16 v[144:147], v[88:91], a[88:91], v[144:147]
  ds_read_b64_tr_b16 v[76:77], v20 offset:49184
  v_mfma_f32_16x16x32_bf16 v[148:151], v[88:91], a[92:95], v[148:151]
  s_waitcnt lgkmcnt(3)
  ds_read_b64_tr_b16 v[78:79], v20 offset:52768
  v_mfma_f32_16x16x32_bf16 v[152:155], v[92:95], a[88:91], v[152:155]
  ds_read_b64_tr_b16 v[80:81], v20 offset:49216
  v_mfma_f32_16x16x32_bf16 v[156:159], v[92:95], a[92:95], v[156:159]
  s_waitcnt lgkmcnt(3)
  ds_read_b64_tr_b16 v[82:83], v20 offset:52800
  v_mfma_f32_16x16x32_bf16 v[104:107], v[72:75], a[0:3], v[104:107]
  ds_read_b64_tr_b16 v[84:85], v20 offset:49248
  s_add_u32 m0, s46, 26624
  s_add_u32 s52, s47, 229376
  buffer_load_dwordx4 v36, s[24:27], s52 offen lds
  v_mfma_f32_16x16x32_bf16 v[108:111], v[72:75], a[4:7], v[108:111]
  s_waitcnt lgkmcnt(3)
  ds_read_b64_tr_b16 v[86:87], v20 offset:52832
  v_mfma_f32_16x16x32_bf16 v[112:115], v[76:79], a[0:3], v[112:115]
  ds_read_b64_tr_b16 v[88:89], v20 offset:49280
  v_mfma_f32_16x16x32_bf16 v[116:119], v[76:79], a[4:7], v[116:119]
  s_waitcnt lgkmcnt(3)
  ds_read_b64_tr_b16 v[90:91], v20 offset:52864
  v_mfma_f32_16x16x32_bf16 v[120:123], v[80:83], a[0:3], v[120:123]
  ds_read_b64_tr_b16 v[92:93], v20 offset:49312
  v_mfma_f32_16x16x32_bf16 v[124:127], v[80:83], a[4:7], v[124:127]
  s_waitcnt lgkmcnt(3)
  ds_read_b64_tr_b16 v[94:95], v20 offset:52896
  v_mfma_f32_16x16x32_bf16 v[128:131], v[84:87], a[0:3], v[128:131]
  ds_read_b64_tr_b16 v[72:73], v20 offset:49344
  v_mfma_f32_16x16x32_bf16 v[132:135], v[84:87], a[4:7], v[132:135]
  s_waitcnt lgkmcnt(3)
  ds_read_b64_tr_b16 v[74:75], v20 offset:52928
  s_add_u32 m0, s46, 30720
  s_add_u32 s52, s47, 1146880
  buffer_load_dwordx4 v36, s[24:27], s52 offen lds
  v_mfma_f32_16x16x32_bf16 v[136:139], v[88:91], a[0:3], v[136:139]
  ds_read_b64_tr_b16 v[76:77], v20 offset:56320
  v_mfma_f32_16x16x32_bf16 v[140:143], v[88:91], a[4:7], v[140:143]
  s_waitcnt lgkmcnt(3)
  ds_read_b64_tr_b16 v[78:79], v20 offset:59904
  v_mfma_f32_16x16x32_bf16 v[144:147], v[92:95], a[0:3], v[144:147]
  ds_read_b64_tr_b16 v[80:81], v20 offset:56352
  v_mfma_f32_16x16x32_bf16 v[148:151], v[92:95], a[4:7], v[148:151]
  s_waitcnt lgkmcnt(3)
  ds_read_b64_tr_b16 v[82:83], v20 offset:59936
  v_mfma_f32_16x16x32_bf16 v[152:155], v[72:75], a[0:3], v[152:155]
  ds_read_b64_tr_b16 v[84:85], v20 offset:56384
  v_mfma_f32_16x16x32_bf16 v[156:159], v[72:75], a[4:7], v[156:159]
  s_waitcnt lgkmcnt(3)
  ds_read_b64_tr_b16 v[86:87], v20 offset:59968
  v_mfma_f32_16x16x32_bf16 v[104:107], v[76:79], a[8:11], v[104:107]
  ds_read_b64_tr_b16 v[88:89], v20 offset:56416
  s_add_u32 m0, s46, 34816
  s_add_u32 s52, s47, 393216
  buffer_load_dwordx4 v36, s[24:27], s52 offen lds
  v_mfma_f32_16x16x32_bf16 v[108:111], v[76:79], a[12:15], v[108:111]
  s_waitcnt lgkmcnt(3)
  ds_read_b64_tr_b16 v[90:91], v20 offset:60000
  v_mfma_f32_16x16x32_bf16 v[112:115], v[80:83], a[8:11], v[112:115]
  ds_read_b64_tr_b16 v[92:93], v20 offset:56448
  v_mfma_f32_16x16x32_bf16 v[116:119], v[80:83], a[12:15], v[116:119]
  s_waitcnt lgkmcnt(3)
  ds_read_b64_tr_b16 v[94:95], v20 offset:60032
  v_mfma_f32_16x16x32_bf16 v[120:123], v[84:87], a[8:11], v[120:123]
  ds_read_b64_tr_b16 v[72:73], v20 offset:56480
  v_mfma_f32_16x16x32_bf16 v[124:127], v[84:87], a[12:15], v[124:127]
  s_waitcnt lgkmcnt(3)
  ds_read_b64_tr_b16 v[74:75], v20 offset:60064
  v_mfma_f32_16x16x32_bf16 v[128:131], v[88:91], a[8:11], v[128:131]
  ds_read_b64_tr_b16 v[76:77], v20 offset:56512
  v_mfma_f32_16x16x32_bf16 v[132:135], v[88:91], a[12:15], v[132:135]
  s_waitcnt lgkmcnt(3)
  ds_read_b64_tr_b16 v[78:79], v20 offset:60096
  s_add_u32 m0, s46, 38912
  s_add_u32 s52, s47, 1310720
  buffer_load_dwordx4 v36, s[24:27], s52 offen lds
  v_mfma_f32_16x16x32_bf16 v[136:139], v[92:95], a[8:11], v[136:139]
  ds_read_b64_tr_b16 v[80:81], v20 offset:63488
  v_mfma_f32_16x16x32_bf16 v[140:143], v[92:95], a[12:15], v[140:143]
  s_waitcnt lgkmcnt(3)
  ds_read_b64_tr_b16 v[82:83], v21 offset:1536
  v_mfma_f32_16x16x32_bf16 v[144:147], v[72:75], a[8:11], v[144:147]
  ds_read_b64_tr_b16 v[84:85], v20 offset:63520
  v_mfma_f32_16x16x32_bf16 v[148:151], v[72:75], a[12:15], v[148:151]
  s_waitcnt lgkmcnt(3)
  ds_read_b64_tr_b16 v[86:87], v21 offset:1568
  v_mfma_f32_16x16x32_bf16 v[152:155], v[76:79], a[8:11], v[152:155]
  ds_read_b64_tr_b16 v[88:89], v20 offset:63552
  v_mfma_f32_16x16x32_bf16 v[156:159], v[76:79], a[12:15], v[156:159]
  s_waitcnt lgkmcnt(3)
  ds_read_b64_tr_b16 v[90:91], v21 offset:1600
  v_mfma_f32_16x16x32_bf16 v[104:107], v[80:83], a[16:19], v[104:107]
  ds_read_b64_tr_b16 v[92:93], v20 offset:63584
  v_mfma_f32_16x16x32_bf16 v[108:111], v[80:83], a[20:23], v[108:111]
  s_waitcnt lgkmcnt(3)
  ds_read_b64_tr_b16 v[94:95], v21 offset:1632
  v_mfma_f32_16x16x32_bf16 v[112:115], v[84:87], a[16:19], v[112:115]
  ds_read_b64_tr_b16 v[72:73], v20 offset:63616
  v_mfma_f32_16x16x32_bf16 v[116:119], v[84:87], a[20:23], v[116:119]
  s_waitcnt lgkmcnt(3)
  ds_read_b64_tr_b16 v[74:75], v21 offset:1664
  v_mfma_f32_16x16x32_bf16 v[120:123], v[88:91], a[16:19], v[120:123]
  ds_read_b64_tr_b16 v[76:77], v20 offset:63648
  v_mfma_f32_16x16x32_bf16 v[124:127], v[88:91], a[20:23], v[124:127]
  s_waitcnt lgkmcnt(3)
  ds_read_b64_tr_b16 v[78:79], v21 offset:1696
  v_mfma_f32_16x16x32_bf16 v[128:131], v[92:95], a[16:19], v[128:131]
  ds_read_b64_tr_b16 v[80:81], v20 offset:63680
  v_mfma_f32_16x16x32_bf16 v[132:135], v[92:95], a[20:23], v[132:135]
  s_waitcnt lgkmcnt(3)
  ds_read_b64_tr_b16 v[82:83], v21 offset:1728
  v_mfma_f32_16x16x32_bf16 v[136:139], v[72:75], a[16:19], v[136:139]
  ds_read_b64_tr_b16 v[84:85], v21 offset:5120
  v_mfma_f32_16x16x32_bf16 v[140:143], v[72:75], a[20:23], v[140:143]
  s_waitcnt lgkmcnt(3)
  ds_read_b64_tr_b16 v[86:87], v21 offset:8704
  v_mfma_f32_16x16x32_bf16 v[144:147], v[76:79], a[16:19], v[144:147]
  ds_read_b64_tr_b16 v[88:89], v21 offset:5152
  v_mfma_f32_16x16x32_bf16 v[148:151], v[76:79], a[20:23], v[148:151]
  s_waitcnt lgkmcnt(3)
  ds_read_b64_tr_b16 v[90:91], v21 offset:8736
  v_mfma_f32_16x16x32_bf16 v[152:155], v[80:83], a[16:19], v[152:155]
  ds_read_b64_tr_b16 v[92:93], v21 offset:5184
  v_mfma_f32_16x16x32_bf16 v[156:159], v[80:83], a[20:23], v[156:159]
  s_waitcnt lgkmcnt(3)
  ds_read_b64_tr_b16 v[94:95], v21 offset:8768
  v_mfma_f32_16x16x32_bf16 v[104:107], v[84:87], a[24:27], v[104:107]
  ds_read_b64_tr_b16 v[72:73], v21 offset:5216
  v_mfma_f32_16x16x32_bf16 v[108:111], v[84:87], a[28:31], v[108:111]
  s_waitcnt lgkmcnt(3)
  ds_read_b64_tr_b16 v[74:75], v21 offset:8800
  v_mfma_f32_16x16x32_bf16 v[112:115], v[88:91], a[24:27], v[112:115]
  ds_read_b64_tr_b16 v[76:77], v21 offset:5248
  v_mfma_f32_16x16x32_bf16 v[116:119], v[88:91], a[28:31], v[116:119]
  s_waitcnt lgkmcnt(3)
  ds_read_b64_tr_b16 v[78:79], v21 offset:8832
  v_mfma_f32_16x16x32_bf16 v[120:123], v[92:95], a[24:27], v[120:123]
  ds_read_b64_tr_b16 v[80:81], v21 offset:5280
  v_mfma_f32_16x16x32_bf16 v[124:127], v[92:95], a[28:31], v[124:127]
  s_waitcnt lgkmcnt(3)
  ds_read_b64_tr_b16 v[82:83], v21 offset:8864
  v_mfma_f32_16x16x32_bf16 v[128:131], v[72:75], a[24:27], v[128:131]
  ds_read_b64_tr_b16 v[84:85], v21 offset:5312
  v_mfma_f32_16x16x32_bf16 v[132:135], v[72:75], a[28:31], v[132:135]
  s_waitcnt lgkmcnt(3)
  ds_read_b64_tr_b16 v[86:87], v21 offset:8896
  v_mfma_f32_16x16x32_bf16 v[136:139], v[76:79], a[24:27], v[136:139]
  v_mfma_f32_16x16x32_bf16 v[140:143], v[76:79], a[28:31], v[140:143]
  s_waitcnt lgkmcnt(2)
  v_mfma_f32_16x16x32_bf16 v[144:147], v[80:83], a[24:27], v[144:147]
  v_mfma_f32_16x16x32_bf16 v[148:151], v[80:83], a[28:31], v[148:151]
  s_waitcnt lgkmcnt(0)
  v_mfma_f32_16x16x32_bf16 v[152:155], v[84:87], a[24:27], v[152:155]
  v_mfma_f32_16x16x32_bf16 v[156:159], v[84:87], a[28:31], v[156:159]
  s_barrier
  s_cmp_lg_u32 s3, 0
  s_nop 5
  s_cbranch_scc1 cs1_34
  s_lshl_b32 s53, s6, 5
  s_add_u32 s54, s6, 4
  s_min_u32 s54, s54, 6
  s_lshl_b32 s54, s54, 5
  v_add_u32 v216, s53, v20
  v_add_u32 v219, s54, v20
  v_add_u32 v217, s53, v21
  v_add_u32 v220, s54, v21
  v_add_u32 v218, s53, v22
  v_add_u32 v221, s54, v22
  ds_read_b64_tr_b16 v[72:73], v218 offset:4096
  ds_read_b64_tr_b16 v[74:75], v218 offset:7680
  ds_read_b64_tr_b16 v[76:77], v221 offset:4096
  ds_read_b64_tr_b16 v[78:79], v221 offset:7680
  ds_read_b64_tr_b16 v[80:81], v218 offset:11264
  ds_read_b64_tr_b16 v[82:83], v218 offset:14848
  s_waitcnt lgkmcnt(4)
  v_mfma_f32_16x16x32_bf16 v[208:211], v[72:75], v[10:13], 0
  s_waitcnt lgkmcnt(2)
  ds_read_b64_tr_b16 v[84:85], v221 offset:11264
  ds_read_b64_tr_b16 v[86:87], v221 offset:14848
  v_mfma_f32_16x16x32_bf16 v[212:215], v[76:79], v[10:13], 0
  s_waitcnt lgkmcnt(2)
  ds_read_b64_tr_b16 v[88:89], v218 offset:18432
  ds_read_b64_tr_b16 v[90:91], v218 offset:22016
  v_mfma_f32_16x16x32_bf16 v[208:211], v[80:83], v[10:13], v[208:211]
  s_waitcnt lgkmcnt(2)
  ds_read_b64_tr_b16 v[92:93], v221 offset:18432
  ds_read_b64_tr_b16 v[94:95], v221 offset:22016
  v_mfma_f32_16x16x32_bf16 v[212:215], v[84:87], v[10:13], v[212:215]
  s_waitcnt lgkmcnt(2)
  ds_read_b64_tr_b16 v[72:73], v218 offset:25600
  ds_read_b64_tr_b16 v[74:75], v218 offset:29184
  v_mfma_f32_16x16x32_bf16 v[208:211], v[88:91], v[10:13], v[208:211]
  s_waitcnt lgkmcnt(2)
  ds_read_b64_tr_b16 v[76:77], v221 offset:25600
  ds_read_b64_tr_b16 v[78:79], v221 offset:29184
  v_mfma_f32_16x16x32_bf16 v[212:215], v[92:95], v[10:13], v[212:215]
  s_waitcnt lgkmcnt(2)
  ds_read_b64_tr_b16 v[80:81], v217 offset:40960
  ds_read_b64_tr_b16 v[82:83], v217 offset:44544
  v_mfma_f32_16x16x32_bf16 v[208:211], v[72:75], v[10:13], v[208:211]
  s_waitcnt lgkmcnt(2)
  ds_read_b64_tr_b16 v[84:85], v220 offset:40960
  ds_read_b64_tr_b16 v[86:87], v220 offset:44544
  v_mfma_f32_16x16x32_bf16 v[212:215], v[76:79], v[10:13], v[212:215]
  s_waitcnt lgkmcnt(2)
  ds_read_b64_tr_b16 v[88:89], v217 offset:48128
  ds_read_b64_tr_b16 v[90:91], v217 offset:51712
  v_mfma_f32_16x16x32_bf16 v[208:211], v[80:83], v[10:13], v[208:211]
  s_waitcnt lgkmcnt(2)
  ds_read_b64_tr_b16 v[92:93], v220 offset:48128
  ds_read_b64_tr_b16 v[94:95], v220 offset:51712
  v_mfma_f32_16x16x32_bf16 v[212:215], v[84:87], v[10:13], v[212:215]
  s_waitcnt lgkmcnt(2)
  ds_read_b64_tr_b16 v[72:73], v217 offset:55296
  ds_read_b64_tr_b16 v[74:75], v217 offset:58880
  v_mfma_f32_16x16x32_bf16 v[208:211], v[88:91], v[10:13], v[208:211]
  s_waitcnt lgkmcnt(2)
  ds_read_b64_tr_b16 v[76:77], v220 offset:55296
  ds_read_b64_tr_b16 v[78:79], v220 offset:58880
  v_mfma_f32_16x16x32_bf16 v[212:215], v[92:95], v[10:13], v[212:215]
  s_waitcnt lgkmcnt(2)
  ds_read_b64_tr_b16 v[80:81], v217 offset:62464
  ds_read_b64_tr_b16 v[82:83], v218 offset:512
  v_mfma_f32_16x16x32_bf16 v[208:211], v[72:75], v[10:13], v[208:211]
  s_waitcnt lgkmcnt(2)
  ds_read_b64_tr_b16 v[84:85], v220 offset:62464
  ds_read_b64_tr_b16 v[86:87], v221 offset:512
  v_mfma_f32_16x16x32_bf16 v[212:215], v[76:79], v[10:13], v[212:215]
  s_waitcnt lgkmcnt(2)
  ds_read_b64_tr_b16 v[88:89], v217 offset:12288
  ds_read_b64_tr_b16 v[90:91], v217 offset:15872
  v_mfma_f32_16x16x32_bf16 v[208:211], v[80:83], v[10:13], v[208:211]
  s_waitcnt lgkmcnt(2)
  ds_read_b64_tr_b16 v[92:93], v220 offset:12288
  ds_read_b64_tr_b16 v[94:95], v220 offset:15872
  v_mfma_f32_16x16x32_bf16 v[212:215], v[84:87], v[10:13], v[212:215]
  s_waitcnt lgkmcnt(2)
  ds_read_b64_tr_b16 v[72:73], v217 offset:19456
  ds_read_b64_tr_b16 v[74:75], v217 offset:23040
  v_mfma_f32_16x16x32_bf16 v[208:211], v[88:91], v[10:13], v[208:211]
  s_waitcnt lgkmcnt(2)
  ds_read_b64_tr_b16 v[76:77], v220 offset:19456
  ds_read_b64_tr_b16 v[78:79], v220 offset:23040
  v_mfma_f32_16x16x32_bf16 v[212:215], v[92:95], v[10:13], v[212:215]
  s_waitcnt lgkmcnt(2)
  ds_read_b64_tr_b16 v[80:81], v217 offset:26624
  ds_read_b64_tr_b16 v[82:83], v217 offset:30208
  v_mfma_f32_16x16x32_bf16 v[208:211], v[72:75], v[10:13], v[208:211]
  s_waitcnt lgkmcnt(2)
  ds_read_b64_tr_b16 v[84:85], v220 offset:26624
  ds_read_b64_tr_b16 v[86:87], v220 offset:30208
  v_mfma_f32_16x16x32_bf16 v[212:215], v[76:79], v[10:13], v[212:215]
  s_waitcnt lgkmcnt(2)
  ds_read_b64_tr_b16 v[88:89], v217 offset:33792
  ds_read_b64_tr_b16 v[90:91], v217 offset:37376
  v_mfma_f32_16x16x32_bf16 v[208:211], v[80:83], v[10:13], v[208:211]
  s_waitcnt lgkmcnt(2)
  ds_read_b64_tr_b16 v[92:93], v220 offset:33792
  ds_read_b64_tr_b16 v[94:95], v220 offset:37376
  v_mfma_f32_16x16x32_bf16 v[212:215], v[84:87], v[10:13], v[212:215]
  s_waitcnt lgkmcnt(2)
  ds_read_b64_tr_b16 v[72:73], v216 offset:49152
  ds_read_b64_tr_b16 v[74:75], v216 offset:52736
  v_mfma_f32_16x16x32_bf16 v[208:211], v[88:91], v[10:13], v[208:211]
  s_waitcnt lgkmcnt(2)
  ds_read_b64_tr_b16 v[76:77], v219 offset:49152
  ds_read_b64_tr_b16 v[78:79], v219 offset:52736
  v_mfma_f32_16x16x32_bf16 v[212:215], v[92:95], v[10:13], v[212:215]
  s_waitcnt lgkmcnt(2)
  ds_read_b64_tr_b16 v[80:81], v216 offset:56320
  ds_read_b64_tr_b16 v[82:83], v216 offset:59904
  v_mfma_f32_16x16x32_bf16 v[208:211], v[72:75], v[10:13], v[208:211]
  s_waitcnt lgkmcnt(2)
  ds_read_b64_tr_b16 v[84:85], v219 offset:56320
  ds_read_b64_tr_b16 v[86:87], v219 offset:59904
  v_mfma_f32_16x16x32_bf16 v[212:215], v[76:79], v[10:13], v[212:215]
  s_waitcnt lgkmcnt(2)
  ds_read_b64_tr_b16 v[88:89], v216 offset:63488
  ds_read_b64_tr_b16 v[90:91], v217 offset:1536
  v_mfma_f32_16x16x32_bf16 v[208:211], v[80:83], v[10:13], v[208:211]
  s_waitcnt lgkmcnt(2)
  ds_read_b64_tr_b16 v[92:93], v219 offset:63488
  ds_read_b64_tr_b16 v[94:95], v220 offset:1536
  v_mfma_f32_16x16x32_bf16 v[212:215], v[84:87], v[10:13], v[212:215]
  s_waitcnt lgkmcnt(2)
  ds_read_b64_tr_b16 v[72:73], v217 offset:5120
  ds_read_b64_tr_b16 v[74:75], v217 offset:8704
  v_mfma_f32_16x16x32_bf16 v[208:211], v[88:91], v[10:13], v[208:211]
  s_waitcnt lgkmcnt(2)
  ds_read_b64_tr_b16 v[76:77], v220 offset:5120
  ds_read_b64_tr_b16 v[78:79], v220 offset:8704
  v_mfma_f32_16x16x32_bf16 v[212:215], v[92:95], v[10:13], v[212:215]
  s_waitcnt lgkmcnt(2)
  v_mfma_f32_16x16x32_bf16 v[208:211], v[72:75], v[10:13], v[208:211]
  s_waitcnt lgkmcnt(0)
  v_mfma_f32_16x16x32_bf16 v[212:215], v[76:79], v[10:13], v[212:215]
  s_lshl_b32 s53, s53, 1
  s_lshl_b32 s54, s54, 1
  v_add_u32 v216, s53, v44
  v_add_u32 v217, s54, v44
  s_mov_b32 s52, 0x00010001
  s_mov_b32 s53, 0x00010001
  s_mov_b64 exec, s[52:53]
  ds_write_b128 v216, v[208:211] offset:384
  ds_write_b128 v217, v[212:215] offset:384
  s_mov_b64 exec, -1
  s_waitcnt lgkmcnt(0)
  s_barrier
cs1_34:
  ds_read_b128 v[180:183], v44 offset:384
  ds_read_b128 v[208:211], v44 offset:832
  ds_read_b128 v[184:187], v44 offset:448
  ds_read_b128 v[212:215], v44 offset:896
  ds_read_b128 v[188:191], v44 offset:512
  ds_read_b128 v[216:219], v44 offset:960
  ds_read_b128 v[192:195], v44 offset:576
  ds_read_b128 v[220:223], v44 offset:1024
  ds_read_b128 v[196:199], v44 offset:640
  ds_read_b128 v[224:227], v44 offset:1088
  ds_read_b128 v[200:203], v44 offset:704
  ds_read_b128 v[228:231], v44 offset:1152
  ds_read_b128 v[204:207], v44 offset:768
  ds_read_b128 v[232:235], v44 offset:1216
  s_waitcnt lgkmcnt(12)
  v_pk_fma_f32 v[236:237], v[180:181], v[168:169], v[208:209] op_sel:[0,1,0] op_sel_hi:[1,1,1]
  v_pk_fma_f32 v[238:239], v[182:183], v[168:169], v[210:211] op_sel:[0,1,0] op_sel_hi:[1,1,1]
  v_pk_fma_f32 v[240:241], v[180:181], v[170:171], v[208:209] op_sel:[0,1,0] op_sel_hi:[1,1,1]
  v_pk_fma_f32 v[242:243], v[182:183], v[170:171], v[210:211] op_sel:[0,1,0] op_sel_hi:[1,1,1]
  v_pk_fma_f32 v[236:237], v[104:105], v[168:169], v[236:237] op_sel_hi:[1,0,1]
  v_pk_fma_f32 v[238:239], v[106:107], v[168:169], v[238:239] op_sel_hi:[1,0,1]
  v_pk_fma_f32 v[240:241], v[108:109], v[170:171], v[240:241] op_sel_hi:[1,0,1]
  v_pk_fma_f32 v[242:243], v[110:111], v[170:171], v[242:243] op_sel_hi:[1,0,1]
  v_exp_f32 v244, v236
  v_exp_f32 v245, v237
  v_exp_f32 v246, v238
  v_exp_f32 v247, v239
  s_add_u32 m0, s46, 43008
  s_add_u32 s52, s47, 425984
  buffer_load_dwordx4 v36, s[24:27], s52 offen lds
  v_exp_f32 v248, v240
  v_exp_f32 v249, v241
  v_exp_f32 v250, v242
  v_exp_f32 v251, v243
  v_pk_add_f32 v[244:245], v[244:245], s[62:63]
  v_pk_add_f32 v[246:247], v[246:247], s[62:63]
  v_pk_add_f32 v[248:249], v[248:249], s[62:63]
  v_pk_add_f32 v[250:251], v[250:251], s[62:63]
  v_pk_fma_f32 v[244:245], v[244:245], v[244:245], s[62:63]
  s_add_u32 m0, s46, 47104
  s_add_u32 s52, s47, 1343488
  buffer_load_dwordx4 v36, s[24:27], s52 offen lds
  v_pk_fma_f32 v[246:247], v[246:247], v[246:247], s[62:63]
  v_pk_fma_f32 v[248:249], v[248:249], v[248:249], s[62:63]
  v_pk_fma_f32 v[250:251], v[250:251], v[250:251], s[62:63]
  v_rcp_f32 v244, v244
  v_rcp_f32 v245, v245
  v_rcp_f32 v246, v246
  v_rcp_f32 v247, v247
  v_rcp_f32 v248, v248
  v_rcp_f32 v249, v249
  s_add_u32 m0, s46, 51200
  s_add_u32 s52, s47, 458752
  buffer_load_dwordx4 v36, s[24:27], s52 offen lds
  v_rcp_f32 v250, v250
  v_rcp_f32 v251, v251
  v_pk_fma_f32 v[244:245], v[244:245], s[64:65], v[64:65]
  v_pk_fma_f32 v[246:247], v[246:247], s[64:65], v[64:65]
  v_pk_fma_f32 v[248:249], v[248:249], s[64:65], v[64:65]
  v_pk_fma_f32 v[250:251], v[250:251], s[64:65], v[64:65]
  v_pk_mul_f32 v[236:237], v[236:237], v[244:245]
  v_pk_mul_f32 v[238:239], v[238:239], v[246:247]
  v_pk_mul_f32 v[240:241], v[240:241], v[248:249]
  s_add_u32 m0, s46, 55296
  s_add_u32 s52, s47, 1376256
  buffer_load_dwordx4 v36, s[24:27], s52 offen lds
  v_pk_mul_f32 v[242:243], v[242:243], v[250:251]
  v_cvt_pk_bf16_f32 v72, v236, v237
  v_cvt_pk_bf16_f32 v73, v238, v239
  v_cvt_pk_bf16_f32 v88, v240, v241
  v_cvt_pk_bf16_f32 v89, v242, v243
  s_waitcnt lgkmcnt(10)
  v_pk_fma_f32 v[236:237], v[184:185], v[168:169], v[212:213] op_sel:[0,1,0] op_sel_hi:[1,1,1]
  v_pk_fma_f32 v[238:239], v[186:187], v[168:169], v[214:215] op_sel:[0,1,0] op_sel_hi:[1,1,1]
  v_pk_fma_f32 v[240:241], v[184:185], v[170:171], v[212:213] op_sel:[0,1,0] op_sel_hi:[1,1,1]
  s_add_u32 m0, s46, 59392
  s_add_u32 s52, s47, 262144
  buffer_load_dwordx4 v36, s[24:27], s52 offen lds
  v_pk_fma_f32 v[242:243], v[186:187], v[170:171], v[214:215] op_sel:[0,1,0] op_sel_hi:[1,1,1]
  v_pk_fma_f32 v[236:237], v[112:113], v[168:169], v[236:237] op_sel_hi:[1,0,1]
  v_pk_fma_f32 v[238:239], v[114:115], v[168:169], v[238:239] op_sel_hi:[1,0,1]
  v_pk_fma_f32 v[240:241], v[116:117], v[170:171], v[240:241] op_sel_hi:[1,0,1]
  v_pk_fma_f32 v[242:243], v[118:119], v[170:171], v[242:243] op_sel_hi:[1,0,1]
  v_exp_f32 v244, v236
  v_exp_f32 v245, v237
  v_exp_f32 v246, v238
  v_exp_f32 v247, v239
  s_add_u32 m0, s46, 63488
  s_add_u32 s52, s47, 1179648
  buffer_load_dwordx4 v36, s[24:27], s52 offen lds
  v_exp_f32 v248, v240
  v_exp_f32 v249, v241
  v_exp_f32 v250, v242
  v_exp_f32 v251, v243
  v_pk_add_f32 v[244:245], v[244:245], s[62:63]
  v_pk_add_f32 v[246:247], v[246:247], s[62:63]
  v_pk_add_f32 v[248:249], v[248:249], s[62:63]
  v_pk_add_f32 v[250:251], v[250:251], s[62:63]
  v_pk_fma_f32 v[244:245], v[244:245], v[244:245], s[62:63]
  s_add_u32 m0, s46, 67584
  s_add_u32 s52, s47, 491520
  buffer_load_dwordx4 v36, s[24:27], s52 offen lds
  v_pk_fma_f32 v[246:247], v[246:247], v[246:247], s[62:63]
  v_pk_fma_f32 v[248:249], v[248:249], v[248:249], s[62:63]
  v_pk_fma_f32 v[250:251], v[250:251], v[250:251], s[62:63]
  v_rcp_f32 v244, v244
  v_rcp_f32 v245, v245
  v_rcp_f32 v246, v246
  v_rcp_f32 v247, v247
  v_rcp_f32 v248, v248
  v_rcp_f32 v249, v249
  s_add_u32 m0, s46, 71680
  s_add_u32 s52, s47, 1409024
  buffer_load_dwordx4 v36, s[24:27], s52 offen lds
  v_rcp_f32 v250, v250
  v_rcp_f32 v251, v251
  v_pk_fma_f32 v[244:245], v[244:245], s[64:65], v[64:65]
  v_pk_fma_f32 v[246:247], v[246:247], s[64:65], v[64:65]
  v_pk_fma_f32 v[248:249], v[248:249], s[64:65], v[64:65]
  v_pk_fma_f32 v[250:251], v[250:251], s[64:65], v[64:65]
  v_pk_mul_f32 v[236:237], v[236:237], v[244:245]
  v_pk_mul_f32 v[238:239], v[238:239], v[246:247]
  v_pk_mul_f32 v[240:241], v[240:241], v[248:249]
  s_add_u32 m0, s46, 75776
  s_add_u32 s52, s47, 524288
  buffer_load_dwordx4 v36, s[24:27], s52 offen lds
  v_pk_mul_f32 v[242:243], v[242:243], v[250:251]
  v_cvt_pk_bf16_f32 v74, v236, v237
  v_cvt_pk_bf16_f32 v75, v238, v239
  v_cvt_pk_bf16_f32 v90, v240, v241
  v_cvt_pk_bf16_f32 v91, v242, v243
  s_waitcnt lgkmcnt(8)
  v_pk_fma_f32 v[236:237], v[188:189], v[168:169], v[216:217] op_sel:[0,1,0] op_sel_hi:[1,1,1]
  v_pk_fma_f32 v[238:239], v[190:191], v[168:169], v[218:219] op_sel:[0,1,0] op_sel_hi:[1,1,1]
  v_pk_fma_f32 v[240:241], v[188:189], v[170:171], v[216:217] op_sel:[0,1,0] op_sel_hi:[1,1,1]
  s_add_u32 m0, s46, 79872
  s_add_u32 s52, s47, 1441792
  buffer_load_dwordx4 v36, s[24:27], s52 offen lds
  v_pk_fma_f32 v[242:243], v[190:191], v[170:171], v[218:219] op_sel:[0,1,0] op_sel_hi:[1,1,1]
  v_pk_fma_f32 v[236:237], v[120:121], v[168:169], v[236:237] op_sel_hi:[1,0,1]
  v_pk_fma_f32 v[238:239], v[122:123], v[168:169], v[238:239] op_sel_hi:[1,0,1]
  v_pk_fma_f32 v[240:241], v[124:125], v[170:171], v[240:241] op_sel_hi:[1,0,1]
  v_pk_fma_f32 v[242:243], v[126:127], v[170:171], v[242:243] op_sel_hi:[1,0,1]
  v_exp_f32 v244, v236
  v_exp_f32 v245, v237
  v_exp_f32 v246, v238
  v_exp_f32 v247, v239
  s_add_u32 m0, s46, 83968
  s_add_u32 s52, s47, 557056
  buffer_load_dwordx4 v36, s[24:27], s52 offen lds
  v_exp_f32 v248, v240
  v_exp_f32 v249, v241
  v_exp_f32 v250, v242
  v_exp_f32 v251, v243
  v_pk_add_f32 v[244:245], v[244:245], s[62:63]
  v_pk_add_f32 v[246:247], v[246:247], s[62:63]
  v_pk_add_f32 v[248:249], v[248:249], s[62:63]
  v_pk_add_f32 v[250:251], v[250:251], s[62:63]
  v_pk_fma_f32 v[244:245], v[244:245], v[244:245], s[62:63]
  s_add_u32 m0, s46, 88064
  s_add_u32 s52, s47, 1474560
  buffer_load_dwordx4 v36, s[24:27], s52 offen lds
  v_pk_fma_f32 v[246:247], v[246:247], v[246:247], s[62:63]
  v_pk_fma_f32 v[248:249], v[248:249], v[248:249], s[62:63]
  v_pk_fma_f32 v[250:251], v[250:251], v[250:251], s[62:63]
  v_rcp_f32 v244, v244
  v_rcp_f32 v245, v245
  v_rcp_f32 v246, v246
  v_rcp_f32 v247, v247
  v_rcp_f32 v248, v248
  v_rcp_f32 v249, v249
  s_add_u32 m0, s46, 92160
  s_add_u32 s52, s47, 589824
  buffer_load_dwordx4 v36, s[24:27], s52 offen lds
  v_rcp_f32 v250, v250
  v_rcp_f32 v251, v251
  v_pk_fma_f32 v[244:245], v[244:245], s[64:65], v[64:65]
  v_pk_fma_f32 v[246:247], v[246:247], s[64:65], v[64:65]
  v_pk_fma_f32 v[248:249], v[248:249], s[64:65], v[64:65]
  v_pk_fma_f32 v[250:251], v[250:251], s[64:65], v[64:65]
  v_pk_mul_f32 v[236:237], v[236:237], v[244:245]
  v_pk_mul_f32 v[238:239], v[238:239], v[246:247]
  v_pk_mul_f32 v[240:241], v[240:241], v[248:249]
  s_add_u32 m0, s46, 96256
  s_add_u32 s52, s47, 1507328
  buffer_load_dwordx4 v36, s[24:27], s52 offen lds
  v_pk_mul_f32 v[242:243], v[242:243], v[250:251]
  v_cvt_pk_bf16_f32 v76, v236, v237
  v_cvt_pk_bf16_f32 v77, v238, v239
  v_cvt_pk_bf16_f32 v92, v240, v241
  v_cvt_pk_bf16_f32 v93, v242, v243
  s_waitcnt lgkmcnt(6)
  v_pk_fma_f32 v[236:237], v[192:193], v[168:169], v[220:221] op_sel:[0,1,0] op_sel_hi:[1,1,1]
  v_pk_fma_f32 v[238:239], v[194:195], v[168:169], v[222:223] op_sel:[0,1,0] op_sel_hi:[1,1,1]
  v_pk_fma_f32 v[240:241], v[192:193], v[170:171], v[220:221] op_sel:[0,1,0] op_sel_hi:[1,1,1]
  s_add_u32 m0, s46, 100352
  s_add_u32 s52, s47, 0
  buffer_load_dwordx4 v36, s[24:27], s52 offen lds
  v_pk_fma_f32 v[242:243], v[194:195], v[170:171], v[222:223] op_sel:[0,1,0] op_sel_hi:[1,1,1]
  v_pk_fma_f32 v[236:237], v[128:129], v[168:169], v[236:237] op_sel_hi:[1,0,1]
  v_pk_fma_f32 v[238:239], v[130:131], v[168:169], v[238:239] op_sel_hi:[1,0,1]
  v_pk_fma_f32 v[240:241], v[132:133], v[170:171], v[240:241] op_sel_hi:[1,0,1]
  v_pk_fma_f32 v[242:243], v[134:135], v[170:171], v[242:243] op_sel_hi:[1,0,1]
  v_exp_f32 v244, v236
  v_exp_f32 v245, v237
  v_exp_f32 v246, v238
  v_exp_f32 v247, v239
  s_add_u32 m0, s46, 104448
  s_add_u32 s52, s47, 917504
  buffer_load_dwordx4 v36, s[24:27], s52 offen lds
  v_exp_f32 v248, v240
  v_exp_f32 v249, v241
  v_exp_f32 v250, v242
  v_exp_f32 v251, v243
  v_pk_add_f32 v[244:245], v[244:245], s[62:63]
  v_pk_add_f32 v[246:247], v[246:247], s[62:63]
  v_pk_add_f32 v[248:249], v[248:249], s[62:63]
  v_pk_add_f32 v[250:251], v[250:251], s[62:63]
  v_pk_fma_f32 v[244:245], v[244:245], v[244:245], s[62:63]
  s_add_u32 m0, s46, 108544
  s_add_u32 s52, s47, 32768
  buffer_load_dwordx4 v36, s[24:27], s52 offen lds
  v_pk_fma_f32 v[246:247], v[246:247], v[246:247], s[62:63]
  v_pk_fma_f32 v[248:249], v[248:249], v[248:249], s[62:63]
  v_pk_fma_f32 v[250:251], v[250:251], v[250:251], s[62:63]
  v_rcp_f32 v244, v244
  v_rcp_f32 v245, v245
  v_rcp_f32 v246, v246
  v_rcp_f32 v247, v247
  v_rcp_f32 v248, v248
  v_rcp_f32 v249, v249
  s_add_u32 m0, s46, 112640
  s_add_u32 s52, s47, 950272
  buffer_load_dwordx4 v36, s[24:27], s52 offen lds
  v_rcp_f32 v250, v250
  v_rcp_f32 v251, v251
  v_pk_fma_f32 v[244:245], v[244:245], s[64:65], v[64:65]
  v_pk_fma_f32 v[246:247], v[246:247], s[64:65], v[64:65]
  v_pk_fma_f32 v[248:249], v[248:249], s[64:65], v[64:65]
  v_pk_fma_f32 v[250:251], v[250:251], s[64:65], v[64:65]
  v_pk_mul_f32 v[236:237], v[236:237], v[244:245]
  v_pk_mul_f32 v[238:239], v[238:239], v[246:247]
  v_pk_mul_f32 v[240:241], v[240:241], v[248:249]
  s_add_u32 m0, s46, 116736
  s_add_u32 s52, s47, 65536
  buffer_load_dwordx4 v36, s[24:27], s52 offen lds
  v_pk_mul_f32 v[242:243], v[242:243], v[250:251]
  v_cvt_pk_bf16_f32 v78, v236, v237
  v_cvt_pk_bf16_f32 v79, v238, v239
  v_cvt_pk_bf16_f32 v94, v240, v241
  v_cvt_pk_bf16_f32 v95, v242, v243
  s_waitcnt lgkmcnt(4)
  v_pk_fma_f32 v[236:237], v[196:197], v[168:169], v[224:225] op_sel:[0,1,0] op_sel_hi:[1,1,1]
  v_pk_fma_f32 v[238:239], v[198:199], v[168:169], v[226:227] op_sel:[0,1,0] op_sel_hi:[1,1,1]
  v_pk_fma_f32 v[240:241], v[196:197], v[170:171], v[224:225] op_sel:[0,1,0] op_sel_hi:[1,1,1]
  s_add_u32 m0, s46, 120832
  s_add_u32 s52, s47, 983040
  buffer_load_dwordx4 v36, s[24:27], s52 offen lds
  v_pk_fma_f32 v[242:243], v[198:199], v[170:171], v[226:227] op_sel:[0,1,0] op_sel_hi:[1,1,1]
  v_pk_fma_f32 v[236:237], v[136:137], v[168:169], v[236:237] op_sel_hi:[1,0,1]
  v_pk_fma_f32 v[238:239], v[138:139], v[168:169], v[238:239] op_sel_hi:[1,0,1]
  v_pk_fma_f32 v[240:241], v[140:141], v[170:171], v[240:241] op_sel_hi:[1,0,1]
  v_pk_fma_f32 v[242:243], v[142:143], v[170:171], v[242:243] op_sel_hi:[1,0,1]
  v_exp_f32 v244, v236
  v_exp_f32 v245, v237
  v_exp_f32 v246, v238
  v_exp_f32 v247, v239
  s_add_u32 m0, s46, 124928
  s_add_u32 s52, s47, 98304
  buffer_load_dwordx4 v36, s[24:27], s52 offen lds
  v_exp_f32 v248, v240
  v_exp_f32 v249, v241
  v_exp_f32 v250, v242
  v_exp_f32 v251, v243
  v_pk_add_f32 v[244:245], v[244:245], s[62:63]
  v_pk_add_f32 v[246:247], v[246:247], s[62:63]
  v_pk_add_f32 v[248:249], v[248:249], s[62:63]
  v_pk_add_f32 v[250:251], v[250:251], s[62:63]
  v_pk_fma_f32 v[244:245], v[244:245], v[244:245], s[62:63]
  s_add_u32 m0, s46, 129024
  s_add_u32 s52, s47, 1015808
  buffer_load_dwordx4 v36, s[24:27], s52 offen lds
  v_pk_fma_f32 v[246:247], v[246:247], v[246:247], s[62:63]
  v_pk_fma_f32 v[248:249], v[248:249], v[248:249], s[62:63]
  v_pk_fma_f32 v[250:251], v[250:251], v[250:251], s[62:63]
  v_rcp_f32 v244, v244
  v_rcp_f32 v245, v245
  v_rcp_f32 v246, v246
  v_rcp_f32 v247, v247
  v_rcp_f32 v248, v248
  v_rcp_f32 v249, v249
  s_add_u32 m0, s46, 133120
  s_add_u32 s52, s47, 131072
  buffer_load_dwordx4 v36, s[24:27], s52 offen lds
  v_rcp_f32 v250, v250
  v_rcp_f32 v251, v251
  v_pk_fma_f32 v[244:245], v[244:245], s[64:65], v[64:65]
  v_pk_fma_f32 v[246:247], v[246:247], s[64:65], v[64:65]
  v_pk_fma_f32 v[248:249], v[248:249], s[64:65], v[64:65]
  v_pk_fma_f32 v[250:251], v[250:251], s[64:65], v[64:65]
  v_pk_mul_f32 v[236:237], v[236:237], v[244:245]
  v_pk_mul_f32 v[238:239], v[238:239], v[246:247]
  v_pk_mul_f32 v[240:241], v[240:241], v[248:249]
  s_add_u32 m0, s46, 137216
  s_add_u32 s52, s47, 1048576
  buffer_load_dwordx4 v36, s[24:27], s52 offen lds
  v_pk_mul_f32 v[242:243], v[242:243], v[250:251]
  v_cvt_pk_bf16_f32 v80, v236, v237
  v_cvt_pk_bf16_f32 v81, v238, v239
  v_cvt_pk_bf16_f32 v96, v240, v241
  v_cvt_pk_bf16_f32 v97, v242, v243
  s_waitcnt lgkmcnt(2)
  v_pk_fma_f32 v[236:237], v[200:201], v[168:169], v[228:229] op_sel:[0,1,0] op_sel_hi:[1,1,1]
  v_pk_fma_f32 v[238:239], v[202:203], v[168:169], v[230:231] op_sel:[0,1,0] op_sel_hi:[1,1,1]
  v_pk_fma_f32 v[240:241], v[200:201], v[170:171], v[228:229] op_sel:[0,1,0] op_sel_hi:[1,1,1]
  v_pk_fma_f32 v[242:243], v[202:203], v[170:171], v[230:231] op_sel:[0,1,0] op_sel_hi:[1,1,1]
  v_pk_fma_f32 v[236:237], v[144:145], v[168:169], v[236:237] op_sel_hi:[1,0,1]
  v_pk_fma_f32 v[238:239], v[146:147], v[168:169], v[238:239] op_sel_hi:[1,0,1]
  v_pk_fma_f32 v[240:241], v[148:149], v[170:171], v[240:241] op_sel_hi:[1,0,1]
  v_pk_fma_f32 v[242:243], v[150:151], v[170:171], v[242:243] op_sel_hi:[1,0,1]
  v_exp_f32 v244, v236
  v_exp_f32 v245, v237
  v_exp_f32 v246, v238
  v_exp_f32 v247, v239
  v_exp_f32 v248, v240
  v_exp_f32 v249, v241
  v_exp_f32 v250, v242
  v_exp_f32 v251, v243
  v_pk_add_f32 v[244:245], v[244:245], s[62:63]
  v_pk_add_f32 v[246:247], v[246:247], s[62:63]
  v_pk_add_f32 v[248:249], v[248:249], s[62:63]
  v_pk_add_f32 v[250:251], v[250:251], s[62:63]
  v_pk_fma_f32 v[244:245], v[244:245], v[244:245], s[62:63]
  v_pk_fma_f32 v[246:247], v[246:247], v[246:247], s[62:63]
  v_pk_fma_f32 v[248:249], v[248:249], v[248:249], s[62:63]
  v_pk_fma_f32 v[250:251], v[250:251], v[250:251], s[62:63]
  v_rcp_f32 v244, v244
  v_rcp_f32 v245, v245
  v_rcp_f32 v246, v246
  v_rcp_f32 v247, v247
  v_rcp_f32 v248, v248
  v_rcp_f32 v249, v249
  v_rcp_f32 v250, v250
  v_rcp_f32 v251, v251
  v_pk_fma_f32 v[244:245], v[244:245], s[64:65], v[64:65]
  v_pk_fma_f32 v[246:247], v[246:247], s[64:65], v[64:65]
  v_pk_fma_f32 v[248:249], v[248:249], s[64:65], v[64:65]
  v_pk_fma_f32 v[250:251], v[250:251], s[64:65], v[64:65]
  v_pk_mul_f32 v[236:237], v[236:237], v[244:245]
  v_pk_mul_f32 v[238:239], v[238:239], v[246:247]
  v_pk_mul_f32 v[240:241], v[240:241], v[248:249]
  v_pk_mul_f32 v[242:243], v[242:243], v[250:251]
  v_cvt_pk_bf16_f32 v82, v236, v237
  v_cvt_pk_bf16_f32 v83, v238, v239
  v_cvt_pk_bf16_f32 v98, v240, v241
  v_cvt_pk_bf16_f32 v99, v242, v243
  s_waitcnt lgkmcnt(0)
  v_pk_fma_f32 v[236:237], v[204:205], v[168:169], v[232:233] op_sel:[0,1,0] op_sel_hi:[1,1,1]
  v_pk_fma_f32 v[238:239], v[206:207], v[168:169], v[234:235] op_sel:[0,1,0] op_sel_hi:[1,1,1]
  v_pk_fma_f32 v[240:241], v[204:205], v[170:171], v[232:233] op_sel:[0,1,0] op_sel_hi:[1,1,1]
  v_pk_fma_f32 v[242:243], v[206:207], v[170:171], v[234:235] op_sel:[0,1,0] op_sel_hi:[1,1,1]
  v_pk_fma_f32 v[236:237], v[152:153], v[168:169], v[236:237] op_sel_hi:[1,0,1]
  v_pk_fma_f32 v[238:239], v[154:155], v[168:169], v[238:239] op_sel_hi:[1,0,1]
  v_pk_fma_f32 v[240:241], v[156:157], v[170:171], v[240:241] op_sel_hi:[1,0,1]
  v_pk_fma_f32 v[242:243], v[158:159], v[170:171], v[242:243] op_sel_hi:[1,0,1]
  v_exp_f32 v244, v236
  v_exp_f32 v245, v237
  v_exp_f32 v246, v238
  v_exp_f32 v247, v239
  v_exp_f32 v248, v240
  v_exp_f32 v249, v241
  v_exp_f32 v250, v242
  v_exp_f32 v251, v243
  v_pk_add_f32 v[244:245], v[244:245], s[62:63]
  v_pk_add_f32 v[246:247], v[246:247], s[62:63]
  v_pk_add_f32 v[248:249], v[248:249], s[62:63]
  v_pk_add_f32 v[250:251], v[250:251], s[62:63]
  v_pk_fma_f32 v[244:245], v[244:245], v[244:245], s[62:63]
  v_pk_fma_f32 v[246:247], v[246:247], v[246:247], s[62:63]
  v_pk_fma_f32 v[248:249], v[248:249], v[248:249], s[62:63]
  v_pk_fma_f32 v[250:251], v[250:251], v[250:251], s[62:63]
  v_rcp_f32 v244, v244
  v_rcp_f32 v245, v245
  v_rcp_f32 v246, v246
  v_rcp_f32 v247, v247
  v_rcp_f32 v248, v248
  v_rcp_f32 v249, v249
  v_rcp_f32 v250, v250
  v_rcp_f32 v251, v251
  v_pk_fma_f32 v[244:245], v[244:245], s[64:65], v[64:65]
  v_pk_fma_f32 v[246:247], v[246:247], s[64:65], v[64:65]
  v_pk_fma_f32 v[248:249], v[248:249], s[64:65], v[64:65]
  v_pk_fma_f32 v[250:251], v[250:251], s[64:65], v[64:65]
  v_pk_mul_f32 v[236:237], v[236:237], v[244:245]
  v_pk_mul_f32 v[238:239], v[238:239], v[246:247]
  v_pk_mul_f32 v[240:241], v[240:241], v[248:249]
  v_pk_mul_f32 v[242:243], v[242:243], v[250:251]
  v_cvt_pk_bf16_f32 v84, v236, v237
  v_cvt_pk_bf16_f32 v85, v238, v239
  v_cvt_pk_bf16_f32 v100, v240, v241
  v_cvt_pk_bf16_f32 v101, v242, v243
  s_lshr_b32 s52, s5, 1
  s_mul_i32 s52, s52, 7168
  s_add_u32 s52, s52, s95
  s_mul_i32 s53, s6, 114688
  s_add_u32 s52, s52, s53
  s_add_u32 s53, s52, 57344
  s_add_u32 s54, s52, 4096
  s_add_u32 s55, s53, 4096
  s_bitcmp1_b32 s5, 0
  s_cbranch_scc1 odd_35
  s_cmp_eq_u32 s7, 0
  s_cbranch_scc1 e1_36
  buffer_store_dwordx4 v[72:75], v1, s[28:31], s52 offen offset:0 sc1
  buffer_store_dwordx4 v[76:79], v1, s[28:31], s52 offen offset:1024 sc1
  buffer_store_dwordx4 v[80:83], v1, s[28:31], s52 offen offset:2048 sc1
  buffer_store_dwordx2 v[84:85], v1, s[28:31], s52 offen offset:3072 sc1
  buffer_store_dwordx4 v[88:91], v1, s[28:31], s53 offen offset:0 sc1
  buffer_store_dwordx4 v[92:95], v1, s[28:31], s53 offen offset:1024 sc1
  buffer_store_dwordx4 v[96:99], v1, s[28:31], s53 offen offset:2048 sc1
  buffer_store_dwordx2 v[100:101], v1, s[28:31], s53 offen offset:3072 sc1
  s_nop 0
  s_branch dn_38
e1_36:
  buffer_store_dwordx4 v[72:75], v1, s[28:31], s52 offen offset:0
  buffer_store_dwordx4 v[76:79], v1, s[28:31], s52 offen offset:1024
  buffer_store_dwordx4 v[80:83], v1, s[28:31], s52 offen offset:2048
  buffer_store_dwordx2 v[84:85], v1, s[28:31], s52 offen offset:3072
  buffer_store_dwordx4 v[88:91], v1, s[28:31], s53 offen offset:0
  buffer_store_dwordx4 v[92:95], v1, s[28:31], s53 offen offset:1024
  buffer_store_dwordx4 v[96:99], v1, s[28:31], s53 offen offset:2048
  buffer_store_dwordx2 v[100:101], v1, s[28:31], s53 offen offset:3072
  s_nop 0
  s_branch dn_38
odd_35:
  s_cmp_eq_u32 s7, 0
  s_cbranch_scc1 o1_37
  buffer_store_dwordx2 v[72:73], v1, s[28:31], s52 offen offset:3080 sc1
  buffer_store_dwordx4 v[74:77], v1, s[28:31], s54 offen offset:0 sc1
  buffer_store_dwordx4 v[78:81], v1, s[28:31], s54 offen offset:1024 sc1
  buffer_store_dwordx4 v[82:85], v1, s[28:31], s54 offen offset:2048 sc1
  buffer_store_dwordx2 v[88:89], v1, s[28:31], s53 offen offset:3080 sc1
  buffer_store_dwordx4 v[90:93], v1, s[28:31], s55 offen offset:0 sc1
  buffer_store_dwordx4 v[94:97], v1, s[28:31], s55 offen offset:1024 sc1
  buffer_store_dwordx4 v[98:101], v1, s[28:31], s55 offen offset:2048 sc1
  s_nop 1
  s_branch dn_38
o1_37:
  buffer_store_dwordx2 v[72:73], v1, s[28:31], s52 offen offset:3080
  buffer_store_dwordx4 v[74:77], v1, s[28:31], s54 offen offset:0
  buffer_store_dwordx4 v[78:81], v1, s[28:31], s54 offen offset:1024
  buffer_store_dwordx4 v[82:85], v1, s[28:31], s54 offen offset:2048
  buffer_store_dwordx2 v[88:89], v1, s[28:31], s53 offen offset:3080
  buffer_store_dwordx4 v[90:93], v1, s[28:31], s55 offen offset:0
  buffer_store_dwordx4 v[94:97], v1, s[28:31], s55 offen offset:1024
  buffer_store_dwordx4 v[98:101], v1, s[28:31], s55 offen offset:2048
dn_38:
  s_add_u32 s76, s78, 3
  v_mov_b32 v254, s76
  v_mov_b32 v255, 0
  v_lshlrev_b32 v250, 2, v0
  s_add_u32 m0, s46, 141312
  s_add_u32 s52, s47, 163840
  buffer_load_dwordx4 v36, s[24:27], s52 offen lds
  s_add_u32 m0, s46, 145408
  s_add_u32 s52, s47, 1081344
  buffer_load_dwordx4 v36, s[24:27], s52 offen lds
  s_add_u32 m0, s46, 149504
  s_add_u32 s52, s47, 196608
  buffer_load_dwordx4 v36, s[24:27], s52 offen lds
  s_add_u32 m0, s46, 153600
  s_add_u32 s52, s47, 1114112
  buffer_load_dwordx4 v36, s[24:27], s52 offen lds
  s_waitcnt vmcnt(4)
  s_mov_b64 exec, 1
  s_cmp_eq_u32 s7, 0
  s_cbranch_scc1 fp_39
  buffer_store_dword v254, v255, s[28:31], s56 offen sc1
  s_branch fd_40
fp_39:
  buffer_store_dword v254, v255, s[28:31], s56 offen
fd_40:
  s_mov_b64 exec, -1
  s_cmp_lg_u32 s6, 0
  s_cbranch_scc1 so_41
  s_mov_b32 s77, 0
  buffer_load_dword v248, v250, s[28:31], s57 offen sc1
sp_43:
  buffer_load_dword v249, v250, s[28:31], s57 offen sc1
  s_waitcnt vmcnt(1)
  v_cmp_gt_u32 vcc, s76, v248
  s_add_u32 s77, s77, 1
  s_cbranch_vccz sj_42
  buffer_load_dword v248, v250, s[28:31], s57 offen sc1
  s_waitcnt vmcnt(1)
  v_cmp_gt_u32 vcc, s76, v249
  s_cmp_lt_u32 s77, 0x80000
  s_cbranch_vccz sj_42
  s_nop 2
  s_cbranch_scc1 sp_43
  s_endpgm
so_41:
sj_42:
  s_waitcnt vmcnt(0) lgkmcnt(0)
  s_barrier
L_C4:
  s_cmp_eq_u32 s3, 0
  s_cselect_b64 s[74:75], -1, 0
  s_lshl_b32 s53, s6, 10
  s_add_u32 s53, s53, 2048
  v_add_u32 v228, s53, v1
  v_add_u32 v229, 0x10000, v228
  s_and_b32 s52, s6, 1
  s_mul_i32 s52, s52, 28672
  s_add_u32 s52, s52, s95
  s_mul_i32 s53, s86, 57344
  s_add_u32 s50, s52, s53
  s_xor_b32 s53, s86, 1
  s_mul_i32 s53, s53, 57344
  s_add_u32 s51, s52, s53
  s_add_u32 s92, s50, 0
  buffer_load_dwordx4 a[0:3], v1, s[28:31], s92 offen offset:0 sc1
  s_add_u32 s93, s51, 0
  buffer_load_dwordx4 a[4:7], v1, s[28:31], s93 offen offset:0 sc1
  buffer_load_dwordx4 a[8:11], v1, s[28:31], s92 offen offset:1024 sc1
  buffer_load_dwordx4 a[12:15], v1, s[28:31], s93 offen offset:1024 sc1
  buffer_load_dwordx4 a[16:19], v1, s[28:31], s92 offen offset:2048 sc1
  buffer_load_dwordx4 a[20:23], v1, s[28:31], s93 offen offset:2048 sc1
  buffer_load_dwordx4 a[24:27], v1, s[28:31], s92 offen offset:3072 sc1
  buffer_load_dwordx4 a[28:31], v1, s[28:31], s93 offen offset:3072 sc1
  s_add_u32 s92, s50, 4096
  buffer_load_dwordx4 a[32:35], v1, s[28:31], s92 offen offset:0 sc1
  s_add_u32 s93, s51, 4096
  buffer_load_dwordx4 a[36:39], v1, s[28:31], s93 offen offset:0 sc1
  buffer_load_dwordx4 a[40:43], v1, s[28:31], s92 offen offset:1024 sc1
  buffer_load_dwordx4 a[44:47], v1, s[28:31], s93 offen offset:1024 sc1
  ds_read_b64_tr_b16 v[72:73], v24 offset:32768
  ds_read_b64_tr_b16 v[74:75], v24 offset:34816
  ds_read_b64_tr_b16 v[76:77], v27 offset:32768
  ds_read_b64_tr_b16 v[78:79], v27 offset:34816
  ds_read_b64_tr_b16 v[80:81], v30 offset:32768
  ds_read_b64_tr_b16 v[82:83], v30 offset:34816
  s_waitcnt vmcnt(11) lgkmcnt(4)
  v_mfma_f32_16x16x32_bf16 v[104:107], v[72:75], a[0:3], 0
  s_waitcnt vmcnt(10)
  ds_read_b64_tr_b16 v[84:85], v33 offset:32768
  v_mfma_f32_16x16x32_bf16 v[120:123], v[72:75], a[4:7], 0
  s_waitcnt lgkmcnt(3)
  ds_read_b64_tr_b16 v[86:87], v33 offset:34816
  buffer_load_dwordx4 a[48:51], v1, s[28:31], s92 offen offset:2048 sc1
  v_mfma_f32_16x16x32_bf16 v[108:111], v[76:79], a[0:3], 0
  ds_read_b64_tr_b16 v[88:89], v24 offset:40960
  buffer_load_dwordx4 a[52:55], v1, s[28:31], s93 offen offset:2048 sc1
  v_mfma_f32_16x16x32_bf16 v[124:127], v[76:79], a[4:7], 0
  s_waitcnt lgkmcnt(3)
  ds_read_b64_tr_b16 v[90:91], v24 offset:43008
  v_mfma_f32_16x16x32_bf16 v[112:115], v[80:83], a[0:3], 0
  ds_read_b64_tr_b16 v[92:93], v27 offset:40960
  v_mfma_f32_16x16x32_bf16 v[128:131], v[80:83], a[4:7], 0
  s_waitcnt lgkmcnt(3)
  ds_read_b64_tr_b16 v[94:95], v27 offset:43008
  v_mfma_f32_16x16x32_bf16 v[116:119], v[84:87], a[0:3], 0
  ds_read_b64_tr_b16 v[72:73], v30 offset:40960
  v_mfma_f32_16x16x32_bf16 v[132:135], v[84:87], a[4:7], 0
  s_waitcnt vmcnt(11) lgkmcnt(3)
  ds_read_b64_tr_b16 v[74:75], v30 offset:43008
  buffer_load_dwordx4 a[0:3], v1, s[28:31], s92 offen offset:3072 sc1
  v_mfma_f32_16x16x32_bf16 v[104:107], v[88:91], a[8:11], v[104:107]
  s_waitcnt vmcnt(11)
  ds_read_b64_tr_b16 v[76:77], v33 offset:40960
  buffer_load_dwordx4 a[4:7], v1, s[28:31], s93 offen offset:3072 sc1
  v_mfma_f32_16x16x32_bf16 v[120:123], v[88:91], a[12:15], v[120:123]
  s_waitcnt lgkmcnt(3)
  ds_read_b64_tr_b16 v[78:79], v33 offset:43008
  v_mfma_f32_16x16x32_bf16 v[108:111], v[92:95], a[8:11], v[108:111]
  ds_read_b64_tr_b16 v[80:81], v24 offset:49152
  v_mfma_f32_16x16x32_bf16 v[124:127], v[92:95], a[12:15], v[124:127]
  s_waitcnt lgkmcnt(3)
  ds_read_b64_tr_b16 v[82:83], v24 offset:51200
  v_mfma_f32_16x16x32_bf16 v[112:115], v[72:75], a[8:11], v[112:115]
  ds_read_b64_tr_b16 v[84:85], v27 offset:49152
  v_mfma_f32_16x16x32_bf16 v[128:131], v[72:75], a[12:15], v[128:131]
  s_waitcnt lgkmcnt(3)
  ds_read_b64_tr_b16 v[86:87], v27 offset:51200
  v_mfma_f32_16x16x32_bf16 v[116:119], v[76:79], a[8:11], v[116:119]
  ds_read_b64_tr_b16 v[88:89], v30 offset:49152
  v_mfma_f32_16x16x32_bf16 v[132:135], v[76:79], a[12:15], v[132:135]
  s_waitcnt vmcnt(11) lgkmcnt(3)
  ds_read_b64_tr_b16 v[90:91], v30 offset:51200
  s_add_u32 s92, s50, 8192
  buffer_load_dwordx4 a[8:11], v1, s[28:31], s92 offen offset:0 sc1
  v_mfma_f32_16x16x32_bf16 v[104:107], v[80:83], a[16:19], v[104:107]
  s_waitcnt vmcnt(11)
  ds_read_b64_tr_b16 v[92:93], v33 offset:49152
  s_add_u32 s93, s51, 8192
  buffer_load_dwordx4 a[12:15], v1, s[28:31], s93 offen offset:0 sc1
  v_mfma_f32_16x16x32_bf16 v[120:123], v[80:83], a[20:23], v[120:123]
  s_waitcnt lgkmcnt(3)
  ds_read_b64_tr_b16 v[94:95], v33 offset:51200
  v_mfma_f32_16x16x32_bf16 v[108:111], v[84:87], a[16:19], v[108:111]
  ds_read_b64_tr_b16 v[72:73], v24 offset:57344
  v_mfma_f32_16x16x32_bf16 v[124:127], v[84:87], a[20:23], v[124:127]
  s_waitcnt lgkmcnt(3)
  ds_read_b64_tr_b16 v[74:75], v24 offset:59392
  v_mfma_f32_16x16x32_bf16 v[112:115], v[88:91], a[16:19], v[112:115]
  ds_read_b64_tr_b16 v[76:77], v27 offset:57344
  v_mfma_f32_16x16x32_bf16 v[128:131], v[88:91], a[20:23], v[128:131]
  s_waitcnt lgkmcnt(3)
  ds_read_b64_tr_b16 v[78:79], v27 offset:59392
  v_mfma_f32_16x16x32_bf16 v[116:119], v[92:95], a[16:19], v[116:119]
  ds_read_b64_tr_b16 v[80:81], v30 offset:57344
  v_mfma_f32_16x16x32_bf16 v[132:135], v[92:95], a[20:23], v[132:135]
  s_waitcnt vmcnt(11) lgkmcnt(3)
  ds_read_b64_tr_b16 v[82:83], v30 offset:59392
  buffer_load_dwordx4 a[16:19], v1, s[28:31], s92 offen offset:1024 sc1
  v_mfma_f32_16x16x32_bf16 v[104:107], v[72:75], a[24:27], v[104:107]
  s_waitcnt vmcnt(11)
  ds_read_b64_tr_b16 v[84:85], v33 offset:57344
  buffer_load_dwordx4 a[20:23], v1, s[28:31], s93 offen offset:1024 sc1
  v_mfma_f32_16x16x32_bf16 v[120:123], v[72:75], a[28:31], v[120:123]
  s_waitcnt lgkmcnt(3)
  ds_read_b64_tr_b16 v[86:87], v33 offset:59392
  v_mfma_f32_16x16x32_bf16 v[108:111], v[76:79], a[24:27], v[108:111]
  ds_read_b64_tr_b16 v[88:89], v25 offset:0
  v_mfma_f32_16x16x32_bf16 v[124:127], v[76:79], a[28:31], v[124:127]
  s_waitcnt lgkmcnt(3)
  ds_read_b64_tr_b16 v[90:91], v25 offset:2048
  v_mfma_f32_16x16x32_bf16 v[112:115], v[80:83], a[24:27], v[112:115]
  ds_read_b64_tr_b16 v[92:93], v28 offset:0
  v_mfma_f32_16x16x32_bf16 v[128:131], v[80:83], a[28:31], v[128:131]
  s_waitcnt lgkmcnt(3)
  ds_read_b64_tr_b16 v[94:95], v28 offset:2048
  v_mfma_f32_16x16x32_bf16 v[116:119], v[84:87], a[24:27], v[116:119]
  ds_read_b64_tr_b16 v[72:73], v31 offset:0
  v_mfma_f32_16x16x32_bf16 v[132:135], v[84:87], a[28:31], v[132:135]
  s_waitcnt vmcnt(11) lgkmcnt(3)
  ds_read_b64_tr_b16 v[74:75], v31 offset:2048
  buffer_load_dwordx4 a[24:27], v1, s[28:31], s92 offen offset:2048 sc1
  v_mfma_f32_16x16x32_bf16 v[104:107], v[88:91], a[32:35], v[104:107]
  s_waitcnt vmcnt(11)
  ds_read_b64_tr_b16 v[76:77], v34 offset:0
  buffer_load_dwordx4 a[28:31], v1, s[28:31], s93 offen offset:2048 sc1
  v_mfma_f32_16x16x32_bf16 v[120:123], v[88:91], a[36:39], v[120:123]
  s_waitcnt lgkmcnt(3)
  ds_read_b64_tr_b16 v[78:79], v34 offset:2048
  v_mfma_f32_16x16x32_bf16 v[108:111], v[92:95], a[32:35], v[108:111]
  ds_read_b64_tr_b16 v[80:81], v25 offset:8192
  v_mfma_f32_16x16x32_bf16 v[124:127], v[92:95], a[36:39], v[124:127]
  s_waitcnt lgkmcnt(3)
  ds_read_b64_tr_b16 v[82:83], v25 offset:10240
  v_mfma_f32_16x16x32_bf16 v[112:115], v[72:75], a[32:35], v[112:115]
  ds_read_b64_tr_b16 v[84:85], v28 offset:8192
  v_mfma_f32_16x16x32_bf16 v[128:131], v[72:75], a[36:39], v[128:131]
  s_waitcnt lgkmcnt(3)
  ds_read_b64_tr_b16 v[86:87], v28 offset:10240
  v_mfma_f32_16x16x32_bf16 v[116:119], v[76:79], a[32:35], v[116:119]
  ds_read_b64_tr_b16 v[88:89], v31 offset:8192
  v_mfma_f32_16x16x32_bf16 v[132:135], v[76:79], a[36:39], v[132:135]
  s_waitcnt vmcnt(11) lgkmcnt(3)
  ds_read_b64_tr_b16 v[90:91], v31 offset:10240
  buffer_load_dwordx4 a[32:35], v1, s[28:31], s92 offen offset:3072 sc1
  v_mfma_f32_16x16x32_bf16 v[104:107], v[80:83], a[40:43], v[104:107]
  s_waitcnt vmcnt(11)
  ds_read_b64_tr_b16 v[92:93], v34 offset:8192
  buffer_load_dwordx4 a[36:39], v1, s[28:31], s93 offen offset:3072 sc1
  v_mfma_f32_16x16x32_bf16 v[120:123], v[80:83], a[44:47], v[120:123]
  s_waitcnt lgkmcnt(3)
  ds_read_b64_tr_b16 v[94:95], v34 offset:10240
  v_mfma_f32_16x16x32_bf16 v[108:111], v[84:87], a[40:43], v[108:111]
  ds_read_b64_tr_b16 v[72:73], v25 offset:16384
  v_mfma_f32_16x16x32_bf16 v[124:127], v[84:87], a[44:47], v[124:127]
  s_waitcnt lgkmcnt(3)
  ds_read_b64_tr_b16 v[74:75], v25 offset:18432
  v_mfma_f32_16x16x32_bf16 v[112:115], v[88:91], a[40:43], v[112:115]
  ds_read_b64_tr_b16 v[76:77], v28 offset:16384
  v_mfma_f32_16x16x32_bf16 v[128:131], v[88:91], a[44:47], v[128:131]
  s_waitcnt lgkmcnt(3)
  ds_read_b64_tr_b16 v[78:79], v28 offset:18432
  v_mfma_f32_16x16x32_bf16 v[116:119], v[92:95], a[40:43], v[116:119]
  ds_read_b64_tr_b16 v[80:81], v31 offset:16384
  v_mfma_f32_16x16x32_bf16 v[132:135], v[92:95], a[44:47], v[132:135]
  s_waitcnt vmcnt(11) lgkmcnt(3)
  ds_read_b64_tr_b16 v[82:83], v31 offset:18432
  s_add_u32 s92, s50, 12288
  buffer_load_dwordx4 a[40:43], v1, s[28:31], s92 offen offset:0 sc1
  v_mfma_f32_16x16x32_bf16 v[104:107], v[72:75], a[48:51], v[104:107]
  s_waitcnt vmcnt(11)
  ds_read_b64_tr_b16 v[84:85], v34 offset:16384
  s_add_u32 s93, s51, 12288
  buffer_load_dwordx4 a[44:47], v1, s[28:31], s93 offen offset:0 sc1
  v_mfma_f32_16x16x32_bf16 v[120:123], v[72:75], a[52:55], v[120:123]
  s_waitcnt lgkmcnt(3)
  ds_read_b64_tr_b16 v[86:87], v34 offset:18432
  v_mfma_f32_16x16x32_bf16 v[108:111], v[76:79], a[48:51], v[108:111]
  ds_read_b64_tr_b16 v[88:89], v23 offset:24576
  v_mfma_f32_16x16x32_bf16 v[124:127], v[76:79], a[52:55], v[124:127]
  s_waitcnt lgkmcnt(3)
  ds_read_b64_tr_b16 v[90:91], v23 offset:26624
  v_mfma_f32_16x16x32_bf16 v[112:115], v[80:83], a[48:51], v[112:115]
  ds_read_b64_tr_b16 v[92:93], v26 offset:24576
  v_mfma_f32_16x16x32_bf16 v[128:131], v[80:83], a[52:55], v[128:131]
  s_waitcnt lgkmcnt(3)
  ds_read_b64_tr_b16 v[94:95], v26 offset:26624
  v_mfma_f32_16x16x32_bf16 v[116:119], v[84:87], a[48:51], v[116:119]
  ds_read_b64_tr_b16 v[72:73], v29 offset:24576
  v_mfma_f32_16x16x32_bf16 v[132:135], v[84:87], a[52:55], v[132:135]
  s_waitcnt vmcnt(11) lgkmcnt(3)
  ds_read_b64_tr_b16 v[74:75], v29 offset:26624
  buffer_load_dwordx4 a[48:51], v1, s[28:31], s92 offen offset:1024 sc1
  v_mfma_f32_16x16x32_bf16 v[104:107], v[88:91], a[0:3], v[104:107]
  s_waitcnt vmcnt(11)
  ds_read_b64_tr_b16 v[76:77], v32 offset:24576
  buffer_load_dwordx4 a[52:55], v1, s[28:31], s93 offen offset:1024 sc1
  v_mfma_f32_16x16x32_bf16 v[120:123], v[88:91], a[4:7], v[120:123]
  s_waitcnt lgkmcnt(3)
  ds_read_b64_tr_b16 v[78:79], v32 offset:26624
  v_mfma_f32_16x16x32_bf16 v[108:111], v[92:95], a[0:3], v[108:111]
  ds_read_b64_tr_b16 v[80:81], v23 offset:57344
  v_mfma_f32_16x16x32_bf16 v[124:127], v[92:95], a[4:7], v[124:127]
  s_waitcnt lgkmcnt(3)
  ds_read_b64_tr_b16 v[82:83], v23 offset:59392
  v_mfma_f32_16x16x32_bf16 v[112:115], v[72:75], a[0:3], v[112:115]
  ds_read_b64_tr_b16 v[84:85], v26 offset:57344
  v_mfma_f32_16x16x32_bf16 v[128:131], v[72:75], a[4:7], v[128:131]
  s_waitcnt lgkmcnt(3)
  ds_read_b64_tr_b16 v[86:87], v26 offset:59392
  v_mfma_f32_16x16x32_bf16 v[116:119], v[76:79], a[0:3], v[116:119]
  ds_read_b64_tr_b16 v[88:89], v29 offset:57344
  v_mfma_f32_16x16x32_bf16 v[132:135], v[76:79], a[4:7], v[132:135]
  s_waitcnt vmcnt(11) lgkmcnt(3)
  ds_read_b64_tr_b16 v[90:91], v29 offset:59392
  buffer_load_dwordx4 a[0:3], v1, s[28:31], s92 offen offset:2048 sc1
  v_mfma_f32_16x16x32_bf16 v[104:107], v[80:83], a[8:11], v[104:107]
  s_waitcnt vmcnt(11)
  ds_read_b64_tr_b16 v[92:93], v32 offset:57344
  buffer_load_dwordx4 a[4:7], v1, s[28:31], s93 offen offset:2048 sc1
  v_mfma_f32_16x16x32_bf16 v[120:123], v[80:83], a[12:15], v[120:123]
  s_waitcnt lgkmcnt(3)
  ds_read_b64_tr_b16 v[94:95], v32 offset:59392
  v_mfma_f32_16x16x32_bf16 v[108:111], v[84:87], a[8:11], v[108:111]
  ds_read_b64_tr_b16 v[72:73], v23 offset:0
  v_mfma_f32_16x16x32_bf16 v[124:127], v[84:87], a[12:15], v[124:127]
  s_waitcnt lgkmcnt(3)
  ds_read_b64_tr_b16 v[74:75], v23 offset:2048
  v_mfma_f32_16x16x32_bf16 v[112:115], v[88:91], a[8:11], v[112:115]
  ds_read_b64_tr_b16 v[76:77], v26 offset:0
  v_mfma_f32_16x16x32_bf16 v[128:131], v[88:91], a[12:15], v[128:131]
  s_waitcnt lgkmcnt(3)
  ds_read_b64_tr_b16 v[78:79], v26 offset:2048
  v_mfma_f32_16x16x32_bf16 v[116:119], v[92:95], a[8:11], v[116:119]
  ds_read_b64_tr_b16 v[80:81], v29 offset:0
  v_mfma_f32_16x16x32_bf16 v[132:135], v[92:95], a[12:15], v[132:135]
  s_waitcnt vmcnt(11) lgkmcnt(3)
  ds_read_b64_tr_b16 v[82:83], v29 offset:2048
  buffer_load_dwordx4 a[8:11], v1, s[28:31], s92 offen offset:3072 sc1
  v_mfma_f32_16x16x32_bf16 v[104:107], v[72:75], a[16:19], v[104:107]
  s_waitcnt vmcnt(11)
  ds_read_b64_tr_b16 v[84:85], v32 offset:0
  s_barrier
  v_mfma_f32_16x16x32_bf16 v[120:123], v[72:75], a[20:23], v[120:123]
  s_waitcnt lgkmcnt(3)
  ds_read_b64_tr_b16 v[86:87], v32 offset:2048
  buffer_load_dwordx4 a[12:15], v1, s[28:31], s93 offen offset:3072 sc1
  v_mfma_f32_16x16x32_bf16 v[108:111], v[76:79], a[16:19], v[108:111]
  ds_read_b64_tr_b16 v[88:89], v23 offset:8192
  s_add_u32 m0, s46, 100352
  s_add_u32 s52, s47, 622592
  buffer_load_dwordx4 v36, s[24:27], s52 offen lds
  v_mfma_f32_16x16x32_bf16 v[124:127], v[76:79], a[20:23], v[124:127]
  s_waitcnt lgkmcnt(3)
  ds_read_b64_tr_b16 v[90:91], v23 offset:10240
  s_add_u32 m0, s46, 104448
  s_add_u32 s52, s47, 1540096
  buffer_load_dwordx4 v36, s[24:27], s52 offen lds
  v_mfma_f32_16x16x32_bf16 v[112:115], v[80:83], a[16:19], v[112:115]
  ds_read_b64_tr_b16 v[92:93], v26 offset:8192
  v_mfma_f32_16x16x32_bf16 v[128:131], v[80:83], a[20:23], v[128:131]
  s_waitcnt lgkmcnt(3)
  ds_read_b64_tr_b16 v[94:95], v26 offset:10240
  v_mfma_f32_16x16x32_bf16 v[116:119], v[84:87], a[16:19], v[116:119]
  ds_read_b64_tr_b16 v[72:73], v29 offset:8192
  v_mfma_f32_16x16x32_bf16 v[132:135], v[84:87], a[20:23], v[132:135]
  s_waitcnt vmcnt(13) lgkmcnt(3)
  ds_read_b64_tr_b16 v[74:75], v29 offset:10240
  s_add_u32 s92, s50, 16384
  buffer_load_dwordx4 a[16:19], v1, s[28:31], s92 offen offset:0 sc1
  v_mfma_f32_16x16x32_bf16 v[104:107], v[88:91], a[24:27], v[104:107]
  s_waitcnt vmcnt(13)
  ds_read_b64_tr_b16 v[76:77], v32 offset:8192
  s_add_u32 s93, s51, 16384
  buffer_load_dwordx4 a[20:23], v1, s[28:31], s93 offen offset:0 sc1
  v_mfma_f32_16x16x32_bf16 v[120:123], v[88:91], a[28:31], v[120:123]
  s_waitcnt lgkmcnt(3)
  ds_read_b64_tr_b16 v[78:79], v32 offset:10240
  s_add_u32 m0, s46, 108544
  s_add_u32 s52, s47, 655360
  buffer_load_dwordx4 v36, s[24:27], s52 offen lds
  v_mfma_f32_16x16x32_bf16 v[108:111], v[92:95], a[24:27], v[108:111]
  ds_read_b64_tr_b16 v[80:81], v23 offset:16384
  v_mfma_f32_16x16x32_bf16 v[124:127], v[92:95], a[28:31], v[124:127]
  s_waitcnt lgkmcnt(3)
  ds_read_b64_tr_b16 v[82:83], v23 offset:18432
  s_add_u32 m0, s46, 112640
  s_add_u32 s52, s47, 1572864
  buffer_load_dwordx4 v36, s[24:27], s52 offen lds
  v_mfma_f32_16x16x32_bf16 v[112:115], v[72:75], a[24:27], v[112:115]
  ds_read_b64_tr_b16 v[84:85], v26 offset:16384
  v_mfma_f32_16x16x32_bf16 v[128:131], v[72:75], a[28:31], v[128:131]
  s_waitcnt lgkmcnt(3)
  ds_read_b64_tr_b16 v[86:87], v26 offset:18432
  v_mfma_f32_16x16x32_bf16 v[116:119], v[76:79], a[24:27], v[116:119]
  ds_read_b64_tr_b16 v[88:89], v29 offset:16384
  v_mfma_f32_16x16x32_bf16 v[132:135], v[76:79], a[28:31], v[132:135]
  s_waitcnt vmcnt(15) lgkmcnt(3)
  ds_read_b64_tr_b16 v[90:91], v29 offset:18432
  buffer_load_dwordx4 a[24:27], v1, s[28:31], s92 offen offset:1024 sc1
  v_mfma_f32_16x16x32_bf16 v[104:107], v[80:83], a[32:35], v[104:107]
  s_waitcnt vmcnt(15)
  ds_read_b64_tr_b16 v[92:93], v32 offset:16384
  buffer_load_dwordx4 a[28:31], v1, s[28:31], s93 offen offset:1024 sc1
  v_mfma_f32_16x16x32_bf16 v[120:123], v[80:83], a[36:39], v[120:123]
  s_waitcnt lgkmcnt(3)
  ds_read_b64_tr_b16 v[94:95], v32 offset:18432
  s_add_u32 m0, s46, 116736
  s_add_u32 s52, s47, 688128
  buffer_load_dwordx4 v36, s[24:27], s52 offen lds
  v_mfma_f32_16x16x32_bf16 v[108:111], v[84:87], a[32:35], v[108:111]
  ds_read_b64_tr_b16 v[72:73], v23 offset:32768
  v_mfma_f32_16x16x32_bf16 v[124:127], v[84:87], a[36:39], v[124:127]
  s_waitcnt lgkmcnt(3)
  ds_read_b64_tr_b16 v[74:75], v23 offset:34816
  s_add_u32 m0, s46, 120832
  s_add_u32 s52, s47, 1605632
  buffer_load_dwordx4 v36, s[24:27], s52 offen lds
  v_mfma_f32_16x16x32_bf16 v[112:115], v[88:91], a[32:35], v[112:115]
  ds_read_b64_tr_b16 v[76:77], v26 offset:32768
  v_mfma_f32_16x16x32_bf16 v[128:131], v[88:91], a[36:39], v[128:131]
  s_waitcnt lgkmcnt(3)
  ds_read_b64_tr_b16 v[78:79], v26 offset:34816
  v_mfma_f32_16x16x32_bf16 v[116:119], v[92:95], a[32:35], v[116:119]
  ds_read_b64_tr_b16 v[80:81], v29 offset:32768
  v_mfma_f32_16x16x32_bf16 v[132:135], v[92:95], a[36:39], v[132:135]
  s_waitcnt vmcnt(17) lgkmcnt(3)
  ds_read_b64_tr_b16 v[82:83], v29 offset:34816
  buffer_load_dwordx4 a[32:35], v1, s[28:31], s92 offen offset:2048 sc1
  v_mfma_f32_16x16x32_bf16 v[104:107], v[72:75], a[40:43], v[104:107]
  s_waitcnt vmcnt(17)
  ds_read_b64_tr_b16 v[84:85], v32 offset:32768
  buffer_load_dwordx4 a[36:39], v1, s[28:31], s93 offen offset:2048 sc1
  v_mfma_f32_16x16x32_bf16 v[120:123], v[72:75], a[44:47], v[120:123]
  s_waitcnt lgkmcnt(3)
  ds_read_b64_tr_b16 v[86:87], v32 offset:34816
  s_add_u32 m0, s46, 124928
  s_add_u32 s52, s47, 720896
  buffer_load_dwordx4 v36, s[24:27], s52 offen lds
  v_mfma_f32_16x16x32_bf16 v[108:111], v[76:79], a[40:43], v[108:111]
  ds_read_b64_tr_b16 v[88:89], v23 offset:40960
  v_mfma_f32_16x16x32_bf16 v[124:127], v[76:79], a[44:47], v[124:127]
  s_waitcnt lgkmcnt(3)
  ds_read_b64_tr_b16 v[90:91], v23 offset:43008
  s_add_u32 m0, s46, 129024
  s_add_u32 s52, s47, 1638400
  buffer_load_dwordx4 v36, s[24:27], s52 offen lds
  v_mfma_f32_16x16x32_bf16 v[112:115], v[80:83], a[40:43], v[112:115]
  ds_read_b64_tr_b16 v[92:93], v26 offset:40960
  v_mfma_f32_16x16x32_bf16 v[128:131], v[80:83], a[44:47], v[128:131]
  s_waitcnt lgkmcnt(3)
  ds_read_b64_tr_b16 v[94:95], v26 offset:43008
  v_mfma_f32_16x16x32_bf16 v[116:119], v[84:87], a[40:43], v[116:119]
  ds_read_b64_tr_b16 v[72:73], v29 offset:40960
  v_mfma_f32_16x16x32_bf16 v[132:135], v[84:87], a[44:47], v[132:135]
  s_waitcnt vmcnt(19) lgkmcnt(3)
  ds_read_b64_tr_b16 v[74:75], v29 offset:43008
  buffer_load_dwordx4 a[40:43], v1, s[28:31], s92 offen offset:3072 sc1
  v_mfma_f32_16x16x32_bf16 v[104:107], v[88:91], a[48:51], v[104:107]
  s_waitcnt vmcnt(19)
  ds_read_b64_tr_b16 v[76:77], v32 offset:40960
  buffer_load_dwordx4 a[44:47], v1, s[28:31], s93 offen offset:3072 sc1
  v_mfma_f32_16x16x32_bf16 v[120:123], v[88:91], a[52:55], v[120:123]
  s_waitcnt lgkmcnt(3)
  ds_read_b64_tr_b16 v[78:79], v32 offset:43008
  s_add_u32 m0, s46, 133120
  s_add_u32 s52, s47, 753664
  buffer_load_dwordx4 v36, s[24:27], s52 offen lds
  v_mfma_f32_16x16x32_bf16 v[108:111], v[92:95], a[48:51], v[108:111]
  ds_read_b64_tr_b16 v[80:81], v23 offset:49152
  v_mfma_f32_16x16x32_bf16 v[124:127], v[92:95], a[52:55], v[124:127]
  s_waitcnt lgkmcnt(3)
  ds_read_b64_tr_b16 v[82:83], v23 offset:51200
  s_add_u32 m0, s46, 137216
  s_add_u32 s52, s47, 1671168
  buffer_load_dwordx4 v36, s[24:27], s52 offen lds
  v_mfma_f32_16x16x32_bf16 v[112:115], v[72:75], a[48:51], v[112:115]
  ds_read_b64_tr_b16 v[84:85], v26 offset:49152
  v_mfma_f32_16x16x32_bf16 v[128:131], v[72:75], a[52:55], v[128:131]
  s_waitcnt lgkmcnt(3)
  ds_read_b64_tr_b16 v[86:87], v26 offset:51200
  v_mfma_f32_16x16x32_bf16 v[116:119], v[76:79], a[48:51], v[116:119]
  ds_read_b64_tr_b16 v[88:89], v29 offset:49152
  v_mfma_f32_16x16x32_bf16 v[132:135], v[76:79], a[52:55], v[132:135]
  s_waitcnt vmcnt(21) lgkmcnt(3)
  ds_read_b64_tr_b16 v[90:91], v29 offset:51200
  s_add_u32 s92, s50, 20480
  buffer_load_dwordx4 a[48:51], v1, s[28:31], s92 offen offset:0 sc1
  v_mfma_f32_16x16x32_bf16 v[104:107], v[80:83], a[0:3], v[104:107]
  s_waitcnt vmcnt(21)
  ds_read_b64_tr_b16 v[92:93], v32 offset:49152
  s_add_u32 s93, s51, 20480
  buffer_load_dwordx4 a[52:55], v1, s[28:31], s93 offen offset:0 sc1
  v_mfma_f32_16x16x32_bf16 v[120:123], v[80:83], a[4:7], v[120:123]
  s_waitcnt lgkmcnt(3)
  ds_read_b64_tr_b16 v[94:95], v32 offset:51200
  s_add_u32 m0, s46, 141312
  s_add_u32 s52, s47, 786432
  buffer_load_dwordx4 v36, s[24:27], s52 offen lds
  v_mfma_f32_16x16x32_bf16 v[108:111], v[84:87], a[0:3], v[108:111]
  ds_read_b64_tr_b16 v[72:73], v24 offset:0
  v_mfma_f32_16x16x32_bf16 v[124:127], v[84:87], a[4:7], v[124:127]
  s_waitcnt lgkmcnt(3)
  ds_read_b64_tr_b16 v[74:75], v24 offset:2048
  s_add_u32 m0, s46, 145408
  s_add_u32 s52, s47, 1703936
  buffer_load_dwordx4 v36, s[24:27], s52 offen lds
  v_mfma_f32_16x16x32_bf16 v[112:115], v[88:91], a[0:3], v[112:115]
  ds_read_b64_tr_b16 v[76:77], v27 offset:0
  v_mfma_f32_16x16x32_bf16 v[128:131], v[88:91], a[4:7], v[128:131]
  s_waitcnt lgkmcnt(3)
  ds_read_b64_tr_b16 v[78:79], v27 offset:2048
  v_mfma_f32_16x16x32_bf16 v[116:119], v[92:95], a[0:3], v[116:119]
  ds_read_b64_tr_b16 v[80:81], v30 offset:0
  v_mfma_f32_16x16x32_bf16 v[132:135], v[92:95], a[4:7], v[132:135]
  s_waitcnt vmcnt(23) lgkmcnt(3)
  ds_read_b64_tr_b16 v[82:83], v30 offset:2048
  buffer_load_dwordx4 a[0:3], v1, s[28:31], s92 offen offset:1024 sc1
  v_mfma_f32_16x16x32_bf16 v[104:107], v[72:75], a[8:11], v[104:107]
  s_waitcnt vmcnt(23)
  ds_read_b64_tr_b16 v[84:85], v33 offset:0
  buffer_load_dwordx4 a[4:7], v1, s[28:31], s93 offen offset:1024 sc1
  v_mfma_f32_16x16x32_bf16 v[120:123], v[72:75], a[12:15], v[120:123]
  s_waitcnt lgkmcnt(3)
  ds_read_b64_tr_b16 v[86:87], v33 offset:2048
  s_add_u32 m0, s46, 149504
  s_add_u32 s52, s47, 819200
  buffer_load_dwordx4 v36, s[24:27], s52 offen lds
  v_mfma_f32_16x16x32_bf16 v[108:111], v[76:79], a[8:11], v[108:111]
  ds_read_b64_tr_b16 v[88:89], v24 offset:8192
  v_mfma_f32_16x16x32_bf16 v[124:127], v[76:79], a[12:15], v[124:127]
  s_waitcnt lgkmcnt(3)
  ds_read_b64_tr_b16 v[90:91], v24 offset:10240
  s_add_u32 m0, s46, 153600
  s_add_u32 s52, s47, 1736704
  buffer_load_dwordx4 v36, s[24:27], s52 offen lds
  v_mfma_f32_16x16x32_bf16 v[112:115], v[80:83], a[8:11], v[112:115]
  ds_read_b64_tr_b16 v[92:93], v27 offset:8192
  v_mfma_f32_16x16x32_bf16 v[128:131], v[80:83], a[12:15], v[128:131]
  s_waitcnt lgkmcnt(3)
  ds_read_b64_tr_b16 v[94:95], v27 offset:10240
  v_mfma_f32_16x16x32_bf16 v[116:119], v[84:87], a[8:11], v[116:119]
  ds_read_b64_tr_b16 v[72:73], v30 offset:8192
  v_mfma_f32_16x16x32_bf16 v[132:135], v[84:87], a[12:15], v[132:135]
  s_waitcnt vmcnt(23) lgkmcnt(3)
  ds_read_b64_tr_b16 v[74:75], v30 offset:10240
  buffer_load_dwordx4 a[8:11], v1, s[28:31], s92 offen offset:2048 sc1
  v_mfma_f32_16x16x32_bf16 v[104:107], v[88:91], a[16:19], v[104:107]
  s_waitcnt vmcnt(23)
  ds_read_b64_tr_b16 v[76:77], v33 offset:8192
  buffer_load_dwordx4 a[12:15], v1, s[28:31], s93 offen offset:2048 sc1
  v_mfma_f32_16x16x32_bf16 v[120:123], v[88:91], a[20:23], v[120:123]
  s_waitcnt lgkmcnt(3)
  ds_read_b64_tr_b16 v[78:79], v33 offset:10240
  s_add_u32 m0, s46, 26624
  s_add_u32 s52, s47, 851968
  buffer_load_dwordx4 v36, s[24:27], s52 offen lds
  v_mfma_f32_16x16x32_bf16 v[108:111], v[92:95], a[16:19], v[108:111]
  ds_read_b64_tr_b16 v[80:81], v24 offset:16384
  v_mfma_f32_16x16x32_bf16 v[124:127], v[92:95], a[20:23], v[124:127]
  s_waitcnt lgkmcnt(3)
  ds_read_b64_tr_b16 v[82:83], v24 offset:18432
  s_add_u32 m0, s46, 30720
  s_add_u32 s52, s47, 1769472
  buffer_load_dwordx4 v36, s[24:27], s52 offen lds
  v_mfma_f32_16x16x32_bf16 v[112:115], v[72:75], a[16:19], v[112:115]
  ds_read_b64_tr_b16 v[84:85], v27 offset:16384
  v_mfma_f32_16x16x32_bf16 v[128:131], v[72:75], a[20:23], v[128:131]
  s_waitcnt lgkmcnt(3)
  ds_read_b64_tr_b16 v[86:87], v27 offset:18432
  v_mfma_f32_16x16x32_bf16 v[116:119], v[76:79], a[16:19], v[116:119]
  ds_read_b64_tr_b16 v[88:89], v30 offset:16384
  v_mfma_f32_16x16x32_bf16 v[132:135], v[76:79], a[20:23], v[132:135]
  s_waitcnt vmcnt(23) lgkmcnt(3)
  ds_read_b64_tr_b16 v[90:91], v30 offset:18432
  buffer_load_dwordx4 a[16:19], v1, s[28:31], s92 offen offset:3072 sc1
  v_mfma_f32_16x16x32_bf16 v[104:107], v[80:83], a[24:27], v[104:107]
  s_waitcnt vmcnt(23)
  ds_read_b64_tr_b16 v[92:93], v33 offset:16384
  buffer_load_dwordx4 a[20:23], v1, s[28:31], s93 offen offset:3072 sc1
  v_mfma_f32_16x16x32_bf16 v[120:123], v[80:83], a[28:31], v[120:123]
  s_waitcnt lgkmcnt(3)
  ds_read_b64_tr_b16 v[94:95], v33 offset:18432
  s_add_u32 m0, s46, 59392
  s_add_u32 s52, s47, 884736
  buffer_load_dwordx4 v36, s[24:27], s52 offen lds
  v_mfma_f32_16x16x32_bf16 v[108:111], v[84:87], a[24:27], v[108:111]
  ds_read_b64_tr_b16 v[72:73], v24 offset:24576
  v_mfma_f32_16x16x32_bf16 v[124:127], v[84:87], a[28:31], v[124:127]
  s_waitcnt lgkmcnt(3)
  ds_read_b64_tr_b16 v[74:75], v24 offset:26624
  s_add_u32 m0, s46, 63488
  s_add_u32 s52, s47, 1802240
  buffer_load_dwordx4 v36, s[24:27], s52 offen lds
  v_mfma_f32_16x16x32_bf16 v[112:115], v[88:91], a[24:27], v[112:115]
  ds_read_b64_tr_b16 v[76:77], v27 offset:24576
  v_mfma_f32_16x16x32_bf16 v[128:131], v[88:91], a[28:31], v[128:131]
  s_waitcnt lgkmcnt(3)
  ds_read_b64_tr_b16 v[78:79], v27 offset:26624
  v_mfma_f32_16x16x32_bf16 v[116:119], v[92:95], a[24:27], v[116:119]
  ds_read_b64_tr_b16 v[80:81], v30 offset:24576
  v_mfma_f32_16x16x32_bf16 v[132:135], v[92:95], a[28:31], v[132:135]
  s_waitcnt vmcnt(23) lgkmcnt(3)
  ds_read_b64_tr_b16 v[82:83], v30 offset:26624
  s_add_u32 s92, s50, 24576
  buffer_load_dwordx4 a[24:27], v1, s[28:31], s92 offen offset:0 sc1
  v_mfma_f32_16x16x32_bf16 v[104:107], v[72:75], a[32:35], v[104:107]
  s_waitcnt vmcnt(23)
  ds_read_b64_tr_b16 v[84:85], v33 offset:24576
  s_add_u32 s93, s51, 24576
  buffer_load_dwordx4 a[28:31], v1, s[28:31], s93 offen offset:0 sc1
  v_mfma_f32_16x16x32_bf16 v[120:123], v[72:75], a[36:39], v[120:123]
  s_waitcnt lgkmcnt(3)
  ds_read_b64_tr_b16 v[86:87], v33 offset:26624
  v_mfma_f32_16x16x32_bf16 v[108:111], v[76:79], a[32:35], v[108:111]
  s_barrier
  ds_read_b64_tr_b16 v[88:89], v24 offset:32768
  v_mfma_f32_16x16x32_bf16 v[124:127], v[76:79], a[36:39], v[124:127]
  s_waitcnt lgkmcnt(3)
  ds_read_b64_tr_b16 v[90:91], v24 offset:34816
  v_mfma_f32_16x16x32_bf16 v[112:115], v[80:83], a[32:35], v[112:115]
  ds_read_b64_tr_b16 v[92:93], v27 offset:32768
  v_mfma_f32_16x16x32_bf16 v[128:131], v[80:83], a[36:39], v[128:131]
  s_waitcnt lgkmcnt(3)
  ds_read_b64_tr_b16 v[94:95], v27 offset:34816
  v_mfma_f32_16x16x32_bf16 v[116:119], v[84:87], a[32:35], v[116:119]
  ds_read_b64_tr_b16 v[72:73], v30 offset:32768
  v_mfma_f32_16x16x32_bf16 v[132:135], v[84:87], a[36:39], v[132:135]
  s_waitcnt vmcnt(21) lgkmcnt(3)
  ds_read_b64_tr_b16 v[74:75], v30 offset:34816
  buffer_load_dwordx4 a[32:35], v1, s[28:31], s92 offen offset:1024 sc1
  v_mfma_f32_16x16x32_bf16 v[104:107], v[88:91], a[40:43], v[104:107]
  s_waitcnt vmcnt(21)
  ds_read_b64_tr_b16 v[76:77], v33 offset:32768
  s_barrier
  v_mfma_f32_16x16x32_bf16 v[120:123], v[88:91], a[44:47], v[120:123]
  s_waitcnt lgkmcnt(3)
  ds_read_b64_tr_b16 v[78:79], v33 offset:34816
  buffer_load_dwordx4 a[36:39], v1, s[28:31], s93 offen offset:1024 sc1
  v_mfma_f32_16x16x32_bf16 v[108:111], v[92:95], a[40:43], v[108:111]
  s_barrier
  ds_read_b64_tr_b16 v[80:81], v24 offset:40960
  s_mov_b64 exec, s[74:75]
  ds_write_b128 v228, a[160:163] offset:0
  s_mov_b64 exec, -1
  v_mfma_f32_16x16x32_bf16 v[124:127], v[92:95], a[44:47], v[124:127]
  s_waitcnt lgkmcnt(4)
  ds_read_b64_tr_b16 v[82:83], v24 offset:43008
  v_mfma_f32_16x16x32_bf16 v[112:115], v[72:75], a[40:43], v[112:115]
  ds_read_b64_tr_b16 v[84:85], v27 offset:40960
  s_mov_b64 exec, s[74:75]
  ds_write_b128 v228, a[164:167] offset:4096
  s_mov_b64 exec, -1
  v_mfma_f32_16x16x32_bf16 v[128:131], v[72:75], a[44:47], v[128:131]
  s_waitcnt lgkmcnt(5)
  ds_read_b64_tr_b16 v[86:87], v27 offset:43008
  v_mfma_f32_16x16x32_bf16 v[116:119], v[76:79], a[40:43], v[116:119]
  ds_read_b64_tr_b16 v[88:89], v30 offset:40960
  v_mfma_f32_16x16x32_bf16 v[132:135], v[76:79], a[44:47], v[132:135]
  s_waitcnt vmcnt(19) lgkmcnt(4)
  ds_read_b64_tr_b16 v[90:91], v30 offset:43008
  buffer_load_dwordx4 a[40:43], v1, s[28:31], s92 offen offset:2048 sc1
  v_mfma_f32_16x16x32_bf16 v[104:107], v[80:83], a[48:51], v[104:107]
  s_waitcnt vmcnt(19)
  ds_read_b64_tr_b16 v[92:93], v33 offset:40960
  s_mov_b64 exec, s[74:75]
  ds_write_b128 v228, a[168:171] offset:8192
  s_mov_b64 exec, -1
  v_mfma_f32_16x16x32_bf16 v[120:123], v[80:83], a[52:55], v[120:123]
  s_waitcnt lgkmcnt(4)
  ds_read_b64_tr_b16 v[94:95], v33 offset:43008
  buffer_load_dwordx4 a[44:47], v1, s[28:31], s93 offen offset:2048 sc1
  v_mfma_f32_16x16x32_bf16 v[108:111], v[84:87], a[48:51], v[108:111]
  s_barrier
  ds_read_b64_tr_b16 v[72:73], v24 offset:49152
  v_mfma_f32_16x16x32_bf16 v[124:127], v[84:87], a[52:55], v[124:127]
  s_waitcnt lgkmcnt(4)
  ds_read_b64_tr_b16 v[74:75], v24 offset:51200
  s_mov_b64 exec, s[74:75]
  ds_write_b128 v228, a[172:175] offset:12288
  s_mov_b64 exec, -1
  v_mfma_f32_16x16x32_bf16 v[112:115], v[88:91], a[48:51], v[112:115]
  ds_read_b64_tr_b16 v[76:77], v27 offset:49152
  v_mfma_f32_16x16x32_bf16 v[128:131], v[88:91], a[52:55], v[128:131]
  s_waitcnt lgkmcnt(4)
  ds_read_b64_tr_b16 v[78:79], v27 offset:51200
  v_mfma_f32_16x16x32_bf16 v[116:119], v[92:95], a[48:51], v[116:119]
  ds_read_b64_tr_b16 v[80:81], v30 offset:49152
  s_mov_b64 exec, s[74:75]
  ds_write_b128 v228, a[176:179] offset:16384
  s_mov_b64 exec, -1
  v_mfma_f32_16x16x32_bf16 v[132:135], v[92:95], a[52:55], v[132:135]
  s_waitcnt vmcnt(17) lgkmcnt(5)
  ds_read_b64_tr_b16 v[82:83], v30 offset:51200
  buffer_load_dwordx4 a[48:51], v1, s[28:31], s92 offen offset:3072 sc1
  v_mfma_f32_16x16x32_bf16 v[104:107], v[72:75], a[0:3], v[104:107]
  s_waitcnt vmcnt(17)
  ds_read_b64_tr_b16 v[84:85], v33 offset:49152
  buffer_load_dwordx4 a[52:55], v1, s[28:31], s93 offen offset:3072 sc1
  v_mfma_f32_16x16x32_bf16 v[120:123], v[72:75], a[4:7], v[120:123]
  s_waitcnt lgkmcnt(4)
  ds_read_b64_tr_b16 v[86:87], v33 offset:51200
  v_mfma_f32_16x16x32_bf16 v[108:111], v[76:79], a[0:3], v[108:111]
  s_barrier
  ds_read_b64_tr_b16 v[88:89], v24 offset:57344
  s_mov_b64 exec, s[74:75]
  ds_write_b128 v228, a[180:183] offset:20480
  s_mov_b64 exec, -1
  v_mfma_f32_16x16x32_bf16 v[124:127], v[76:79], a[4:7], v[124:127]
  s_waitcnt lgkmcnt(4)
  ds_read_b64_tr_b16 v[90:91], v24 offset:59392
  v_mfma_f32_16x16x32_bf16 v[112:115], v[80:83], a[0:3], v[112:115]
  ds_read_b64_tr_b16 v[92:93], v27 offset:57344
  v_mfma_f32_16x16x32_bf16 v[128:131], v[80:83], a[4:7], v[128:131]
  s_waitcnt lgkmcnt(4)
  ds_read_b64_tr_b16 v[94:95], v27 offset:59392
  s_mov_b64 exec, s[74:75]
  ds_write_b128 v228, a[192:195] offset:32768
  s_mov_b64 exec, -1
  v_mfma_f32_16x16x32_bf16 v[116:119], v[84:87], a[0:3], v[116:119]
  ds_read_b64_tr_b16 v[72:73], v30 offset:57344
  v_mfma_f32_16x16x32_bf16 v[132:135], v[84:87], a[4:7], v[132:135]
  s_waitcnt vmcnt(15) lgkmcnt(4)
  ds_read_b64_tr_b16 v[74:75], v30 offset:59392
  v_mfma_f32_16x16x32_bf16 v[104:107], v[88:91], a[8:11], v[104:107]
  s_waitcnt vmcnt(14)
  ds_read_b64_tr_b16 v[76:77], v33 offset:57344
  s_mov_b64 exec, s[74:75]
  ds_write_b128 v228, a[196:199] offset:36864
  s_mov_b64 exec, -1
  v_mfma_f32_16x16x32_bf16 v[120:123], v[88:91], a[12:15], v[120:123]
  s_waitcnt lgkmcnt(5)
  ds_read_b64_tr_b16 v[78:79], v33 offset:59392
  v_mfma_f32_16x16x32_bf16 v[108:111], v[92:95], a[8:11], v[108:111]
  s_barrier
  ds_read_b64_tr_b16 v[80:81], v25 offset:0
  v_mfma_f32_16x16x32_bf16 v[124:127], v[92:95], a[12:15], v[124:127]
  s_waitcnt lgkmcnt(4)
  ds_read_b64_tr_b16 v[82:83], v25 offset:2048
  v_mfma_f32_16x16x32_bf16 v[112:115], v[72:75], a[8:11], v[112:115]
  ds_read_b64_tr_b16 v[84:85], v28 offset:0
  s_mov_b64 exec, s[74:75]
  ds_write_b128 v228, a[200:203] offset:40960
  s_mov_b64 exec, -1
  v_mfma_f32_16x16x32_bf16 v[128:131], v[72:75], a[12:15], v[128:131]
  s_waitcnt lgkmcnt(4)
  ds_read_b64_tr_b16 v[86:87], v28 offset:2048
  v_mfma_f32_16x16x32_bf16 v[116:119], v[76:79], a[8:11], v[116:119]
  ds_read_b64_tr_b16 v[88:89], v31 offset:0
  v_mfma_f32_16x16x32_bf16 v[132:135], v[76:79], a[12:15], v[132:135]
  s_waitcnt vmcnt(11) lgkmcnt(4)
  ds_read_b64_tr_b16 v[90:91], v31 offset:2048
  s_mov_b64 exec, s[74:75]
  ds_write_b128 v228, a[204:207] offset:45056
  s_mov_b64 exec, -1
  v_mfma_f32_16x16x32_bf16 v[104:107], v[80:83], a[16:19], v[104:107]
  s_waitcnt vmcnt(10)
  ds_read_b64_tr_b16 v[92:93], v34 offset:0
  v_mfma_f32_16x16x32_bf16 v[120:123], v[80:83], a[20:23], v[120:123]
  s_waitcnt lgkmcnt(4)
  ds_read_b64_tr_b16 v[94:95], v34 offset:2048
  v_mfma_f32_16x16x32_bf16 v[108:111], v[84:87], a[16:19], v[108:111]
  s_barrier
  ds_read_b64_tr_b16 v[72:73], v25 offset:8192
  v_mfma_f32_16x16x32_bf16 v[124:127], v[84:87], a[20:23], v[124:127]
  s_waitcnt lgkmcnt(4)
  ds_read_b64_tr_b16 v[74:75], v25 offset:10240
  s_mov_b64 exec, s[74:75]
  ds_write_b128 v228, a[208:211] offset:49152
  s_mov_b64 exec, -1
  v_mfma_f32_16x16x32_bf16 v[112:115], v[88:91], a[16:19], v[112:115]
  ds_read_b64_tr_b16 v[76:77], v28 offset:8192
  v_mfma_f32_16x16x32_bf16 v[128:131], v[88:91], a[20:23], v[128:131]
  s_waitcnt lgkmcnt(4)
  ds_read_b64_tr_b16 v[78:79], v28 offset:10240
  v_mfma_f32_16x16x32_bf16 v[116:119], v[92:95], a[16:19], v[116:119]
  ds_read_b64_tr_b16 v[80:81], v31 offset:8192
  s_mov_b64 exec, s[74:75]
  ds_write_b128 v228, a[212:215] offset:53248
  s_mov_b64 exec, -1
  v_mfma_f32_16x16x32_bf16 v[132:135], v[92:95], a[20:23], v[132:135]
  s_waitcnt vmcnt(7) lgkmcnt(5)
  ds_read_b64_tr_b16 v[82:83], v31 offset:10240
  v_mfma_f32_16x16x32_bf16 v[104:107], v[72:75], a[24:27], v[104:107]
  s_waitcnt vmcnt(6)
  ds_read_b64_tr_b16 v[84:85], v34 offset:8192
  v_mfma_f32_16x16x32_bf16 v[120:123], v[72:75], a[28:31], v[120:123]
  s_waitcnt lgkmcnt(4)
  ds_read_b64_tr_b16 v[86:87], v34 offset:10240
  s_mov_b64 exec, s[74:75]
  ds_write_b128 v229, a[224:227] offset:0
  s_mov_b64 exec, -1
  v_mfma_f32_16x16x32_bf16 v[108:111], v[76:79], a[24:27], v[108:111]
  s_barrier
  ds_read_b64_tr_b16 v[88:89], v25 offset:16384
  v_mfma_f32_16x16x32_bf16 v[124:127], v[76:79], a[28:31], v[124:127]
  s_waitcnt lgkmcnt(4)
  ds_read_b64_tr_b16 v[90:91], v25 offset:18432
  v_mfma_f32_16x16x32_bf16 v[112:115], v[80:83], a[24:27], v[112:115]
  ds_read_b64_tr_b16 v[92:93], v28 offset:16384
  v_mfma_f32_16x16x32_bf16 v[128:131], v[80:83], a[28:31], v[128:131]
  s_waitcnt lgkmcnt(4)
  ds_read_b64_tr_b16 v[94:95], v28 offset:18432
  s_mov_b64 exec, s[74:75]
  ds_write_b128 v229, a[228:231] offset:4096
  s_mov_b64 exec, -1
  v_mfma_f32_16x16x32_bf16 v[116:119], v[84:87], a[24:27], v[116:119]
  ds_read_b64_tr_b16 v[72:73], v31 offset:16384
  v_mfma_f32_16x16x32_bf16 v[132:135], v[84:87], a[28:31], v[132:135]
  s_waitcnt vmcnt(5) lgkmcnt(4)
  ds_read_b64_tr_b16 v[74:75], v31 offset:18432
  v_mfma_f32_16x16x32_bf16 v[104:107], v[88:91], a[32:35], v[104:107]
  s_waitcnt vmcnt(4)
  ds_read_b64_tr_b16 v[76:77], v34 offset:16384
  s_mov_b64 exec, s[74:75]
  ds_write_b128 v229, a[232:235] offset:8192
  s_mov_b64 exec, -1
  v_mfma_f32_16x16x32_bf16 v[120:123], v[88:91], a[36:39], v[120:123]
  s_waitcnt lgkmcnt(5)
  ds_read_b64_tr_b16 v[78:79], v34 offset:18432
  v_mfma_f32_16x16x32_bf16 v[108:111], v[92:95], a[32:35], v[108:111]
  s_barrier
  ds_read_b64_tr_b16 v[80:81], v23 offset:24576
  v_mfma_f32_16x16x32_bf16 v[124:127], v[92:95], a[36:39], v[124:127]
  s_waitcnt lgkmcnt(4)
  ds_read_b64_tr_b16 v[82:83], v23 offset:26624
  v_mfma_f32_16x16x32_bf16 v[112:115], v[72:75], a[32:35], v[112:115]
  ds_read_b64_tr_b16 v[84:85], v26 offset:24576
  s_mov_b64 exec, s[74:75]
  ds_write_b128 v229, a[236:239] offset:12288
  s_mov_b64 exec, -1
  v_mfma_f32_16x16x32_bf16 v[128:131], v[72:75], a[36:39], v[128:131]
  s_waitcnt lgkmcnt(4)
  ds_read_b64_tr_b16 v[86:87], v26 offset:26624
  v_mfma_f32_16x16x32_bf16 v[116:119], v[76:79], a[32:35], v[116:119]
  ds_read_b64_tr_b16 v[88:89], v29 offset:24576
  v_mfma_f32_16x16x32_bf16 v[132:135], v[76:79], a[36:39], v[132:135]
  s_waitcnt vmcnt(3) lgkmcnt(4)
  ds_read_b64_tr_b16 v[90:91], v29 offset:26624
  s_mov_b64 exec, s[74:75]
  ds_write_b128 v229, a[240:243] offset:16384
  s_mov_b64 exec, -1
  v_mfma_f32_16x16x32_bf16 v[104:107], v[80:83], a[40:43], v[104:107]
  s_waitcnt vmcnt(2)
  ds_read_b64_tr_b16 v[92:93], v32 offset:24576
  v_mfma_f32_16x16x32_bf16 v[120:123], v[80:83], a[44:47], v[120:123]
  s_waitcnt lgkmcnt(4)
  ds_read_b64_tr_b16 v[94:95], v32 offset:26624
  v_mfma_f32_16x16x32_bf16 v[108:111], v[84:87], a[40:43], v[108:111]
  s_barrier
  ds_read_b64_tr_b16 v[72:73], v23 offset:57344
  s_mov_b64 exec, s[74:75]
  ds_write_b128 v229, a[244:247] offset:20480
  s_mov_b64 exec, -1
  v_mfma_f32_16x16x32_bf16 v[124:127], v[84:87], a[44:47], v[124:127]
  s_waitcnt lgkmcnt(5)
  ds_read_b64_tr_b16 v[74:75], v23 offset:59392
  v_mfma_f32_16x16x32_bf16 v[112:115], v[88:91], a[40:43], v[112:115]
  ds_read_b64_tr_b16 v[76:77], v26 offset:57344
  v_mfma_f32_16x16x32_bf16 v[128:131], v[88:91], a[44:47], v[128:131]
  s_waitcnt lgkmcnt(4)
  ds_read_b64_tr_b16 v[78:79], v26 offset:59392
  v_mfma_f32_16x16x32_bf16 v[116:119], v[92:95], a[40:43], v[116:119]
  ds_read_b64_tr_b16 v[80:81], v29 offset:57344
  s_mov_b64 exec, s[74:75]
  ds_write_b128 v229, a[248:251] offset:24576
  s_mov_b64 exec, -1
  v_mfma_f32_16x16x32_bf16 v[132:135], v[92:95], a[44:47], v[132:135]
  s_waitcnt vmcnt(1) lgkmcnt(4)
  ds_read_b64_tr_b16 v[82:83], v29 offset:59392
  v_mfma_f32_16x16x32_bf16 v[104:107], v[72:75], a[48:51], v[104:107]
  s_waitcnt vmcnt(0)
  ds_read_b64_tr_b16 v[84:85], v32 offset:57344
  v_mfma_f32_16x16x32_bf16 v[120:123], v[72:75], a[52:55], v[120:123]
  s_waitcnt lgkmcnt(4)
  ds_read_b64_tr_b16 v[86:87], v32 offset:59392
  s_mov_b64 exec, s[74:75]
  ds_write_b128 v229, a[252:255] offset:28672
  s_mov_b64 exec, -1
  v_mfma_f32_16x16x32_bf16 v[108:111], v[76:79], a[48:51], v[108:111]
  v_mfma_f32_16x16x32_bf16 v[124:127], v[76:79], a[52:55], v[124:127]
  s_waitcnt lgkmcnt(3)
  v_mfma_f32_16x16x32_bf16 v[112:115], v[80:83], a[48:51], v[112:115]
  v_mfma_f32_16x16x32_bf16 v[128:131], v[80:83], a[52:55], v[128:131]
  s_waitcnt lgkmcnt(1)
  v_mfma_f32_16x16x32_bf16 v[116:119], v[84:87], a[48:51], v[116:119]
  v_mfma_f32_16x16x32_bf16 v[132:135], v[84:87], a[52:55], v[132:135]
  s_barrier
  v_add_u32 v254, 100352, v66
  v_add_u32 v255, 100352, v67
  s_mov_b64 exec, s[74:75]
  ds_write_b128 v228, a[184:187] offset:24576
  s_mov_b64 exec, -1
  s_mov_b64 exec, s[74:75]
  ds_write_b128 v228, a[188:191] offset:28672
  s_mov_b64 exec, -1
  s_mov_b64 exec, s[74:75]
  ds_write_b128 v228, a[216:219] offset:57344
  s_mov_b64 exec, -1
  s_mov_b64 exec, s[74:75]
  ds_write_b128 v228, a[220:223] offset:61440
  s_mov_b64 exec, -1
  ds_write_b128 v254, v[120:123] offset:0
  ds_write_b128 v254, v[124:127] offset:1024
  ds_write_b128 v254, v[128:131] offset:2048
  ds_write_b128 v254, v[132:135] offset:3072
  s_waitcnt lgkmcnt(0)
  s_barrier
  ds_read_b128 v[168:171], v255 offset:0
  ds_read_b128 v[172:175], v255 offset:1024
  ds_read_b128 v[176:179], v255 offset:2048
  ds_read_b128 v[180:183], v255 offset:3072
  v_lshlrev_b32 v184, 16, v2
  v_and_b32 v185, 0xffff0000, v2
  v_lshlrev_b32 v186, 16, v3
  v_and_b32 v187, 0xffff0000, v3
  v_lshlrev_b32 v188, 16, v4
  v_and_b32 v189, 0xffff0000, v4
  v_lshlrev_b32 v190, 16, v5
  v_and_b32 v191, 0xffff0000, v5
  v_lshlrev_b32 v192, 16, v6
  v_and_b32 v193, 0xffff0000, v6
  v_lshlrev_b32 v194, 16, v7
  v_and_b32 v195, 0xffff0000, v7
  v_lshlrev_b32 v196, 16, v8
  v_and_b32 v197, 0xffff0000, v8
  v_lshlrev_b32 v198, 16, v9
  v_and_b32 v199, 0xffff0000, v9
  v_pk_add_f32 v[104:105], v[104:105], v[184:185]
  v_pk_add_f32 v[106:107], v[106:107], v[186:187]
  v_pk_add_f32 v[108:109], v[108:109], v[188:189]
  v_pk_add_f32 v[110:111], v[110:111], v[190:191]
  v_pk_add_f32 v[112:113], v[112:113], v[192:193]
  v_pk_add_f32 v[114:115], v[114:115], v[194:195]
  v_pk_add_f32 v[116:117], v[116:117], v[196:197]
  v_pk_add_f32 v[118:119], v[118:119], v[198:199]
  s_waitcnt lgkmcnt(3)
  v_pk_add_f32 v[104:105], v[104:105], v[168:169]
  v_pk_add_f32 v[106:107], v[106:107], v[170:171]
  s_waitcnt lgkmcnt(2)
  v_pk_add_f32 v[108:109], v[108:109], v[172:173]
  v_pk_add_f32 v[110:111], v[110:111], v[174:175]
  s_waitcnt lgkmcnt(1)
  v_pk_add_f32 v[112:113], v[112:113], v[176:177]
  v_pk_add_f32 v[114:115], v[114:115], v[178:179]
  s_waitcnt lgkmcnt(0)
  v_pk_add_f32 v[116:117], v[116:117], v[180:181]
  v_pk_add_f32 v[118:119], v[118:119], v[182:183]
  v_cvt_pk_bf16_f32 v2, v104, v105
  v_cvt_pk_bf16_f32 v3, v106, v107
  v_cvt_pk_bf16_f32 v4, v108, v109
  v_cvt_pk_bf16_f32 v5, v110, v111
  v_cvt_pk_bf16_f32 v6, v112, v113
  v_cvt_pk_bf16_f32 v7, v114, v115
  v_cvt_pk_bf16_f32 v8, v116, v117
  v_cvt_pk_bf16_f32 v9, v118, v119
L_C5:
  s_cmp_lg_u32 s3, 0
  s_nop 0
  s_cbranch_scc1 L_FINAL
  s_mul_i32 s53, s86, 16384
  s_add_u32 s53, s53, s98
  s_lshl_b32 s54, s60, 11
  s_add_u32 s53, s53, s54
  s_lshl_b32 s54, s86, 10
  s_add_u32 s54, s54, s99
  s_mov_b32 s55, 0
  s_add_u32 s55, s55, s53
  s_cmp_eq_u32 s7, 0
  s_cbranch_scc1 stp_44
  buffer_store_dwordx4 v[2:5], v1, s[28:31], s53 offen sc1
  buffer_store_dwordx4 v[6:9], v1, s[28:31], s55 offen offset:1024 sc1
  s_nop 1
  s_branch std_45
stp_44:
  buffer_store_dwordx4 v[2:5], v1, s[28:31], s53 offen
  buffer_store_dwordx4 v[6:9], v1, s[28:31], s55 offen offset:1024
std_45:
  v_mov_b32 v200, 0
  v_mov_b32 v201, 0
  v_mov_b32 v202, 0
  v_mov_b32 v203, 0
  v_dot2c_f32_bf16 v200, v2, v10
  v_dot2c_f32_bf16 v201, v2, v2
  v_dot2c_f32_bf16 v202, v3, v10
  v_dot2c_f32_bf16 v203, v3, v3
  v_dot2c_f32_bf16 v200, v4, v10
  v_dot2c_f32_bf16 v201, v4, v4
  v_dot2c_f32_bf16 v202, v5, v10
  v_dot2c_f32_bf16 v203, v5, v5
  v_dot2c_f32_bf16 v200, v6, v10
  v_dot2c_f32_bf16 v201, v6, v6
  v_dot2c_f32_bf16 v202, v7, v10
  v_dot2c_f32_bf16 v203, v7, v7
  v_dot2c_f32_bf16 v200, v8, v10
  v_dot2c_f32_bf16 v201, v8, v8
  v_dot2c_f32_bf16 v202, v9, v10
  v_dot2c_f32_bf16 v203, v9, v9
  s_nop 1
  v_add_f32 v200, v200, v202
  v_add_f32 v201, v201, v203
  s_nop 1
  v_permlane32_swap_b32 v200, v201
  v_add_f32 v200, v200, v201
  v_mov_b32 v252, v200
  s_nop 1
  v_permlane16_swap_b32 v200, v252
  v_add_f32 v200, v200, v252
  v_mov_b32 v201, v200
  s_nop 1
  v_permlane32_swap_b32 v200, v201
  s_mov_b64 exec, 0xffff
  s_cmp_eq_u32 s7, 0
  s_cbranch_scc1 stp_46
  buffer_store_dwordx2 v[200:201], v68, s[28:31], s54 offen sc1
  s_branch std_47
stp_46:
  buffer_store_dwordx2 v[200:201], v68, s[28:31], s54 offen
std_47:
  s_mov_b64 exec, -1
  s_add_u32 s52, s4, 1
  s_lshl_b32 s53, s52, 14
  s_lshl_b32 s54, s60, 11
  s_add_u32 s53, s53, s54
  s_add_u32 s53, s53, 589824
  s_lshl_b32 s54, s52, 10
  s_add_u32 s54, s54, 524288
  buffer_store_dwordx4 v[2:5], v69, s[28:31], s53 offen sc1
  s_mov_b32 s55, 0
  s_add_u32 s55, s55, s53
  buffer_store_dwordx4 v[6:9], v69, s[28:31], s55 offen offset:1024 sc1
  buffer_store_dwordx2 v[200:201], v70, s[28:31], s54 offen sc1
  s_add_u32 s76, s78, 4
  v_mov_b32 v254, s76
  v_mov_b32 v255, 0
  v_lshlrev_b32 v250, 2, v0
  s_waitcnt vmcnt(3)
  s_mov_b64 exec, 1
  s_cmp_eq_u32 s7, 0
  s_cbranch_scc1 fp_48
  buffer_store_dword v254, v255, s[28:31], s56 offen sc1
  s_branch fd_49
fp_48:
  buffer_store_dword v254, v255, s[28:31], s56 offen
fd_49:
  s_mov_b64 exec, -1
  s_cmp_lg_u32 s6, 0
  s_cbranch_scc1 so_50
  s_mov_b32 s77, 0
  buffer_load_dword v248, v250, s[28:31], s57 offen sc1
sp_52:
  buffer_load_dword v249, v250, s[28:31], s57 offen sc1
  s_waitcnt vmcnt(1)
  v_cmp_gt_u32 vcc, s76, v248
  s_add_u32 s77, s77, 1
  s_cbranch_vccz sj_51
  buffer_load_dword v248, v250, s[28:31], s57 offen sc1
  s_waitcnt vmcnt(1)
  v_cmp_gt_u32 vcc, s76, v249
  s_cmp_lt_u32 s77, 0x80000
  s_cbranch_vccz sj_51
  s_nop 2
  s_cbranch_scc1 sp_52
  s_endpgm
so_50:
sj_51:
  s_waitcnt vmcnt(0) lgkmcnt(0)
  s_barrier
  s_mov_b32 s3, 1
  s_add_u32 s94, s94, s83
  s_add_u32 s95, s95, s84
  s_add_u32 s96, s96, s85
  s_add_u32 s97, s97, s82
  s_lshl_b32 s53, s6, 1
  s_add_u32 s53, s53, 0
  s_lshl_b32 s53, s53, 14
  s_add_u32 s50, s53, s98
  s_lshl_b32 s53, s6, 1
  s_add_u32 s53, s53, 1
  s_lshl_b32 s53, s53, 14
  s_add_u32 s51, s53, s98
  s_add_u32 s92, s50, 0
  buffer_load_dwordx4 a[0:3], v1, s[28:31], s92 offen offset:0 sc1
  s_add_u32 s93, s51, 0
  buffer_load_dwordx4 a[4:7], v1, s[28:31], s93 offen offset:0 sc1
  buffer_load_dwordx4 a[8:11], v1, s[28:31], s92 offen offset:1024 sc1
  buffer_load_dwordx4 a[12:15], v1, s[28:31], s93 offen offset:1024 sc1
  buffer_load_dwordx4 a[16:19], v1, s[28:31], s92 offen offset:2048 sc1
  buffer_load_dwordx4 a[20:23], v1, s[28:31], s93 offen offset:2048 sc1
  buffer_load_dwordx4 a[24:27], v1, s[28:31], s92 offen offset:3072 sc1
  buffer_load_dwordx4 a[28:31], v1, s[28:31], s93 offen offset:3072 sc1
  s_lshl_b32 s54, s6, 11
  s_add_u32 s53, s54, s99
  s_add_u32 s53, s53, 0
  buffer_load_dwordx4 v[180:183], v1, s[28:31], s53 offen sc1
  s_lshl_b32 s54, s6, 11
  s_add_u32 s53, s54, s99
  s_add_u32 s53, s53, 1024
  buffer_load_dwordx4 v[184:187], v1, s[28:31], s53 offen sc1
  ds_read_b64_tr_b16 v[72:73], v14 offset:0
  ds_read_b64_tr_b16 v[74:75], v14 offset:1024
  ds_read_b64_tr_b16 v[76:77], v15 offset:0
  ds_read_b64_tr_b16 v[78:79], v15 offset:1024
  ds_read_b64_tr_b16 v[80:81], v14 offset:32768
  ds_read_b64_tr_b16 v[82:83], v14 offset:33792
  s_waitcnt vmcnt(9) lgkmcnt(4)
  v_mfma_f32_16x16x32_bf16 v[104:107], v[72:75], a[0:3], 0
  s_waitcnt vmcnt(8)
  ds_read_b64_tr_b16 v[84:85], v15 offset:32768
  v_mfma_f32_16x16x32_bf16 v[108:111], v[72:75], a[4:7], 0
  s_waitcnt lgkmcnt(3)
  ds_read_b64_tr_b16 v[86:87], v15 offset:33792
  s_add_u32 s92, s50, 4096
  buffer_load_dwordx4 a[32:35], v1, s[28:31], s92 offen offset:0 sc1
  v_mfma_f32_16x16x32_bf16 v[112:115], v[76:79], a[0:3], 0
  ds_read_b64_tr_b16 v[88:89], v16 offset:0
  v_mfma_f32_16x16x32_bf16 v[116:119], v[76:79], a[4:7], 0
  s_waitcnt lgkmcnt(3)
  ds_read_b64_tr_b16 v[90:91], v16 offset:1024
  v_mfma_f32_16x16x32_bf16 v[120:123], v[80:83], a[0:3], 0
  ds_read_b64_tr_b16 v[92:93], v17 offset:0
  s_add_u32 s93, s51, 4096
  buffer_load_dwordx4 a[36:39], v1, s[28:31], s93 offen offset:0 sc1
  v_mfma_f32_16x16x32_bf16 v[124:127], v[80:83], a[4:7], 0
  s_waitcnt lgkmcnt(3)
  ds_read_b64_tr_b16 v[94:95], v17 offset:1024
  v_mfma_f32_16x16x32_bf16 v[128:131], v[84:87], a[0:3], 0
  ds_read_b64_tr_b16 v[72:73], v14 offset:2048
  v_mov_b32 v254, 1
  s_cmp_eq_u32 s6, 3
  s_cselect_b32 s53, 0, 0x40000000
  s_cmp_eq_u32 s4, 15
  s_cselect_b32 s53, 0x40000000, s53
  s_add_u32 s54, s4, 1
  s_lshr_b32 s52, s54, 1
  s_lshl_b32 s52, s52, 5
  s_and_b32 s54, s54, 1
  s_lshl_b32 s54, s54, 2
  s_add_u32 s52, s52, s54
  s_add_u32 s52, s52, 8
  s_or_b32 s53, s53, s52
  v_mov_b32 v255, s53
  s_mov_b64 exec, 1
  buffer_atomic_add v254, v255, s[36:39], 0 offen
  s_mov_b64 exec, -1
  v_mfma_f32_16x16x32_bf16 v[132:135], v[84:87], a[4:7], 0
  s_waitcnt lgkmcnt(3)
  ds_read_b64_tr_b16 v[74:75], v14 offset:3072
  buffer_load_dwordx4 a[40:43], v1, s[28:31], s92 offen offset:1024 sc1
  v_mfma_f32_16x16x32_bf16 v[136:139], v[88:91], a[0:3], 0
  ds_read_b64_tr_b16 v[76:77], v15 offset:2048
  v_mfma_f32_16x16x32_bf16 v[140:143], v[88:91], a[4:7], 0
  s_waitcnt lgkmcnt(3)
  ds_read_b64_tr_b16 v[78:79], v15 offset:3072
  v_mfma_f32_16x16x32_bf16 v[144:147], v[92:95], a[0:3], 0
  ds_read_b64_tr_b16 v[80:81], v14 offset:34816
  buffer_load_dwordx4 a[44:47], v1, s[28:31], s93 offen offset:1024 sc1
  v_mfma_f32_16x16x32_bf16 v[148:151], v[92:95], a[4:7], 0
  s_waitcnt vmcnt(12) lgkmcnt(3)
  ds_read_b64_tr_b16 v[82:83], v14 offset:35840
  v_mfma_f32_16x16x32_bf16 v[104:107], v[72:75], a[8:11], v[104:107]
  s_waitcnt vmcnt(11)
  ds_read_b64_tr_b16 v[84:85], v15 offset:34816
  v_mfma_f32_16x16x32_bf16 v[108:111], v[72:75], a[12:15], v[108:111]
  s_waitcnt lgkmcnt(3)
  ds_read_b64_tr_b16 v[86:87], v15 offset:35840
  buffer_load_dwordx4 a[48:51], v1, s[28:31], s92 offen offset:2048 sc1
  v_mfma_f32_16x16x32_bf16 v[112:115], v[76:79], a[8:11], v[112:115]
  ds_read_b64_tr_b16 v[88:89], v16 offset:2048
  v_mfma_f32_16x16x32_bf16 v[116:119], v[76:79], a[12:15], v[116:119]
  s_waitcnt lgkmcnt(3)
  ds_read_b64_tr_b16 v[90:91], v16 offset:3072
  v_mfma_f32_16x16x32_bf16 v[120:123], v[80:83], a[8:11], v[120:123]
  ds_read_b64_tr_b16 v[92:93], v17 offset:2048
  buffer_load_dwordx4 a[52:55], v1, s[28:31], s93 offen offset:2048 sc1
  v_mfma_f32_16x16x32_bf16 v[124:127], v[80:83], a[12:15], v[124:127]
  s_waitcnt lgkmcnt(3)
  ds_read_b64_tr_b16 v[94:95], v17 offset:3072
  v_mfma_f32_16x16x32_bf16 v[128:131], v[84:87], a[8:11], v[128:131]
  ds_read_b64_tr_b16 v[72:73], v14 offset:4096
  v_mfma_f32_16x16x32_bf16 v[132:135], v[84:87], a[12:15], v[132:135]
  s_waitcnt lgkmcnt(3)
  ds_read_b64_tr_b16 v[74:75], v14 offset:5120
  buffer_load_dwordx4 a[56:59], v1, s[28:31], s92 offen offset:3072 sc1
  v_mfma_f32_16x16x32_bf16 v[136:139], v[88:91], a[8:11], v[136:139]
  ds_read_b64_tr_b16 v[76:77], v15 offset:4096
  v_mfma_f32_16x16x32_bf16 v[140:143], v[88:91], a[12:15], v[140:143]
  s_waitcnt lgkmcnt(3)
  ds_read_b64_tr_b16 v[78:79], v15 offset:5120
  v_mfma_f32_16x16x32_bf16 v[144:147], v[92:95], a[8:11], v[144:147]
  ds_read_b64_tr_b16 v[80:81], v14 offset:36864
  buffer_load_dwordx4 a[60:63], v1, s[28:31], s93 offen offset:3072 sc1
  v_mfma_f32_16x16x32_bf16 v[148:151], v[92:95], a[12:15], v[148:151]
  s_waitcnt vmcnt(14) lgkmcnt(3)
  ds_read_b64_tr_b16 v[82:83], v14 offset:37888
  v_mfma_f32_16x16x32_bf16 v[104:107], v[72:75], a[16:19], v[104:107]
  s_waitcnt vmcnt(13)
  ds_read_b64_tr_b16 v[84:85], v15 offset:36864
  v_mfma_f32_16x16x32_bf16 v[108:111], v[72:75], a[20:23], v[108:111]
  s_waitcnt lgkmcnt(3)
  ds_read_b64_tr_b16 v[86:87], v15 offset:37888
  s_add_u32 s92, s50, 8192
  buffer_load_dwordx4 a[64:67], v1, s[28:31], s92 offen offset:0 sc1
  v_mfma_f32_16x16x32_bf16 v[112:115], v[76:79], a[16:19], v[112:115]
  ds_read_b64_tr_b16 v[88:89], v16 offset:4096
  s_waitcnt vmcnt(10)
  v_add_f32 v180, v180, v182
  v_mfma_f32_16x16x32_bf16 v[116:119], v[76:79], a[20:23], v[116:119]
  s_waitcnt lgkmcnt(3)
  ds_read_b64_tr_b16 v[90:91], v16 offset:5120
  v_add_f32 v181, v181, v183
  v_mfma_f32_16x16x32_bf16 v[120:123], v[80:83], a[16:19], v[120:123]
  ds_read_b64_tr_b16 v[92:93], v17 offset:4096
  s_add_u32 s93, s51, 8192
  buffer_load_dwordx4 a[68:71], v1, s[28:31], s93 offen offset:0 sc1
  v_mfma_f32_16x16x32_bf16 v[124:127], v[80:83], a[20:23], v[124:127]
  s_waitcnt lgkmcnt(3)
  ds_read_b64_tr_b16 v[94:95], v17 offset:5120
  v_permlane32_swap_b32 v180, v181
  v_mfma_f32_16x16x32_bf16 v[128:131], v[84:87], a[16:19], v[128:131]
  ds_read_b64_tr_b16 v[72:73], v14 offset:6144
  v_add_f32 v180, v180, v181
  v_mfma_f32_16x16x32_bf16 v[132:135], v[84:87], a[20:23], v[132:135]
  s_waitcnt lgkmcnt(3)
  ds_read_b64_tr_b16 v[74:75], v14 offset:7168
  v_mov_b32 v252, v180
  v_mfma_f32_16x16x32_bf16 v[136:139], v[88:91], a[16:19], v[136:139]
  ds_read_b64_tr_b16 v[76:77], v15 offset:6144
  buffer_load_dwordx4 a[72:75], v1, s[28:31], s92 offen offset:1024 sc1
  v_mfma_f32_16x16x32_bf16 v[140:143], v[88:91], a[20:23], v[140:143]
  s_waitcnt lgkmcnt(3)
  ds_read_b64_tr_b16 v[78:79], v15 offset:7168
  v_permlane16_swap_b32 v180, v252
  v_mfma_f32_16x16x32_bf16 v[144:147], v[92:95], a[16:19], v[144:147]
  ds_read_b64_tr_b16 v[80:81], v14 offset:38912
  v_add_f32 v180, v180, v252
  v_mfma_f32_16x16x32_bf16 v[148:151], v[92:95], a[20:23], v[148:151]
  s_waitcnt lgkmcnt(3)
  ds_read_b64_tr_b16 v[82:83], v14 offset:39936
  v_mov_b32 v181, v180
  v_mfma_f32_16x16x32_bf16 v[104:107], v[72:75], a[24:27], v[104:107]
  ds_read_b64_tr_b16 v[84:85], v15 offset:38912
  buffer_load_dwordx4 a[76:79], v1, s[28:31], s93 offen offset:1024 sc1
  v_mfma_f32_16x16x32_bf16 v[108:111], v[72:75], a[28:31], v[108:111]
  s_waitcnt lgkmcnt(3)
  ds_read_b64_tr_b16 v[86:87], v15 offset:39936
  v_permlane32_swap_b32 v180, v181
  v_mfma_f32_16x16x32_bf16 v[112:115], v[76:79], a[24:27], v[112:115]
  ds_read_b64_tr_b16 v[88:89], v16 offset:6144
  v_mul_f32 v248, 0x3b000000, v180
  v_mfma_f32_16x16x32_bf16 v[116:119], v[76:79], a[28:31], v[116:119]
  s_waitcnt lgkmcnt(3)
  ds_read_b64_tr_b16 v[90:91], v16 offset:7168
  v_mul_f32 v249, 0x3b000000, v181
  v_mfma_f32_16x16x32_bf16 v[120:123], v[80:83], a[24:27], v[120:123]
  ds_read_b64_tr_b16 v[92:93], v17 offset:6144
  buffer_load_dwordx4 a[80:83], v1, s[28:31], s92 offen offset:2048 sc1
  v_mfma_f32_16x16x32_bf16 v[124:127], v[80:83], a[28:31], v[124:127]
  s_waitcnt lgkmcnt(3)
  ds_read_b64_tr_b16 v[94:95], v17 offset:7168
  v_fma_f32 v249, -v248, v248, v249
  v_mfma_f32_16x16x32_bf16 v[128:131], v[84:87], a[24:27], v[128:131]
  ds_read_b64_tr_b16 v[72:73], v14 offset:8192
  v_max_f32 v249, 0, v249
  v_mfma_f32_16x16x32_bf16 v[132:135], v[84:87], a[28:31], v[132:135]
  s_waitcnt lgkmcnt(3)
  ds_read_b64_tr_b16 v[74:75], v14 offset:9216
  v_add_f32 v249, 0x3727c5ac, v249
  v_mfma_f32_16x16x32_bf16 v[136:139], v[88:91], a[24:27], v[136:139]
  ds_read_b64_tr_b16 v[76:77], v15 offset:8192
  buffer_load_dwordx4 a[84:87], v1, s[28:31], s93 offen offset:2048 sc1
  v_mfma_f32_16x16x32_bf16 v[140:143], v[88:91], a[28:31], v[140:143]
  s_waitcnt lgkmcnt(3)
  ds_read_b64_tr_b16 v[78:79], v15 offset:9216
  v_rsq_f32 v168, v249
  v_mfma_f32_16x16x32_bf16 v[144:147], v[92:95], a[24:27], v[144:147]
  ds_read_b64_tr_b16 v[80:81], v14 offset:40960
  v_mul_f32 v169, -v248, v168
  v_mfma_f32_16x16x32_bf16 v[148:151], v[92:95], a[28:31], v[148:151]
  s_waitcnt vmcnt(14) lgkmcnt(3)
  ds_read_b64_tr_b16 v[82:83], v14 offset:41984
  v_mul_f32 v172, 0x3eb8aa3b, v168
  v_mfma_f32_16x16x32_bf16 v[104:107], v[72:75], a[32:35], v[104:107]
  s_waitcnt vmcnt(13)
  ds_read_b64_tr_b16 v[84:85], v15 offset:40960
  buffer_load_dwordx4 a[88:91], v1, s[28:31], s92 offen offset:3072 sc1
  v_mfma_f32_16x16x32_bf16 v[108:111], v[72:75], a[36:39], v[108:111]
  s_waitcnt lgkmcnt(3)
  ds_read_b64_tr_b16 v[86:87], v15 offset:41984
  v_mul_f32 v173, 0x3eb8aa3b, v169
  v_mfma_f32_16x16x32_bf16 v[112:115], v[76:79], a[32:35], v[112:115]
  ds_read_b64_tr_b16 v[88:89], v16 offset:8192
  v_add_f32 v184, v184, v186
  v_mfma_f32_16x16x32_bf16 v[116:119], v[76:79], a[36:39], v[116:119]
  s_waitcnt lgkmcnt(3)
  ds_read_b64_tr_b16 v[90:91], v16 offset:9216
  v_add_f32 v185, v185, v187
  v_mfma_f32_16x16x32_bf16 v[120:123], v[80:83], a[32:35], v[120:123]
  ds_read_b64_tr_b16 v[92:93], v17 offset:8192
  buffer_load_dwordx4 a[92:95], v1, s[28:31], s93 offen offset:3072 sc1
  v_mfma_f32_16x16x32_bf16 v[124:127], v[80:83], a[36:39], v[124:127]
  s_waitcnt lgkmcnt(3)
  ds_read_b64_tr_b16 v[94:95], v17 offset:9216
  v_permlane32_swap_b32 v184, v185
  v_mfma_f32_16x16x32_bf16 v[128:131], v[84:87], a[32:35], v[128:131]
  ds_read_b64_tr_b16 v[72:73], v14 offset:10240
  s_add_u32 s92, s50, 12288
  buffer_load_dwordx4 a[0:3], v1, s[28:31], s92 offen offset:0 sc1
  v_mfma_f32_16x16x32_bf16 v[132:135], v[84:87], a[36:39], v[132:135]
  s_waitcnt lgkmcnt(3)
  ds_read_b64_tr_b16 v[74:75], v14 offset:11264
  v_add_f32 v184, v184, v185
  v_mfma_f32_16x16x32_bf16 v[136:139], v[88:91], a[32:35], v[136:139]
  ds_read_b64_tr_b16 v[76:77], v15 offset:10240
  s_add_u32 s93, s51, 12288
  buffer_load_dwordx4 a[4:7], v1, s[28:31], s93 offen offset:0 sc1
  v_mfma_f32_16x16x32_bf16 v[140:143], v[88:91], a[36:39], v[140:143]
  s_waitcnt lgkmcnt(3)
  ds_read_b64_tr_b16 v[78:79], v15 offset:11264
  v_mov_b32 v252, v184
  v_mfma_f32_16x16x32_bf16 v[144:147], v[92:95], a[32:35], v[144:147]
  ds_read_b64_tr_b16 v[80:81], v14 offset:43008
  buffer_load_dwordx4 a[8:11], v1, s[28:31], s92 offen offset:1024 sc1
  v_mfma_f32_16x16x32_bf16 v[148:151], v[92:95], a[36:39], v[148:151]
  s_waitcnt vmcnt(16) lgkmcnt(3)
  ds_read_b64_tr_b16 v[82:83], v14 offset:44032
  v_permlane16_swap_b32 v184, v252
  v_mfma_f32_16x16x32_bf16 v[104:107], v[72:75], a[40:43], v[104:107]
  s_waitcnt vmcnt(15)
  ds_read_b64_tr_b16 v[84:85], v15 offset:43008
  buffer_load_dwordx4 a[12:15], v1, s[28:31], s93 offen offset:1024 sc1
  v_mfma_f32_16x16x32_bf16 v[108:111], v[72:75], a[44:47], v[108:111]
  s_waitcnt lgkmcnt(3)
  ds_read_b64_tr_b16 v[86:87], v15 offset:44032
  v_add_f32 v184, v184, v252
  v_mfma_f32_16x16x32_bf16 v[112:115], v[76:79], a[40:43], v[112:115]
  ds_read_b64_tr_b16 v[88:89], v16 offset:10240
  buffer_load_dwordx4 a[16:19], v1, s[28:31], s92 offen offset:2048 sc1
  v_mfma_f32_16x16x32_bf16 v[116:119], v[76:79], a[44:47], v[116:119]
  s_waitcnt lgkmcnt(3)
  ds_read_b64_tr_b16 v[90:91], v16 offset:11264
  v_mov_b32 v185, v184
  v_mfma_f32_16x16x32_bf16 v[120:123], v[80:83], a[40:43], v[120:123]
  ds_read_b64_tr_b16 v[92:93], v17 offset:10240
  buffer_load_dwordx4 a[20:23], v1, s[28:31], s93 offen offset:2048 sc1
  v_mfma_f32_16x16x32_bf16 v[124:127], v[80:83], a[44:47], v[124:127]
  s_waitcnt lgkmcnt(3)
  ds_read_b64_tr_b16 v[94:95], v17 offset:11264
  v_permlane32_swap_b32 v184, v185
  v_mfma_f32_16x16x32_bf16 v[128:131], v[84:87], a[40:43], v[128:131]
  ds_read_b64_tr_b16 v[72:73], v14 offset:12288
  buffer_load_dwordx4 a[24:27], v1, s[28:31], s92 offen offset:3072 sc1
  v_mfma_f32_16x16x32_bf16 v[132:135], v[84:87], a[44:47], v[132:135]
  s_waitcnt lgkmcnt(3)
  ds_read_b64_tr_b16 v[74:75], v14 offset:13312
  v_mul_f32 v248, 0x3b000000, v184
  v_mfma_f32_16x16x32_bf16 v[136:139], v[88:91], a[40:43], v[136:139]
  ds_read_b64_tr_b16 v[76:77], v15 offset:12288
  buffer_load_dwordx4 a[28:31], v1, s[28:31], s93 offen offset:3072 sc1
  v_mfma_f32_16x16x32_bf16 v[140:143], v[88:91], a[44:47], v[140:143]
  s_waitcnt lgkmcnt(3)
  ds_read_b64_tr_b16 v[78:79], v15 offset:13312
  v_mul_f32 v249, 0x3b000000, v185
  v_mfma_f32_16x16x32_bf16 v[144:147], v[92:95], a[40:43], v[144:147]
  ds_read_b64_tr_b16 v[80:81], v14 offset:45056
  v_fma_f32 v249, -v248, v248, v249
  v_mfma_f32_16x16x32_bf16 v[148:151], v[92:95], a[44:47], v[148:151]
  s_waitcnt vmcnt(19) lgkmcnt(3)
  ds_read_b64_tr_b16 v[82:83], v14 offset:46080
  v_mov_b32 v229, 0
  s_lshr_b32 s54, s4, 1
  s_lshl_b32 s54, s54, 5
  s_and_b32 s53, s4, 1
  s_lshl_b32 s53, s53, 2
  s_add_u32 s54, s54, s53
  s_add_u32 s79, s54, 8
  buffer_load_dword v228, v229, s[36:39], s79 offen sc1
  v_mfma_f32_16x16x32_bf16 v[104:107], v[72:75], a[48:51], v[104:107]
  s_waitcnt vmcnt(19)
  ds_read_b64_tr_b16 v[84:85], v15 offset:45056
  v_max_f32 v249, 0, v249
  v_mfma_f32_16x16x32_bf16 v[108:111], v[72:75], a[52:55], v[108:111]
  s_waitcnt lgkmcnt(3)
  ds_read_b64_tr_b16 v[86:87], v15 offset:46080
  v_add_f32 v249, 0x3727c5ac, v249
  v_mfma_f32_16x16x32_bf16 v[112:115], v[76:79], a[48:51], v[112:115]
  ds_read_b64_tr_b16 v[88:89], v16 offset:12288
  v_rsq_f32 v170, v249
  v_mfma_f32_16x16x32_bf16 v[116:119], v[76:79], a[52:55], v[116:119]
  s_waitcnt lgkmcnt(3)
  ds_read_b64_tr_b16 v[90:91], v16 offset:13312
  v_mul_f32 v171, -v248, v170
  v_mfma_f32_16x16x32_bf16 v[120:123], v[80:83], a[48:51], v[120:123]
  ds_read_b64_tr_b16 v[92:93], v17 offset:12288
  v_mul_f32 v174, 0x3eb8aa3b, v170
  v_mfma_f32_16x16x32_bf16 v[124:127], v[80:83], a[52:55], v[124:127]
  s_waitcnt lgkmcnt(3)
  ds_read_b64_tr_b16 v[94:95], v17 offset:13312
  v_mul_f32 v175, 0x3eb8aa3b, v171
  v_mfma_f32_16x16x32_bf16 v[128:131], v[84:87], a[48:51], v[128:131]
  ds_read_b64_tr_b16 v[72:73], v14 offset:14336
  v_mfma_f32_16x16x32_bf16 v[132:135], v[84:87], a[52:55], v[132:135]
  s_waitcnt lgkmcnt(3)
  ds_read_b64_tr_b16 v[74:75], v14 offset:15360
  v_mfma_f32_16x16x32_bf16 v[136:139], v[88:91], a[48:51], v[136:139]
  ds_read_b64_tr_b16 v[76:77], v15 offset:14336
  v_mfma_f32_16x16x32_bf16 v[140:143], v[88:91], a[52:55], v[140:143]
  s_waitcnt lgkmcnt(3)
  ds_read_b64_tr_b16 v[78:79], v15 offset:15360
  v_mfma_f32_16x16x32_bf16 v[144:147], v[92:95], a[48:51], v[144:147]
  ds_read_b64_tr_b16 v[80:81], v14 offset:47104
  v_mfma_f32_16x16x32_bf16 v[148:151], v[92:95], a[52:55], v[148:151]
  s_waitcnt vmcnt(18) lgkmcnt(3)
  ds_read_b64_tr_b16 v[82:83], v14 offset:48128
  v_mfma_f32_16x16x32_bf16 v[104:107], v[72:75], a[56:59], v[104:107]
  s_waitcnt vmcnt(17)
  ds_read_b64_tr_b16 v[84:85], v15 offset:47104
  v_mfma_f32_16x16x32_bf16 v[108:111], v[72:75], a[60:63], v[108:111]
  s_waitcnt lgkmcnt(3)
  ds_read_b64_tr_b16 v[86:87], v15 offset:48128
  v_mfma_f32_16x16x32_bf16 v[112:115], v[76:79], a[56:59], v[112:115]
  ds_read_b64_tr_b16 v[88:89], v16 offset:14336
  v_mfma_f32_16x16x32_bf16 v[116:119], v[76:79], a[60:63], v[116:119]
  s_waitcnt lgkmcnt(3)
  ds_read_b64_tr_b16 v[90:91], v16 offset:15360
  v_mfma_f32_16x16x32_bf16 v[120:123], v[80:83], a[56:59], v[120:123]
  ds_read_b64_tr_b16 v[92:93], v17 offset:14336
  v_mfma_f32_16x16x32_bf16 v[124:127], v[80:83], a[60:63], v[124:127]
  s_waitcnt lgkmcnt(3)
  ds_read_b64_tr_b16 v[94:95], v17 offset:15360
  v_mfma_f32_16x16x32_bf16 v[128:131], v[84:87], a[56:59], v[128:131]
  ds_read_b64_tr_b16 v[72:73], v14 offset:16384
  v_mfma_f32_16x16x32_bf16 v[132:135], v[84:87], a[60:63], v[132:135]
  s_waitcnt lgkmcnt(3)
  ds_read_b64_tr_b16 v[74:75], v14 offset:17408
  v_mfma_f32_16x16x32_bf16 v[136:139], v[88:91], a[56:59], v[136:139]
  ds_read_b64_tr_b16 v[76:77], v15 offset:16384
  v_mfma_f32_16x16x32_bf16 v[140:143], v[88:91], a[60:63], v[140:143]
  s_waitcnt lgkmcnt(3)
  ds_read_b64_tr_b16 v[78:79], v15 offset:17408
  v_mfma_f32_16x16x32_bf16 v[144:147], v[92:95], a[56:59], v[144:147]
  ds_read_b64_tr_b16 v[80:81], v14 offset:49152
  v_mfma_f32_16x16x32_bf16 v[148:151], v[92:95], a[60:63], v[148:151]
  s_waitcnt vmcnt(16) lgkmcnt(3)
  ds_read_b64_tr_b16 v[82:83], v14 offset:50176
  v_mfma_f32_16x16x32_bf16 v[104:107], v[72:75], a[64:67], v[104:107]
  s_waitcnt vmcnt(15)
  ds_read_b64_tr_b16 v[84:85], v15 offset:49152
  v_mfma_f32_16x16x32_bf16 v[108:111], v[72:75], a[68:71], v[108:111]
  s_waitcnt lgkmcnt(3)
  ds_read_b64_tr_b16 v[86:87], v15 offset:50176
  v_mfma_f32_16x16x32_bf16 v[112:115], v[76:79], a[64:67], v[112:115]
  ds_read_b64_tr_b16 v[88:89], v16 offset:16384
  v_mfma_f32_16x16x32_bf16 v[116:119], v[76:79], a[68:71], v[116:119]
  s_waitcnt lgkmcnt(3)
  ds_read_b64_tr_b16 v[90:91], v16 offset:17408
  v_mfma_f32_16x16x32_bf16 v[120:123], v[80:83], a[64:67], v[120:123]
  ds_read_b64_tr_b16 v[92:93], v17 offset:16384
  v_mfma_f32_16x16x32_bf16 v[124:127], v[80:83], a[68:71], v[124:127]
  s_waitcnt lgkmcnt(3)
  ds_read_b64_tr_b16 v[94:95], v17 offset:17408
  v_mfma_f32_16x16x32_bf16 v[128:131], v[84:87], a[64:67], v[128:131]
  ds_read_b64_tr_b16 v[72:73], v14 offset:18432
  v_mfma_f32_16x16x32_bf16 v[132:135], v[84:87], a[68:71], v[132:135]
  s_waitcnt lgkmcnt(3)
  ds_read_b64_tr_b16 v[74:75], v14 offset:19456
  v_mfma_f32_16x16x32_bf16 v[136:139], v[88:91], a[64:67], v[136:139]
  ds_read_b64_tr_b16 v[76:77], v15 offset:18432
  v_mfma_f32_16x16x32_bf16 v[140:143], v[88:91], a[68:71], v[140:143]
  s_waitcnt lgkmcnt(3)
  ds_read_b64_tr_b16 v[78:79], v15 offset:19456
  v_mfma_f32_16x16x32_bf16 v[144:147], v[92:95], a[64:67], v[144:147]
  ds_read_b64_tr_b16 v[80:81], v14 offset:51200
  v_mfma_f32_16x16x32_bf16 v[148:151], v[92:95], a[68:71], v[148:151]
  s_waitcnt vmcnt(14) lgkmcnt(3)
  ds_read_b64_tr_b16 v[82:83], v14 offset:52224
  v_mfma_f32_16x16x32_bf16 v[104:107], v[72:75], a[72:75], v[104:107]
  s_waitcnt vmcnt(13)
  ds_read_b64_tr_b16 v[84:85], v15 offset:51200
  v_mfma_f32_16x16x32_bf16 v[108:111], v[72:75], a[76:79], v[108:111]
  s_waitcnt lgkmcnt(3)
  ds_read_b64_tr_b16 v[86:87], v15 offset:52224
  v_mfma_f32_16x16x32_bf16 v[112:115], v[76:79], a[72:75], v[112:115]
  ds_read_b64_tr_b16 v[88:89], v16 offset:18432
  v_mfma_f32_16x16x32_bf16 v[116:119], v[76:79], a[76:79], v[116:119]
  s_waitcnt lgkmcnt(3)
  ds_read_b64_tr_b16 v[90:91], v16 offset:19456
  v_mfma_f32_16x16x32_bf16 v[120:123], v[80:83], a[72:75], v[120:123]
  ds_read_b64_tr_b16 v[92:93], v17 offset:18432
  v_mfma_f32_16x16x32_bf16 v[124:127], v[80:83], a[76:79], v[124:127]
  s_waitcnt lgkmcnt(3)
  ds_read_b64_tr_b16 v[94:95], v17 offset:19456
  v_mfma_f32_16x16x32_bf16 v[128:131], v[84:87], a[72:75], v[128:131]
  ds_read_b64_tr_b16 v[72:73], v14 offset:20480
  v_mfma_f32_16x16x32_bf16 v[132:135], v[84:87], a[76:79], v[132:135]
  s_waitcnt lgkmcnt(3)
  ds_read_b64_tr_b16 v[74:75], v14 offset:21504
  v_mfma_f32_16x16x32_bf16 v[136:139], v[88:91], a[72:75], v[136:139]
  ds_read_b64_tr_b16 v[76:77], v15 offset:20480
  v_mfma_f32_16x16x32_bf16 v[140:143], v[88:91], a[76:79], v[140:143]
  s_waitcnt lgkmcnt(3)
  ds_read_b64_tr_b16 v[78:79], v15 offset:21504
  v_mfma_f32_16x16x32_bf16 v[144:147], v[92:95], a[72:75], v[144:147]
  ds_read_b64_tr_b16 v[80:81], v14 offset:53248
  v_mfma_f32_16x16x32_bf16 v[148:151], v[92:95], a[76:79], v[148:151]
  s_waitcnt vmcnt(12) lgkmcnt(3)
  ds_read_b64_tr_b16 v[82:83], v14 offset:54272
  v_mfma_f32_16x16x32_bf16 v[104:107], v[72:75], a[80:83], v[104:107]
  s_waitcnt vmcnt(11)
  ds_read_b64_tr_b16 v[84:85], v15 offset:53248
  s_waitcnt vmcnt(0)
  s_mov_b32 s77, 0
  s_cmp_eq_u32 s4, 0
  s_nop 2
  s_cbranch_scc1 hok_54
hsp_53:
  v_cmp_ne_u32 vcc, 16, v228
  s_nop 4
  s_cbranch_vccz hok_54
  buffer_load_dword v228, v229, s[36:39], s79 offen sc1
  s_add_u32 s77, s77, 1
  s_waitcnt vmcnt(0)
  s_cmp_lt_u32 s77, 0x100000
  s_cbranch_scc1 hsp_53
  s_endpgm
hok_54:
  s_cmp_eq_u32 s4, 0
  s_cselect_b32 s53, 0x40000000, 0
  v_or_b32 v229, s53, v1
  s_lshl_b32 s53, s4, 10
  s_add_u32 s53, s53, 524288
  buffer_load_dwordx4 v[224:227], v229, s[28:31], s53 offen sc1
  s_lshl_b32 s53, s4, 14
  s_lshl_b32 s54, s6, 12
  s_add_u32 s53, s53, s54
  s_add_u32 s79, s53, 589824
  buffer_load_dwordx4 v[208:211], v229, s[28:31], s79 offen offset:0 sc1
  buffer_load_dwordx4 v[212:215], v229, s[28:31], s79 offen offset:1024 sc1
  buffer_load_dwordx4 v[216:219], v229, s[28:31], s79 offen offset:2048 sc1
  buffer_load_dwordx4 v[220:223], v229, s[28:31], s79 offen offset:3072 sc1
  v_mfma_f32_16x16x32_bf16 v[108:111], v[72:75], a[84:87], v[108:111]
  s_waitcnt lgkmcnt(3)
  ds_read_b64_tr_b16 v[86:87], v15 offset:54272
  v_mfma_f32_16x16x32_bf16 v[112:115], v[76:79], a[80:83], v[112:115]
  ds_read_b64_tr_b16 v[88:89], v16 offset:20480
  s_add_u32 m0, s49, 106496
  s_add_u32 s52, s48, 458752
  buffer_load_dwordx4 v37, s[20:23], s52 offen lds
  v_mfma_f32_16x16x32_bf16 v[116:119], v[76:79], a[84:87], v[116:119]
  s_waitcnt lgkmcnt(3)
  ds_read_b64_tr_b16 v[90:91], v16 offset:21504
  v_mfma_f32_16x16x32_bf16 v[120:123], v[80:83], a[80:83], v[120:123]
  ds_read_b64_tr_b16 v[92:93], v17 offset:20480
  v_mfma_f32_16x16x32_bf16 v[124:127], v[80:83], a[84:87], v[124:127]
  s_waitcnt lgkmcnt(3)
  ds_read_b64_tr_b16 v[94:95], v17 offset:21504
  s_add_u32 m0, s49, 107520
  s_add_u32 s52, s48, 458752
  buffer_load_dwordx4 v38, s[20:23], s52 offen lds
  v_mfma_f32_16x16x32_bf16 v[128:131], v[84:87], a[80:83], v[128:131]
  ds_read_b64_tr_b16 v[72:73], v14 offset:22528
  v_mfma_f32_16x16x32_bf16 v[132:135], v[84:87], a[84:87], v[132:135]
  s_waitcnt lgkmcnt(3)
  ds_read_b64_tr_b16 v[74:75], v14 offset:23552
  v_mfma_f32_16x16x32_bf16 v[136:139], v[88:91], a[80:83], v[136:139]
  ds_read_b64_tr_b16 v[76:77], v15 offset:22528
  s_add_u32 m0, s49, 108544
  s_add_u32 s52, s48, 458752
  buffer_load_dwordx4 v39, s[20:23], s52 offen lds
  v_mfma_f32_16x16x32_bf16 v[140:143], v[88:91], a[84:87], v[140:143]
  s_waitcnt lgkmcnt(3)
  ds_read_b64_tr_b16 v[78:79], v15 offset:23552
  v_mfma_f32_16x16x32_bf16 v[144:147], v[92:95], a[80:83], v[144:147]
  ds_read_b64_tr_b16 v[80:81], v14 offset:55296
  v_mfma_f32_16x16x32_bf16 v[148:151], v[92:95], a[84:87], v[148:151]
  s_waitcnt lgkmcnt(3)
  ds_read_b64_tr_b16 v[82:83], v14 offset:56320
  s_add_u32 m0, s49, 109568
  s_add_u32 s52, s48, 458752
  buffer_load_dwordx4 v40, s[20:23], s52 offen lds
  v_mfma_f32_16x16x32_bf16 v[104:107], v[72:75], a[88:91], v[104:107]
  ds_read_b64_tr_b16 v[84:85], v15 offset:55296
  v_mfma_f32_16x16x32_bf16 v[108:111], v[72:75], a[92:95], v[108:111]
  s_waitcnt lgkmcnt(3)
  ds_read_b64_tr_b16 v[86:87], v15 offset:56320
  v_mfma_f32_16x16x32_bf16 v[112:115], v[76:79], a[88:91], v[112:115]
  ds_read_b64_tr_b16 v[88:89], v16 offset:22528
  s_add_u32 m0, s49, 110592
  s_add_u32 s52, s48, 458752
  buffer_load_dwordx4 v41, s[20:23], s52 offen lds
  v_mfma_f32_16x16x32_bf16 v[116:119], v[76:79], a[92:95], v[116:119]
  s_waitcnt lgkmcnt(3)
  ds_read_b64_tr_b16 v[90:91], v16 offset:23552
  v_mfma_f32_16x16x32_bf16 v[120:123], v[80:83], a[88:91], v[120:123]
  ds_read_b64_tr_b16 v[92:93], v17 offset:22528
  v_mfma_f32_16x16x32_bf16 v[124:127], v[80:83], a[92:95], v[124:127]
  s_waitcnt lgkmcnt(3)
  ds_read_b64_tr_b16 v[94:95], v17 offset:23552
  s_add_u32 m0, s49, 111616
  s_add_u32 s52, s48, 458752
  buffer_load_dwordx4 v42, s[20:23], s52 offen lds
  v_mfma_f32_16x16x32_bf16 v[128:131], v[84:87], a[88:91], v[128:131]
  ds_read_b64_tr_b16 v[72:73], v14 offset:24576
  v_mfma_f32_16x16x32_bf16 v[132:135], v[84:87], a[92:95], v[132:135]
  s_waitcnt lgkmcnt(3)
  ds_read_b64_tr_b16 v[74:75], v14 offset:25600
  v_mfma_f32_16x16x32_bf16 v[136:139], v[88:91], a[88:91], v[136:139]
  ds_read_b64_tr_b16 v[76:77], v15 offset:24576
  s_add_u32 m0, s49, 112640
  s_add_u32 s52, s48, 458752
  buffer_load_dwordx4 v43, s[20:23], s52 offen lds
  v_mfma_f32_16x16x32_bf16 v[140:143], v[88:91], a[92:95], v[140:143]
  s_waitcnt lgkmcnt(3)
  ds_read_b64_tr_b16 v[78:79], v15 offset:25600
  v_mfma_f32_16x16x32_bf16 v[144:147], v[92:95], a[88:91], v[144:147]
  ds_read_b64_tr_b16 v[80:81], v14 offset:57344
  v_mfma_f32_16x16x32_bf16 v[148:151], v[92:95], a[92:95], v[148:151]
  s_waitcnt lgkmcnt(3)
  ds_read_b64_tr_b16 v[82:83], v14 offset:58368
  v_mfma_f32_16x16x32_bf16 v[104:107], v[72:75], a[0:3], v[104:107]
  ds_read_b64_tr_b16 v[84:85], v15 offset:57344
  v_mfma_f32_16x16x32_bf16 v[108:111], v[72:75], a[4:7], v[108:111]
  s_waitcnt lgkmcnt(3)
  ds_read_b64_tr_b16 v[86:87], v15 offset:58368
  v_mfma_f32_16x16x32_bf16 v[112:115], v[76:79], a[0:3], v[112:115]
  ds_read_b64_tr_b16 v[88:89], v16 offset:24576
  v_mfma_f32_16x16x32_bf16 v[116:119], v[76:79], a[4:7], v[116:119]
  s_waitcnt lgkmcnt(3)
  ds_read_b64_tr_b16 v[90:91], v16 offset:25600
  v_mfma_f32_16x16x32_bf16 v[120:123], v[80:83], a[0:3], v[120:123]
  ds_read_b64_tr_b16 v[92:93], v17 offset:24576
  v_mfma_f32_16x16x32_bf16 v[124:127], v[80:83], a[4:7], v[124:127]
  s_waitcnt lgkmcnt(3)
  ds_read_b64_tr_b16 v[94:95], v17 offset:25600
  v_mfma_f32_16x16x32_bf16 v[128:131], v[84:87], a[0:3], v[128:131]
  ds_read_b64_tr_b16 v[72:73], v14 offset:26624
  v_mfma_f32_16x16x32_bf16 v[132:135], v[84:87], a[4:7], v[132:135]
  s_waitcnt lgkmcnt(3)
  ds_read_b64_tr_b16 v[74:75], v14 offset:27648
  v_mfma_f32_16x16x32_bf16 v[136:139], v[88:91], a[0:3], v[136:139]
  ds_read_b64_tr_b16 v[76:77], v15 offset:26624
  v_mfma_f32_16x16x32_bf16 v[140:143], v[88:91], a[4:7], v[140:143]
  s_waitcnt lgkmcnt(3)
  ds_read_b64_tr_b16 v[78:79], v15 offset:27648
  v_mfma_f32_16x16x32_bf16 v[144:147], v[92:95], a[0:3], v[144:147]
  ds_read_b64_tr_b16 v[80:81], v14 offset:59392
  v_mfma_f32_16x16x32_bf16 v[148:151], v[92:95], a[4:7], v[148:151]
  s_waitcnt lgkmcnt(3)
  ds_read_b64_tr_b16 v[82:83], v14 offset:60416
  v_mfma_f32_16x16x32_bf16 v[104:107], v[72:75], a[8:11], v[104:107]
  ds_read_b64_tr_b16 v[84:85], v15 offset:59392
  v_mfma_f32_16x16x32_bf16 v[108:111], v[72:75], a[12:15], v[108:111]
  s_waitcnt lgkmcnt(3)
  ds_read_b64_tr_b16 v[86:87], v15 offset:60416
  v_mfma_f32_16x16x32_bf16 v[112:115], v[76:79], a[8:11], v[112:115]
  ds_read_b64_tr_b16 v[88:89], v16 offset:26624
  v_mfma_f32_16x16x32_bf16 v[116:119], v[76:79], a[12:15], v[116:119]
  s_waitcnt lgkmcnt(3)
  ds_read_b64_tr_b16 v[90:91], v16 offset:27648
  v_mfma_f32_16x16x32_bf16 v[120:123], v[80:83], a[8:11], v[120:123]
  ds_read_b64_tr_b16 v[92:93], v17 offset:26624
  v_mfma_f32_16x16x32_bf16 v[124:127], v[80:83], a[12:15], v[124:127]
  s_waitcnt lgkmcnt(3)
  ds_read_b64_tr_b16 v[94:95], v17 offset:27648
  v_mfma_f32_16x16x32_bf16 v[128:131], v[84:87], a[8:11], v[128:131]
  ds_read_b64_tr_b16 v[72:73], v14 offset:28672
  v_mfma_f32_16x16x32_bf16 v[132:135], v[84:87], a[12:15], v[132:135]
  s_waitcnt lgkmcnt(3)
  ds_read_b64_tr_b16 v[74:75], v14 offset:29696
  v_mfma_f32_16x16x32_bf16 v[136:139], v[88:91], a[8:11], v[136:139]
  ds_read_b64_tr_b16 v[76:77], v15 offset:28672
  v_mfma_f32_16x16x32_bf16 v[140:143], v[88:91], a[12:15], v[140:143]
  s_waitcnt lgkmcnt(3)
  ds_read_b64_tr_b16 v[78:79], v15 offset:29696
  v_mfma_f32_16x16x32_bf16 v[144:147], v[92:95], a[8:11], v[144:147]
  ds_read_b64_tr_b16 v[80:81], v14 offset:61440
  s_waitcnt vmcnt(11)
  v_add_f32 v224, v224, v226
  v_mfma_f32_16x16x32_bf16 v[148:151], v[92:95], a[12:15], v[148:151]
  s_waitcnt lgkmcnt(3)
  ds_read_b64_tr_b16 v[82:83], v14 offset:62464
  v_add_f32 v225, v225, v227
  v_mfma_f32_16x16x32_bf16 v[104:107], v[72:75], a[16:19], v[104:107]
  ds_read_b64_tr_b16 v[84:85], v15 offset:61440
  v_permlane32_swap_b32 v224, v225
  v_mfma_f32_16x16x32_bf16 v[108:111], v[72:75], a[20:23], v[108:111]
  s_waitcnt lgkmcnt(3)
  ds_read_b64_tr_b16 v[86:87], v15 offset:62464
  v_add_f32 v224, v224, v225
  v_mfma_f32_16x16x32_bf16 v[112:115], v[76:79], a[16:19], v[112:115]
  ds_read_b64_tr_b16 v[88:89], v16 offset:28672
  v_mov_b32 v252, v224
  v_mfma_f32_16x16x32_bf16 v[116:119], v[76:79], a[20:23], v[116:119]
  s_waitcnt lgkmcnt(3)
  ds_read_b64_tr_b16 v[90:91], v16 offset:29696
  v_permlane16_swap_b32 v224, v252
  v_mfma_f32_16x16x32_bf16 v[120:123], v[80:83], a[16:19], v[120:123]
  ds_read_b64_tr_b16 v[92:93], v17 offset:28672
  v_add_f32 v224, v224, v252
  v_mfma_f32_16x16x32_bf16 v[124:127], v[80:83], a[20:23], v[124:127]
  s_waitcnt lgkmcnt(3)
  ds_read_b64_tr_b16 v[94:95], v17 offset:29696
  v_mov_b32 v225, v224
  v_mfma_f32_16x16x32_bf16 v[128:131], v[84:87], a[16:19], v[128:131]
  ds_read_b64_tr_b16 v[72:73], v14 offset:30720
  v_permlane32_swap_b32 v224, v225
  v_mfma_f32_16x16x32_bf16 v[132:135], v[84:87], a[20:23], v[132:135]
  s_waitcnt lgkmcnt(3)
  ds_read_b64_tr_b16 v[74:75], v14 offset:31744
  v_mul_f32 v248, 0x3b000000, v224
  v_mfma_f32_16x16x32_bf16 v[136:139], v[88:91], a[16:19], v[136:139]
  ds_read_b64_tr_b16 v[76:77], v15 offset:30720
  v_mul_f32 v249, 0x3b000000, v225
  v_mfma_f32_16x16x32_bf16 v[140:143], v[88:91], a[20:23], v[140:143]
  s_waitcnt lgkmcnt(3)
  ds_read_b64_tr_b16 v[78:79], v15 offset:31744
  v_fma_f32 v249, -v248, v248, v249
  v_mfma_f32_16x16x32_bf16 v[144:147], v[92:95], a[16:19], v[144:147]
  ds_read_b64_tr_b16 v[80:81], v14 offset:63488
  v_max_f32 v249, 0, v249
  v_mfma_f32_16x16x32_bf16 v[148:151], v[92:95], a[20:23], v[148:151]
  s_waitcnt lgkmcnt(3)
  ds_read_b64_tr_b16 v[82:83], v14 offset:64512
  v_add_f32 v249, 0x3727c5ac, v249
  v_mfma_f32_16x16x32_bf16 v[104:107], v[72:75], a[24:27], v[104:107]
  ds_read_b64_tr_b16 v[84:85], v15 offset:63488
  v_rsq_f32 v176, v249
  v_mfma_f32_16x16x32_bf16 v[108:111], v[72:75], a[28:31], v[108:111]
  s_waitcnt lgkmcnt(3)
  ds_read_b64_tr_b16 v[86:87], v15 offset:64512
  s_waitcnt vmcnt(7)
  s_lshl_b32 s53, s6, 12
  s_add_u32 s53, s53, 135168
  v_add_u32 v228, s53, v1
  v_mfma_f32_16x16x32_bf16 v[112:115], v[76:79], a[24:27], v[112:115]
  ds_read_b64_tr_b16 v[88:89], v16 offset:30720
  v_mul_f32 v177, -v248, v176
  v_mfma_f32_16x16x32_bf16 v[116:119], v[76:79], a[28:31], v[116:119]
  s_waitcnt lgkmcnt(3)
  ds_read_b64_tr_b16 v[90:91], v16 offset:31744
  ds_write_b128 v228, v[208:211] offset:0
  v_mfma_f32_16x16x32_bf16 v[120:123], v[80:83], a[24:27], v[120:123]
  ds_read_b64_tr_b16 v[92:93], v17 offset:30720
  v_mfma_f32_16x16x32_bf16 v[124:127], v[80:83], a[28:31], v[124:127]
  s_waitcnt lgkmcnt(4)
  ds_read_b64_tr_b16 v[94:95], v17 offset:31744
  ds_write_b128 v228, v[212:215] offset:1024
  v_mfma_f32_16x16x32_bf16 v[128:131], v[84:87], a[24:27], v[128:131]
  v_mfma_f32_16x16x32_bf16 v[132:135], v[84:87], a[28:31], v[132:135]
  s_waitcnt lgkmcnt(4)
  ds_write_b128 v228, v[216:219] offset:2048
  v_mfma_f32_16x16x32_bf16 v[136:139], v[88:91], a[24:27], v[136:139]
  v_mfma_f32_16x16x32_bf16 v[140:143], v[88:91], a[28:31], v[140:143]
  s_waitcnt lgkmcnt(2)
  ds_write_b128 v228, v[220:223] offset:3072
  v_mfma_f32_16x16x32_bf16 v[144:147], v[92:95], a[24:27], v[144:147]
  v_mfma_f32_16x16x32_bf16 v[148:151], v[92:95], a[28:31], v[148:151]
  s_waitcnt lgkmcnt(0)
  s_barrier
  v_add_u32 v228, 135168, v1
  ds_read_b128 v[180:183], v228 offset:0
  ds_read_b64_tr_b16 v[72:73], v18 offset:0
  ds_read_b64_tr_b16 v[74:75], v18 offset:1024
  ds_read_b128 v[184:187], v228 offset:1024
  ds_read_b64_tr_b16 v[76:77], v18 offset:2048
  ds_read_b64_tr_b16 v[78:79], v18 offset:3072
  ds_read_b128 v[188:191], v228 offset:2048
  ds_read_b64_tr_b16 v[80:81], v18 offset:4096
  ds_read_b64_tr_b16 v[82:83], v18 offset:5120
  ds_read_b128 v[192:195], v228 offset:3072
  ds_read_b64_tr_b16 v[84:85], v18 offset:6144
  ds_read_b64_tr_b16 v[86:87], v18 offset:7168
  s_waitcnt lgkmcnt(9)
  v_mfma_f32_16x16x32_bf16 v[152:155], v[72:75], v[180:183], 0
  s_waitcnt lgkmcnt(6)
  ds_read_b128 v[196:199], v228 offset:4096
  ds_read_b64_tr_b16 v[88:89], v18 offset:8192
  ds_read_b64_tr_b16 v[90:91], v18 offset:9216
  v_mfma_f32_16x16x32_bf16 v[152:155], v[76:79], v[184:187], v[152:155]
  s_waitcnt lgkmcnt(6)
  ds_read_b128 v[200:203], v228 offset:5120
  ds_read_b64_tr_b16 v[92:93], v18 offset:10240
  ds_read_b64_tr_b16 v[94:95], v18 offset:11264
  v_mfma_f32_16x16x32_bf16 v[152:155], v[80:83], v[188:191], v[152:155]
  s_waitcnt lgkmcnt(6)
  ds_read_b128 v[204:207], v228 offset:6144
  ds_read_b64_tr_b16 v[72:73], v18 offset:12288
  ds_read_b64_tr_b16 v[74:75], v18 offset:13312
  v_mfma_f32_16x16x32_bf16 v[152:155], v[84:87], v[192:195], v[152:155]
  s_waitcnt lgkmcnt(6)
  ds_read_b128 v[180:183], v228 offset:7168
  ds_read_b64_tr_b16 v[76:77], v18 offset:14336
  ds_read_b64_tr_b16 v[78:79], v18 offset:15360
  v_mfma_f32_16x16x32_bf16 v[152:155], v[88:91], v[196:199], v[152:155]
  s_waitcnt lgkmcnt(6)
  ds_read_b128 v[184:187], v228 offset:8192
  ds_read_b64_tr_b16 v[80:81], v18 offset:16384
  ds_read_b64_tr_b16 v[82:83], v18 offset:17408
  v_mfma_f32_16x16x32_bf16 v[152:155], v[92:95], v[200:203], v[152:155]
  s_waitcnt lgkmcnt(6)
  ds_read_b128 v[188:191], v228 offset:9216
  ds_read_b64_tr_b16 v[84:85], v18 offset:18432
  ds_read_b64_tr_b16 v[86:87], v18 offset:19456
  v_mfma_f32_16x16x32_bf16 v[152:155], v[72:75], v[204:207], v[152:155]
  s_waitcnt lgkmcnt(6)
  ds_read_b128 v[192:195], v228 offset:10240
  ds_read_b64_tr_b16 v[88:89], v18 offset:20480
  ds_read_b64_tr_b16 v[90:91], v18 offset:21504
  v_mfma_f32_16x16x32_bf16 v[152:155], v[76:79], v[180:183], v[152:155]
  s_waitcnt lgkmcnt(6)
  ds_read_b128 v[196:199], v228 offset:11264
  ds_read_b64_tr_b16 v[92:93], v18 offset:22528
  ds_read_b64_tr_b16 v[94:95], v18 offset:23552
  v_mfma_f32_16x16x32_bf16 v[152:155], v[80:83], v[184:187], v[152:155]
  s_waitcnt lgkmcnt(6)
  ds_read_b128 v[200:203], v228 offset:12288
  ds_read_b64_tr_b16 v[72:73], v18 offset:24576
  ds_read_b64_tr_b16 v[74:75], v18 offset:25600
  v_mfma_f32_16x16x32_bf16 v[152:155], v[84:87], v[188:191], v[152:155]
  s_waitcnt lgkmcnt(6)
  ds_read_b128 v[204:207], v228 offset:13312
  ds_read_b64_tr_b16 v[76:77], v18 offset:26624
  ds_read_b64_tr_b16 v[78:79], v18 offset:27648
  v_mfma_f32_16x16x32_bf16 v[152:155], v[88:91], v[192:195], v[152:155]
  s_waitcnt lgkmcnt(6)
  ds_read_b128 v[180:183], v228 offset:14336
  ds_read_b64_tr_b16 v[80:81], v18 offset:28672
  ds_read_b64_tr_b16 v[82:83], v18 offset:29696
  v_mfma_f32_16x16x32_bf16 v[152:155], v[92:95], v[196:199], v[152:155]
  s_waitcnt lgkmcnt(6)
  ds_read_b128 v[184:187], v228 offset:15360
  ds_read_b64_tr_b16 v[84:85], v18 offset:30720
  ds_read_b64_tr_b16 v[86:87], v18 offset:31744
  v_mfma_f32_16x16x32_bf16 v[152:155], v[72:75], v[200:203], v[152:155]
  s_waitcnt lgkmcnt(6)
  v_mfma_f32_16x16x32_bf16 v[152:155], v[76:79], v[204:207], v[152:155]
  s_waitcnt lgkmcnt(3)
  v_mfma_f32_16x16x32_bf16 v[152:155], v[80:83], v[180:183], v[152:155]
  s_waitcnt lgkmcnt(0)
  v_mfma_f32_16x16x32_bf16 v[152:155], v[84:87], v[184:187], v[152:155]
  s_barrier
  s_waitcnt lgkmcnt(0)
  s_nop 5
  s_branch L_P1EPI
L_FINAL:
  v_permlane16_swap_b32 v2, v4
  v_permlane16_swap_b32 v3, v5
  v_permlane16_swap_b32 v6, v8
  v_permlane16_swap_b32 v7, v9
  buffer_store_dwordx4 v[2:5], v71, s[32:35], s61 offen offset:0
  s_mov_b32 s55, 0
  s_add_u32 s55, s55, s61
  buffer_store_dwordx4 v[6:9], v71, s[32:35], s55 offen offset:64
L_END:
  s_nop 1
  s_endpgm
.section .rodata,"a"
.p2align 6
.amdhsa_kernel interleave_layers__sliding_local_dilated__dense_activation_mish__prompt_kernel
  .amdhsa_next_free_vgpr 512
  .amdhsa_next_free_sgpr 102
  .amdhsa_accum_offset 256
  .amdhsa_group_segment_fixed_size 0
  .amdhsa_kernarg_size 80
  .amdhsa_user_sgpr_count 2
  .amdhsa_user_sgpr_kernarg_segment_ptr 1
  .amdhsa_system_sgpr_workgroup_id_x 1
  .amdhsa_float_denorm_mode_32 3
.end_amdhsa_kernel
```
